```python
import torch

def _softmax(x, axis=-1):
    return torch.softmax(x, dim=axis)
def _gelu(x):
    return torch.nn.functional.gelu(x, approximate="tanh")
def _silu(x):
    return torch.nn.functional.silu(x)
def _sigmoid(x):
    return torch.sigmoid(x)
def _layernorm(x, axis=-1, eps=1e-5):
    m = x.mean(dim=axis, keepdim=True)
    v = x.var(dim=axis, keepdim=True, unbiased=False)
    return (x - m) / torch.sqrt(v + eps)
def _scatter_add(tgt, idx, src, axis=0):
    return tgt.clone().index_add_(axis, idx, src)
def _segment_sum(src, seg, n):
    out = torch.zeros((n,) + src.shape[1:], dtype=src.dtype)
    return out.index_add_(0, seg, src)
def _pad(x, pw):
    flat = tuple(v for pair in reversed(pw) for v in pair)
    return torch.nn.functional.pad(x, flat)

kernel_name = 'sequential_preLN__sliding_block__glu_gated_bilinear__prompt'

def setup_inputs():

    _w = (lambda a: (lambda t: t.to(torch.bfloat16) if t.is_floating_point() else t)(torch.as_tensor(a)))
    def _A_setup():
        B, S, D = 1, 2048, 640
        return {
            "x": _w((lambda *s: torch.randn(*s, dtype=torch.bfloat16) * 0.05)(B, S, D)),
            "wqkv": _w((lambda *s: torch.randn(*s, dtype=torch.bfloat16) * 0.05)(D, 3 * D)),
            "wo": _w((lambda *s: torch.randn(*s, dtype=torch.bfloat16) * 0.05)(D, D)),
        }
    _A_in = _A_setup()

    def _B_setup():
        B, S, D, F = 1, 2048, 640, 1728
        return {
            "x": _w((lambda *s: torch.randn(*s, dtype=torch.bfloat16) * 0.05)(B, S, D)),
            "w_gate": _w((lambda *s: torch.randn(*s, dtype=torch.bfloat16) * 0.8)(D, F) * (D ** -0.5)),
            "w_up": _w((lambda *s: torch.randn(*s, dtype=torch.bfloat16) * 0.8)(D, F) * (D ** -0.5)),
            "w_down": _w((lambda *s: torch.randn(*s, dtype=torch.bfloat16) * 0.8)(F, D) * (F ** -0.5)),
        }
    _B_in = _B_setup()

    return {
        "A_x": _A_in["x"],
        "A_wqkv": _A_in["wqkv"],
        "A_wo": _A_in["wo"],
        "B_x": _B_in["x"],
        "B_w_gate": _B_in["w_gate"],
        "B_w_up": _B_in["w_up"],
        "B_w_down": _B_in["w_down"],
    }

def reference(A_x, A_wqkv, A_wo, B_x, B_w_gate, B_w_up, B_w_down):
    def _A_ref(x, wqkv, wo):
        B, S, D = x.shape
        H = 32; Dh = D // H; W = 256
        qkv = (lambda x, *d: x.permute(*d))((x @ wqkv).reshape(B, S, 3, H, Dh), 2, 0, 3, 1, 4)
        q, k, v = qkv[0], qkv[1], qkv[2]
        scores = torch.einsum("bhqd,bhkd->bhqk", q, k) * (Dh ** -0.5)
        idx = torch.arange(S)
        mask = (idx[:, None] - idx[None, :] >= 0) & (idx[:, None] - idx[None, :] < W)
        scores = torch.where(mask[None, None], scores, -1e9)
        p = _softmax(scores, axis=-1)
        o = torch.einsum("bhqk,bhkd->bhqd", p, v)
        return (lambda x, *d: x.permute(*d))(o, 0, 2, 1, 3).reshape(B, S, D) @ wo

    def _B_ref(x, w_gate, w_up, w_down):
        g = torch.einsum("bsd,df->bsf", x, w_gate)
        u = torch.einsum("bsd,df->bsf", x, w_up)
        h = g * u
        return torch.einsum("bsf,fd->bsd", h, w_down)

    x = A_x
    h = x + _A_ref(_layernorm(x, axis=-1), A_wqkv, A_wo)
    h2 = h + _B_ref(_layernorm(h, axis=-1), B_w_gate, B_w_up, B_w_down)
    return h2
```

```asm
; @launch grid=(256,1,1) block=(512,1,1) lds=158720
.amdgcn_target "amdgcn-amd-amdhsa--gfx950"
.text
.globl sequential_preLN__sliding_block__glu_gated_bilinear__prompt_kernel
.p2align 8
.type sequential_preLN__sliding_block__glu_gated_bilinear__prompt_kernel,@function
sequential_preLN__sliding_block__glu_gated_bilinear__prompt_kernel:
  s_load_dwordx2 s[8:9], s[0:1], 72
  s_load_dwordx2 s[4:5], s[0:1], 0
  s_load_dwordx2 s[6:7], s[0:1], 8
  s_cmp_ge_u32 s2, 256
  s_cbranch_scc1 L_exit_phF_kernel
  v_lshrrev_b32 v1, 6, v0
  s_and_b32 s13, s2, 7
  s_lshr_b32 s14, s2, 3
  v_readfirstlane_b32 s10, v1
  v_and_b32 v0, 63, v0
  s_lshr_b32 s12, s13, 1
  s_lshl_b32 s12, s12, 2
  s_lshr_b32 s15, s14, 3
  s_add_u32 s12, s12, s15
  s_and_b32 s11, s13, 1
  s_lshl_b32 s11, s11, 3
  s_and_b32 s15, s14, 7
  s_add_u32 s11, s11, s15
  s_lshr_b32 s29, s14, 3
  s_cmp_ge_u32 s12, 15
  s_cbranch_scc1 L_idle_phF_kernel
  s_cmp_ge_u32 s10, 4
  s_cbranch_scc1 L_prod_phF_kernel
  s_cmp_lg_u32 s10, 0
  s_cbranch_scc1 L_ncpf_phF_kernel
  s_getpc_b64 s[60:61]
L_pc_phF_kernel:
  s_mul_i32 s62, s14, 15
  v_add_u32 v250, s62, v0
  v_lshlrev_b32 v250, 7, v250
  s_mov_b32 s62, L_exit_phF_kernel-L_pc_phF_kernel
  v_min_u32 v250, s62, v250
  v_mov_b32 v251, s61
  v_add_co_u32 v250, vcc, s60, v250
  s_nop 1
  v_addc_co_u32 v251, vcc, 0, v251, vcc
  s_mov_b32 exec_lo, 0x7fff
  s_mov_b32 exec_hi, 0
  global_load_dword v252, v[250:251], off
  s_mov_b64 exec, -1
L_ncpf_phF_kernel:
  s_lshr_b32 s14, s10, 1
  s_and_b32 s15, s10, 1
  v_lshrrev_b32 v1, 4, v0
  v_and_b32 v2, 15, v0
  v_lshrrev_b32 v11, 1, v2
  v_xor_b32 v11, v11, v1
  v_lshlrev_b32 v11, 4, v11
  v_lshl_add_u32 v11, v2, 7, v11
  s_lshl_b32 s16, s14, 2
  s_lshl_b32 s17, s15, 1
  s_add_u32 s18, s16, s17
  s_xor_b32 s19, s18, 2
  s_lshl_b32 s16, s18, 11
  s_lshl_b32 s17, s19, 11
  v_add_u32 v3, s16, v11
  v_add_u32 v4, s17, v11
  v_xor_b32 v5, 64, v3
  v_xor_b32 v6, 64, v4
  v_and_b32 v11, 3, v0
  v_lshrrev_b32 v12, 2, v0
  v_and_b32 v12, 3, v12
  v_lshl_add_u32 v13, v1, 3, v12
  v_lshlrev_b32 v13, 8, v13
  v_add_u32 v13, 65536, v13
  v_and_b32 v14, 1, v1
  v_lshlrev_b32 v14, 3, v14
  v_lshl_or_b32 v14, v12, 1, v14
  v_xor_b32 v14, v14, v11
  v_lshrrev_b32 v15, 1, v11
  v_lshl_add_u32 v13, v15, 3, v13
  s_lshl_b32 s20, s15, 1
  s_add_u32 s20, s20, s14
  s_xor_b32 s21, s20, 1
  s_lshl_b32 s16, s20, 2
  v_xor_b32 v16, s16, v14
  v_lshl_add_u32 v7, v16, 4, v13
  v_xor_b32 v8, 8, v7
  s_lshl_b32 s16, s21, 2
  v_xor_b32 v16, s16, v14
  v_lshl_add_u32 v9, v16, 4, v13
  v_xor_b32 v10, 8, v9
  v_mov_b32 v176, 0x3f803f80
  v_mov_b32 v177, 0x3f803f80
  v_mov_b32 v178, 0x3f803f80
  v_mov_b32 v179, 0x3f803f80
  s_barrier
  ds_read_b128 v[144:147], v3 offset:0
  ds_read_b64_tr_b16 v[112:113], v7 offset:0
  ds_read_b64_tr_b16 v[114:115], v7 offset:1024
  ds_read_b128 v[148:151], v3 offset:2048
  ds_read_b64_tr_b16 v[116:117], v8 offset:0
  ds_read_b64_tr_b16 v[118:119], v8 offset:1024
  ds_read_b128 v[152:155], v4 offset:0
  ds_read_b64_tr_b16 v[120:121], v9 offset:0
  ds_read_b64_tr_b16 v[122:123], v9 offset:1024
  ds_read_b128 v[156:159], v4 offset:2048
  ds_read_b64_tr_b16 v[124:125], v10 offset:0
  ds_read_b64_tr_b16 v[126:127], v10 offset:1024
  s_waitcnt lgkmcnt(0)
  v_mfma_f32_16x16x32_bf16 v[24:27], v[112:115], v[144:147], 0
  ds_read_b128 v[160:163], v5 offset:0
  v_mfma_f32_16x16x32_bf16 v[28:31], v[112:115], v[148:151], 0
  ds_read_b64_tr_b16 v[128:129], v7 offset:8192
  v_mfma_f32_16x16x32_bf16 v[32:35], v[112:115], v[152:155], 0
  ds_read_b64_tr_b16 v[130:131], v7 offset:9216
  v_mfma_f32_16x16x32_bf16 v[36:39], v[112:115], v[156:159], 0
  ds_read_b128 v[164:167], v5 offset:2048
  v_mfma_f32_16x16x32_bf16 v[88:91], v[144:147], v[144:147], 0
  ds_read_b64_tr_b16 v[132:133], v8 offset:8192
  v_mfma_f32_16x16x32_bf16 v[96:99], v[176:179], v[144:147], 0
  ds_read_b64_tr_b16 v[134:135], v8 offset:9216
  v_mfma_f32_16x16x32_bf16 v[104:107], v[112:115], v[176:179], 0
  ds_read_b128 v[168:171], v6 offset:0
  v_mfma_f32_16x16x32_bf16 v[40:43], v[116:119], v[144:147], 0
  ds_read_b64_tr_b16 v[136:137], v9 offset:8192
  v_mfma_f32_16x16x32_bf16 v[44:47], v[116:119], v[148:151], 0
  ds_read_b64_tr_b16 v[138:139], v9 offset:9216
  v_mfma_f32_16x16x32_bf16 v[48:51], v[116:119], v[152:155], 0
  ds_read_b128 v[172:175], v6 offset:2048
  v_mfma_f32_16x16x32_bf16 v[52:55], v[116:119], v[156:159], 0
  ds_read_b64_tr_b16 v[140:141], v10 offset:8192
  v_mfma_f32_16x16x32_bf16 v[92:95], v[148:151], v[148:151], 0
  ds_read_b64_tr_b16 v[142:143], v10 offset:9216
  v_mfma_f32_16x16x32_bf16 v[100:103], v[176:179], v[148:151], 0
  v_mfma_f32_16x16x32_bf16 v[108:111], v[116:119], v[176:179], 0
  v_mfma_f32_16x16x32_bf16 v[56:59], v[120:123], v[144:147], 0
  v_mfma_f32_16x16x32_bf16 v[60:63], v[120:123], v[148:151], 0
  v_mfma_f32_16x16x32_bf16 v[64:67], v[120:123], v[152:155], 0
  v_mfma_f32_16x16x32_bf16 v[68:71], v[120:123], v[156:159], 0
  v_mfma_f32_16x16x32_bf16 v[72:75], v[124:127], v[144:147], 0
  v_mfma_f32_16x16x32_bf16 v[76:79], v[124:127], v[148:151], 0
  v_mfma_f32_16x16x32_bf16 v[80:83], v[124:127], v[152:155], 0
  v_mfma_f32_16x16x32_bf16 v[84:87], v[124:127], v[156:159], 0
  s_waitcnt lgkmcnt(0)
  s_barrier
  v_mfma_f32_16x16x32_bf16 v[24:27], v[128:131], v[160:163], v[24:27]
  ds_read_b128 v[144:147], v3 offset:16384
  v_mfma_f32_16x16x32_bf16 v[28:31], v[128:131], v[164:167], v[28:31]
  ds_read_b64_tr_b16 v[112:113], v7 offset:16384
  v_mfma_f32_16x16x32_bf16 v[32:35], v[128:131], v[168:171], v[32:35]
  ds_read_b64_tr_b16 v[114:115], v7 offset:17408
  v_mfma_f32_16x16x32_bf16 v[36:39], v[128:131], v[172:175], v[36:39]
  ds_read_b128 v[148:151], v3 offset:18432
  v_mfma_f32_16x16x32_bf16 v[88:91], v[160:163], v[160:163], v[88:91]
  ds_read_b64_tr_b16 v[116:117], v8 offset:16384
  v_mfma_f32_16x16x32_bf16 v[96:99], v[176:179], v[160:163], v[96:99]
  ds_read_b64_tr_b16 v[118:119], v8 offset:17408
  v_mfma_f32_16x16x32_bf16 v[104:107], v[128:131], v[176:179], v[104:107]
  ds_read_b128 v[152:155], v4 offset:16384
  v_mfma_f32_16x16x32_bf16 v[40:43], v[132:135], v[160:163], v[40:43]
  ds_read_b64_tr_b16 v[120:121], v9 offset:16384
  v_mfma_f32_16x16x32_bf16 v[44:47], v[132:135], v[164:167], v[44:47]
  ds_read_b64_tr_b16 v[122:123], v9 offset:17408
  v_mfma_f32_16x16x32_bf16 v[48:51], v[132:135], v[168:171], v[48:51]
  ds_read_b128 v[156:159], v4 offset:18432
  v_mfma_f32_16x16x32_bf16 v[52:55], v[132:135], v[172:175], v[52:55]
  ds_read_b64_tr_b16 v[124:125], v10 offset:16384
  v_mfma_f32_16x16x32_bf16 v[92:95], v[164:167], v[164:167], v[92:95]
  ds_read_b64_tr_b16 v[126:127], v10 offset:17408
  v_mfma_f32_16x16x32_bf16 v[100:103], v[176:179], v[164:167], v[100:103]
  v_mfma_f32_16x16x32_bf16 v[108:111], v[132:135], v[176:179], v[108:111]
  v_mfma_f32_16x16x32_bf16 v[56:59], v[136:139], v[160:163], v[56:59]
  v_mfma_f32_16x16x32_bf16 v[60:63], v[136:139], v[164:167], v[60:63]
  v_mfma_f32_16x16x32_bf16 v[64:67], v[136:139], v[168:171], v[64:67]
  v_mfma_f32_16x16x32_bf16 v[68:71], v[136:139], v[172:175], v[68:71]
  v_mfma_f32_16x16x32_bf16 v[72:75], v[140:143], v[160:163], v[72:75]
  v_mfma_f32_16x16x32_bf16 v[76:79], v[140:143], v[164:167], v[76:79]
  v_mfma_f32_16x16x32_bf16 v[80:83], v[140:143], v[168:171], v[80:83]
  v_mfma_f32_16x16x32_bf16 v[84:87], v[140:143], v[172:175], v[84:87]
  s_waitcnt lgkmcnt(9)
  v_mfma_f32_16x16x32_bf16 v[24:27], v[112:115], v[144:147], v[24:27]
  ds_read_b128 v[160:163], v5 offset:16384
  s_waitcnt lgkmcnt(9)
  v_mfma_f32_16x16x32_bf16 v[28:31], v[112:115], v[148:151], v[28:31]
  ds_read_b64_tr_b16 v[128:129], v7 offset:24576
  s_waitcnt lgkmcnt(7)
  v_mfma_f32_16x16x32_bf16 v[32:35], v[112:115], v[152:155], v[32:35]
  ds_read_b64_tr_b16 v[130:131], v7 offset:25600
  s_waitcnt lgkmcnt(5)
  v_mfma_f32_16x16x32_bf16 v[36:39], v[112:115], v[156:159], v[36:39]
  ds_read_b128 v[164:167], v5 offset:18432
  v_mfma_f32_16x16x32_bf16 v[88:91], v[144:147], v[144:147], v[88:91]
  ds_read_b64_tr_b16 v[132:133], v8 offset:24576
  v_mfma_f32_16x16x32_bf16 v[96:99], v[176:179], v[144:147], v[96:99]
  ds_read_b64_tr_b16 v[134:135], v8 offset:25600
  v_mfma_f32_16x16x32_bf16 v[104:107], v[112:115], v[176:179], v[104:107]
  ds_read_b128 v[168:171], v6 offset:16384
  v_mfma_f32_16x16x32_bf16 v[40:43], v[116:119], v[144:147], v[40:43]
  ds_read_b64_tr_b16 v[136:137], v9 offset:24576
  v_mfma_f32_16x16x32_bf16 v[44:47], v[116:119], v[148:151], v[44:47]
  ds_read_b64_tr_b16 v[138:139], v9 offset:25600
  v_mfma_f32_16x16x32_bf16 v[48:51], v[116:119], v[152:155], v[48:51]
  ds_read_b128 v[172:175], v6 offset:18432
  v_mfma_f32_16x16x32_bf16 v[52:55], v[116:119], v[156:159], v[52:55]
  ds_read_b64_tr_b16 v[140:141], v10 offset:24576
  v_mfma_f32_16x16x32_bf16 v[92:95], v[148:151], v[148:151], v[92:95]
  ds_read_b64_tr_b16 v[142:143], v10 offset:25600
  v_mfma_f32_16x16x32_bf16 v[100:103], v[176:179], v[148:151], v[100:103]
  v_mfma_f32_16x16x32_bf16 v[108:111], v[116:119], v[176:179], v[108:111]
  v_mfma_f32_16x16x32_bf16 v[56:59], v[120:123], v[144:147], v[56:59]
  v_mfma_f32_16x16x32_bf16 v[60:63], v[120:123], v[148:151], v[60:63]
  v_mfma_f32_16x16x32_bf16 v[64:67], v[120:123], v[152:155], v[64:67]
  v_mfma_f32_16x16x32_bf16 v[68:71], v[120:123], v[156:159], v[68:71]
  s_waitcnt lgkmcnt(12)
  v_mfma_f32_16x16x32_bf16 v[72:75], v[124:127], v[144:147], v[72:75]
  v_mfma_f32_16x16x32_bf16 v[76:79], v[124:127], v[148:151], v[76:79]
  v_mfma_f32_16x16x32_bf16 v[80:83], v[124:127], v[152:155], v[80:83]
  v_mfma_f32_16x16x32_bf16 v[84:87], v[124:127], v[156:159], v[84:87]
  s_waitcnt lgkmcnt(0)
  s_barrier
  v_mfma_f32_16x16x32_bf16 v[24:27], v[128:131], v[160:163], v[24:27]
  ds_read_b128 v[144:147], v3 offset:32768
  v_mfma_f32_16x16x32_bf16 v[28:31], v[128:131], v[164:167], v[28:31]
  ds_read_b64_tr_b16 v[112:113], v7 offset:32768
  v_mfma_f32_16x16x32_bf16 v[32:35], v[128:131], v[168:171], v[32:35]
  ds_read_b64_tr_b16 v[114:115], v7 offset:33792
  v_mfma_f32_16x16x32_bf16 v[36:39], v[128:131], v[172:175], v[36:39]
  ds_read_b128 v[148:151], v3 offset:34816
  v_mfma_f32_16x16x32_bf16 v[88:91], v[160:163], v[160:163], v[88:91]
  ds_read_b64_tr_b16 v[116:117], v8 offset:32768
  v_mfma_f32_16x16x32_bf16 v[96:99], v[176:179], v[160:163], v[96:99]
  ds_read_b64_tr_b16 v[118:119], v8 offset:33792
  v_mfma_f32_16x16x32_bf16 v[104:107], v[128:131], v[176:179], v[104:107]
  ds_read_b128 v[152:155], v4 offset:32768
  v_mfma_f32_16x16x32_bf16 v[40:43], v[132:135], v[160:163], v[40:43]
  ds_read_b64_tr_b16 v[120:121], v9 offset:32768
  v_mfma_f32_16x16x32_bf16 v[44:47], v[132:135], v[164:167], v[44:47]
  ds_read_b64_tr_b16 v[122:123], v9 offset:33792
  v_mfma_f32_16x16x32_bf16 v[48:51], v[132:135], v[168:171], v[48:51]
  ds_read_b128 v[156:159], v4 offset:34816
  v_mfma_f32_16x16x32_bf16 v[52:55], v[132:135], v[172:175], v[52:55]
  ds_read_b64_tr_b16 v[124:125], v10 offset:32768
  v_mfma_f32_16x16x32_bf16 v[92:95], v[164:167], v[164:167], v[92:95]
  ds_read_b64_tr_b16 v[126:127], v10 offset:33792
  v_mfma_f32_16x16x32_bf16 v[100:103], v[176:179], v[164:167], v[100:103]
  v_mfma_f32_16x16x32_bf16 v[108:111], v[132:135], v[176:179], v[108:111]
  v_mfma_f32_16x16x32_bf16 v[56:59], v[136:139], v[160:163], v[56:59]
  v_mfma_f32_16x16x32_bf16 v[60:63], v[136:139], v[164:167], v[60:63]
  v_mfma_f32_16x16x32_bf16 v[64:67], v[136:139], v[168:171], v[64:67]
  v_mfma_f32_16x16x32_bf16 v[68:71], v[136:139], v[172:175], v[68:71]
  v_mfma_f32_16x16x32_bf16 v[72:75], v[140:143], v[160:163], v[72:75]
  v_mfma_f32_16x16x32_bf16 v[76:79], v[140:143], v[164:167], v[76:79]
  v_mfma_f32_16x16x32_bf16 v[80:83], v[140:143], v[168:171], v[80:83]
  v_mfma_f32_16x16x32_bf16 v[84:87], v[140:143], v[172:175], v[84:87]
  s_waitcnt lgkmcnt(9)
  v_mfma_f32_16x16x32_bf16 v[24:27], v[112:115], v[144:147], v[24:27]
  ds_read_b128 v[160:163], v5 offset:32768
  s_waitcnt lgkmcnt(9)
  v_mfma_f32_16x16x32_bf16 v[28:31], v[112:115], v[148:151], v[28:31]
  ds_read_b64_tr_b16 v[128:129], v7 offset:40960
  s_waitcnt lgkmcnt(7)
  v_mfma_f32_16x16x32_bf16 v[32:35], v[112:115], v[152:155], v[32:35]
  ds_read_b64_tr_b16 v[130:131], v7 offset:41984
  s_waitcnt lgkmcnt(5)
  v_mfma_f32_16x16x32_bf16 v[36:39], v[112:115], v[156:159], v[36:39]
  ds_read_b128 v[164:167], v5 offset:34816
  v_mfma_f32_16x16x32_bf16 v[88:91], v[144:147], v[144:147], v[88:91]
  ds_read_b64_tr_b16 v[132:133], v8 offset:40960
  v_mfma_f32_16x16x32_bf16 v[96:99], v[176:179], v[144:147], v[96:99]
  ds_read_b64_tr_b16 v[134:135], v8 offset:41984
  v_mfma_f32_16x16x32_bf16 v[104:107], v[112:115], v[176:179], v[104:107]
  ds_read_b128 v[168:171], v6 offset:32768
  v_mfma_f32_16x16x32_bf16 v[40:43], v[116:119], v[144:147], v[40:43]
  ds_read_b64_tr_b16 v[136:137], v9 offset:40960
  v_mfma_f32_16x16x32_bf16 v[44:47], v[116:119], v[148:151], v[44:47]
  ds_read_b64_tr_b16 v[138:139], v9 offset:41984
  v_mfma_f32_16x16x32_bf16 v[48:51], v[116:119], v[152:155], v[48:51]
  ds_read_b128 v[172:175], v6 offset:34816
  v_mfma_f32_16x16x32_bf16 v[52:55], v[116:119], v[156:159], v[52:55]
  ds_read_b64_tr_b16 v[140:141], v10 offset:40960
  v_mfma_f32_16x16x32_bf16 v[92:95], v[148:151], v[148:151], v[92:95]
  ds_read_b64_tr_b16 v[142:143], v10 offset:41984
  v_mfma_f32_16x16x32_bf16 v[100:103], v[176:179], v[148:151], v[100:103]
  v_mfma_f32_16x16x32_bf16 v[108:111], v[116:119], v[176:179], v[108:111]
  v_mfma_f32_16x16x32_bf16 v[56:59], v[120:123], v[144:147], v[56:59]
  v_mfma_f32_16x16x32_bf16 v[60:63], v[120:123], v[148:151], v[60:63]
  v_mfma_f32_16x16x32_bf16 v[64:67], v[120:123], v[152:155], v[64:67]
  v_mfma_f32_16x16x32_bf16 v[68:71], v[120:123], v[156:159], v[68:71]
  s_waitcnt lgkmcnt(12)
  v_mfma_f32_16x16x32_bf16 v[72:75], v[124:127], v[144:147], v[72:75]
  v_mfma_f32_16x16x32_bf16 v[76:79], v[124:127], v[148:151], v[76:79]
  v_mfma_f32_16x16x32_bf16 v[80:83], v[124:127], v[152:155], v[80:83]
  v_mfma_f32_16x16x32_bf16 v[84:87], v[124:127], v[156:159], v[84:87]
  s_waitcnt lgkmcnt(0)
  s_barrier
  v_mfma_f32_16x16x32_bf16 v[24:27], v[128:131], v[160:163], v[24:27]
  ds_read_b128 v[144:147], v3 offset:49152
  v_mfma_f32_16x16x32_bf16 v[28:31], v[128:131], v[164:167], v[28:31]
  ds_read_b64_tr_b16 v[112:113], v7 offset:49152
  v_mfma_f32_16x16x32_bf16 v[32:35], v[128:131], v[168:171], v[32:35]
  ds_read_b64_tr_b16 v[114:115], v7 offset:50176
  v_mfma_f32_16x16x32_bf16 v[36:39], v[128:131], v[172:175], v[36:39]
  ds_read_b128 v[148:151], v3 offset:51200
  v_mfma_f32_16x16x32_bf16 v[88:91], v[160:163], v[160:163], v[88:91]
  ds_read_b64_tr_b16 v[116:117], v8 offset:49152
  v_mfma_f32_16x16x32_bf16 v[96:99], v[176:179], v[160:163], v[96:99]
  ds_read_b64_tr_b16 v[118:119], v8 offset:50176
  v_mfma_f32_16x16x32_bf16 v[104:107], v[128:131], v[176:179], v[104:107]
  ds_read_b128 v[152:155], v4 offset:49152
  v_mfma_f32_16x16x32_bf16 v[40:43], v[132:135], v[160:163], v[40:43]
  ds_read_b64_tr_b16 v[120:121], v9 offset:49152
  v_mfma_f32_16x16x32_bf16 v[44:47], v[132:135], v[164:167], v[44:47]
  ds_read_b64_tr_b16 v[122:123], v9 offset:50176
  v_mfma_f32_16x16x32_bf16 v[48:51], v[132:135], v[168:171], v[48:51]
  ds_read_b128 v[156:159], v4 offset:51200
  v_mfma_f32_16x16x32_bf16 v[52:55], v[132:135], v[172:175], v[52:55]
  ds_read_b64_tr_b16 v[124:125], v10 offset:49152
  v_mfma_f32_16x16x32_bf16 v[92:95], v[164:167], v[164:167], v[92:95]
  ds_read_b64_tr_b16 v[126:127], v10 offset:50176
  v_mfma_f32_16x16x32_bf16 v[100:103], v[176:179], v[164:167], v[100:103]
  v_mfma_f32_16x16x32_bf16 v[108:111], v[132:135], v[176:179], v[108:111]
  v_mfma_f32_16x16x32_bf16 v[56:59], v[136:139], v[160:163], v[56:59]
  v_mfma_f32_16x16x32_bf16 v[60:63], v[136:139], v[164:167], v[60:63]
  v_mfma_f32_16x16x32_bf16 v[64:67], v[136:139], v[168:171], v[64:67]
  v_mfma_f32_16x16x32_bf16 v[68:71], v[136:139], v[172:175], v[68:71]
  v_mfma_f32_16x16x32_bf16 v[72:75], v[140:143], v[160:163], v[72:75]
  v_mfma_f32_16x16x32_bf16 v[76:79], v[140:143], v[164:167], v[76:79]
  v_mfma_f32_16x16x32_bf16 v[80:83], v[140:143], v[168:171], v[80:83]
  v_mfma_f32_16x16x32_bf16 v[84:87], v[140:143], v[172:175], v[84:87]
  s_waitcnt lgkmcnt(9)
  v_mfma_f32_16x16x32_bf16 v[24:27], v[112:115], v[144:147], v[24:27]
  ds_read_b128 v[160:163], v5 offset:49152
  s_waitcnt lgkmcnt(9)
  v_mfma_f32_16x16x32_bf16 v[28:31], v[112:115], v[148:151], v[28:31]
  ds_read_b64_tr_b16 v[128:129], v7 offset:57344
  s_waitcnt lgkmcnt(7)
  v_mfma_f32_16x16x32_bf16 v[32:35], v[112:115], v[152:155], v[32:35]
  ds_read_b64_tr_b16 v[130:131], v7 offset:58368
  s_waitcnt lgkmcnt(5)
  v_mfma_f32_16x16x32_bf16 v[36:39], v[112:115], v[156:159], v[36:39]
  ds_read_b128 v[164:167], v5 offset:51200
  v_mfma_f32_16x16x32_bf16 v[88:91], v[144:147], v[144:147], v[88:91]
  ds_read_b64_tr_b16 v[132:133], v8 offset:57344
  v_mfma_f32_16x16x32_bf16 v[96:99], v[176:179], v[144:147], v[96:99]
  ds_read_b64_tr_b16 v[134:135], v8 offset:58368
  v_mfma_f32_16x16x32_bf16 v[104:107], v[112:115], v[176:179], v[104:107]
  ds_read_b128 v[168:171], v6 offset:49152
  v_mfma_f32_16x16x32_bf16 v[40:43], v[116:119], v[144:147], v[40:43]
  ds_read_b64_tr_b16 v[136:137], v9 offset:57344
  v_mfma_f32_16x16x32_bf16 v[44:47], v[116:119], v[148:151], v[44:47]
  ds_read_b64_tr_b16 v[138:139], v9 offset:58368
  v_mfma_f32_16x16x32_bf16 v[48:51], v[116:119], v[152:155], v[48:51]
  ds_read_b128 v[172:175], v6 offset:51200
  v_mfma_f32_16x16x32_bf16 v[52:55], v[116:119], v[156:159], v[52:55]
  ds_read_b64_tr_b16 v[140:141], v10 offset:57344
  v_mfma_f32_16x16x32_bf16 v[92:95], v[148:151], v[148:151], v[92:95]
  ds_read_b64_tr_b16 v[142:143], v10 offset:58368
  v_mfma_f32_16x16x32_bf16 v[100:103], v[176:179], v[148:151], v[100:103]
  v_mfma_f32_16x16x32_bf16 v[108:111], v[116:119], v[176:179], v[108:111]
  v_mfma_f32_16x16x32_bf16 v[56:59], v[120:123], v[144:147], v[56:59]
  v_mfma_f32_16x16x32_bf16 v[60:63], v[120:123], v[148:151], v[60:63]
  v_mfma_f32_16x16x32_bf16 v[64:67], v[120:123], v[152:155], v[64:67]
  v_mfma_f32_16x16x32_bf16 v[68:71], v[120:123], v[156:159], v[68:71]
  s_waitcnt lgkmcnt(12)
  v_mfma_f32_16x16x32_bf16 v[72:75], v[124:127], v[144:147], v[72:75]
  v_mfma_f32_16x16x32_bf16 v[76:79], v[124:127], v[148:151], v[76:79]
  v_mfma_f32_16x16x32_bf16 v[80:83], v[124:127], v[152:155], v[80:83]
  v_mfma_f32_16x16x32_bf16 v[84:87], v[124:127], v[156:159], v[84:87]
  s_waitcnt lgkmcnt(0)
  s_barrier
  v_mfma_f32_16x16x32_bf16 v[24:27], v[128:131], v[160:163], v[24:27]
  ds_read_b128 v[144:147], v3 offset:0
  v_mfma_f32_16x16x32_bf16 v[28:31], v[128:131], v[164:167], v[28:31]
  ds_read_b64_tr_b16 v[112:113], v7 offset:0
  v_mfma_f32_16x16x32_bf16 v[32:35], v[128:131], v[168:171], v[32:35]
  ds_read_b64_tr_b16 v[114:115], v7 offset:1024
  v_mfma_f32_16x16x32_bf16 v[36:39], v[128:131], v[172:175], v[36:39]
  ds_read_b128 v[148:151], v3 offset:2048
  v_mfma_f32_16x16x32_bf16 v[88:91], v[160:163], v[160:163], v[88:91]
  ds_read_b64_tr_b16 v[116:117], v8 offset:0
  v_mfma_f32_16x16x32_bf16 v[96:99], v[176:179], v[160:163], v[96:99]
  ds_read_b64_tr_b16 v[118:119], v8 offset:1024
  v_mfma_f32_16x16x32_bf16 v[104:107], v[128:131], v[176:179], v[104:107]
  ds_read_b128 v[152:155], v4 offset:0
  v_mfma_f32_16x16x32_bf16 v[40:43], v[132:135], v[160:163], v[40:43]
  ds_read_b64_tr_b16 v[120:121], v9 offset:0
  v_mfma_f32_16x16x32_bf16 v[44:47], v[132:135], v[164:167], v[44:47]
  ds_read_b64_tr_b16 v[122:123], v9 offset:1024
  v_mfma_f32_16x16x32_bf16 v[48:51], v[132:135], v[168:171], v[48:51]
  ds_read_b128 v[156:159], v4 offset:2048
  v_mfma_f32_16x16x32_bf16 v[52:55], v[132:135], v[172:175], v[52:55]
  ds_read_b64_tr_b16 v[124:125], v10 offset:0
  v_mfma_f32_16x16x32_bf16 v[92:95], v[164:167], v[164:167], v[92:95]
  ds_read_b64_tr_b16 v[126:127], v10 offset:1024
  v_mfma_f32_16x16x32_bf16 v[100:103], v[176:179], v[164:167], v[100:103]
  v_mfma_f32_16x16x32_bf16 v[108:111], v[132:135], v[176:179], v[108:111]
  v_mfma_f32_16x16x32_bf16 v[56:59], v[136:139], v[160:163], v[56:59]
  v_mfma_f32_16x16x32_bf16 v[60:63], v[136:139], v[164:167], v[60:63]
  v_mfma_f32_16x16x32_bf16 v[64:67], v[136:139], v[168:171], v[64:67]
  v_mfma_f32_16x16x32_bf16 v[68:71], v[136:139], v[172:175], v[68:71]
  v_mfma_f32_16x16x32_bf16 v[72:75], v[140:143], v[160:163], v[72:75]
  v_mfma_f32_16x16x32_bf16 v[76:79], v[140:143], v[164:167], v[76:79]
  v_mfma_f32_16x16x32_bf16 v[80:83], v[140:143], v[168:171], v[80:83]
  v_mfma_f32_16x16x32_bf16 v[84:87], v[140:143], v[172:175], v[84:87]
  s_waitcnt lgkmcnt(9)
  v_mfma_f32_16x16x32_bf16 v[24:27], v[112:115], v[144:147], v[24:27]
  ds_read_b128 v[160:163], v5 offset:0
  s_waitcnt lgkmcnt(9)
  v_mfma_f32_16x16x32_bf16 v[28:31], v[112:115], v[148:151], v[28:31]
  ds_read_b64_tr_b16 v[128:129], v7 offset:8192
  s_waitcnt lgkmcnt(7)
  v_mfma_f32_16x16x32_bf16 v[32:35], v[112:115], v[152:155], v[32:35]
  ds_read_b64_tr_b16 v[130:131], v7 offset:9216
  s_waitcnt lgkmcnt(5)
  v_mfma_f32_16x16x32_bf16 v[36:39], v[112:115], v[156:159], v[36:39]
  ds_read_b128 v[164:167], v5 offset:2048
  v_mfma_f32_16x16x32_bf16 v[88:91], v[144:147], v[144:147], v[88:91]
  ds_read_b64_tr_b16 v[132:133], v8 offset:8192
  v_mfma_f32_16x16x32_bf16 v[96:99], v[176:179], v[144:147], v[96:99]
  ds_read_b64_tr_b16 v[134:135], v8 offset:9216
  v_mfma_f32_16x16x32_bf16 v[104:107], v[112:115], v[176:179], v[104:107]
  ds_read_b128 v[168:171], v6 offset:0
  v_mfma_f32_16x16x32_bf16 v[40:43], v[116:119], v[144:147], v[40:43]
  ds_read_b64_tr_b16 v[136:137], v9 offset:8192
  v_mfma_f32_16x16x32_bf16 v[44:47], v[116:119], v[148:151], v[44:47]
  ds_read_b64_tr_b16 v[138:139], v9 offset:9216
  v_mfma_f32_16x16x32_bf16 v[48:51], v[116:119], v[152:155], v[48:51]
  ds_read_b128 v[172:175], v6 offset:2048
  v_mfma_f32_16x16x32_bf16 v[52:55], v[116:119], v[156:159], v[52:55]
  ds_read_b64_tr_b16 v[140:141], v10 offset:8192
  v_mfma_f32_16x16x32_bf16 v[92:95], v[148:151], v[148:151], v[92:95]
  ds_read_b64_tr_b16 v[142:143], v10 offset:9216
  v_mfma_f32_16x16x32_bf16 v[100:103], v[176:179], v[148:151], v[100:103]
  v_mfma_f32_16x16x32_bf16 v[108:111], v[116:119], v[176:179], v[108:111]
  v_mfma_f32_16x16x32_bf16 v[56:59], v[120:123], v[144:147], v[56:59]
  v_mfma_f32_16x16x32_bf16 v[60:63], v[120:123], v[148:151], v[60:63]
  v_mfma_f32_16x16x32_bf16 v[64:67], v[120:123], v[152:155], v[64:67]
  v_mfma_f32_16x16x32_bf16 v[68:71], v[120:123], v[156:159], v[68:71]
  s_waitcnt lgkmcnt(12)
  v_mfma_f32_16x16x32_bf16 v[72:75], v[124:127], v[144:147], v[72:75]
  v_mfma_f32_16x16x32_bf16 v[76:79], v[124:127], v[148:151], v[76:79]
  v_mfma_f32_16x16x32_bf16 v[80:83], v[124:127], v[152:155], v[80:83]
  v_mfma_f32_16x16x32_bf16 v[84:87], v[124:127], v[156:159], v[84:87]
  s_waitcnt lgkmcnt(0)
  s_barrier
  v_mfma_f32_16x16x32_bf16 v[24:27], v[128:131], v[160:163], v[24:27]
  ds_read_b128 v[144:147], v3 offset:16384
  v_mfma_f32_16x16x32_bf16 v[28:31], v[128:131], v[164:167], v[28:31]
  ds_read_b64_tr_b16 v[112:113], v7 offset:16384
  v_mfma_f32_16x16x32_bf16 v[32:35], v[128:131], v[168:171], v[32:35]
  ds_read_b64_tr_b16 v[114:115], v7 offset:17408
  v_mfma_f32_16x16x32_bf16 v[36:39], v[128:131], v[172:175], v[36:39]
  ds_read_b128 v[148:151], v3 offset:18432
  v_mfma_f32_16x16x32_bf16 v[88:91], v[160:163], v[160:163], v[88:91]
  ds_read_b64_tr_b16 v[116:117], v8 offset:16384
  v_mfma_f32_16x16x32_bf16 v[96:99], v[176:179], v[160:163], v[96:99]
  ds_read_b64_tr_b16 v[118:119], v8 offset:17408
  v_mfma_f32_16x16x32_bf16 v[104:107], v[128:131], v[176:179], v[104:107]
  ds_read_b128 v[152:155], v4 offset:16384
  v_mfma_f32_16x16x32_bf16 v[40:43], v[132:135], v[160:163], v[40:43]
  ds_read_b64_tr_b16 v[120:121], v9 offset:16384
  v_mfma_f32_16x16x32_bf16 v[44:47], v[132:135], v[164:167], v[44:47]
  ds_read_b64_tr_b16 v[122:123], v9 offset:17408
  v_mfma_f32_16x16x32_bf16 v[48:51], v[132:135], v[168:171], v[48:51]
  ds_read_b128 v[156:159], v4 offset:18432
  v_mfma_f32_16x16x32_bf16 v[52:55], v[132:135], v[172:175], v[52:55]
  ds_read_b64_tr_b16 v[124:125], v10 offset:16384
  v_mfma_f32_16x16x32_bf16 v[92:95], v[164:167], v[164:167], v[92:95]
  ds_read_b64_tr_b16 v[126:127], v10 offset:17408
  v_mfma_f32_16x16x32_bf16 v[100:103], v[176:179], v[164:167], v[100:103]
  v_mfma_f32_16x16x32_bf16 v[108:111], v[132:135], v[176:179], v[108:111]
  v_mfma_f32_16x16x32_bf16 v[56:59], v[136:139], v[160:163], v[56:59]
  v_mfma_f32_16x16x32_bf16 v[60:63], v[136:139], v[164:167], v[60:63]
  v_mfma_f32_16x16x32_bf16 v[64:67], v[136:139], v[168:171], v[64:67]
  v_mfma_f32_16x16x32_bf16 v[68:71], v[136:139], v[172:175], v[68:71]
  v_mfma_f32_16x16x32_bf16 v[72:75], v[140:143], v[160:163], v[72:75]
  v_mfma_f32_16x16x32_bf16 v[76:79], v[140:143], v[164:167], v[76:79]
  v_mfma_f32_16x16x32_bf16 v[80:83], v[140:143], v[168:171], v[80:83]
  v_mfma_f32_16x16x32_bf16 v[84:87], v[140:143], v[172:175], v[84:87]
  s_waitcnt lgkmcnt(9)
  v_mfma_f32_16x16x32_bf16 v[24:27], v[112:115], v[144:147], v[24:27]
  ds_read_b128 v[160:163], v5 offset:16384
  s_waitcnt lgkmcnt(9)
  v_mfma_f32_16x16x32_bf16 v[28:31], v[112:115], v[148:151], v[28:31]
  ds_read_b64_tr_b16 v[128:129], v7 offset:24576
  s_waitcnt lgkmcnt(7)
  v_mfma_f32_16x16x32_bf16 v[32:35], v[112:115], v[152:155], v[32:35]
  ds_read_b64_tr_b16 v[130:131], v7 offset:25600
  s_waitcnt lgkmcnt(5)
  v_mfma_f32_16x16x32_bf16 v[36:39], v[112:115], v[156:159], v[36:39]
  ds_read_b128 v[164:167], v5 offset:18432
  v_mfma_f32_16x16x32_bf16 v[88:91], v[144:147], v[144:147], v[88:91]
  ds_read_b64_tr_b16 v[132:133], v8 offset:24576
  v_mfma_f32_16x16x32_bf16 v[96:99], v[176:179], v[144:147], v[96:99]
  ds_read_b64_tr_b16 v[134:135], v8 offset:25600
  v_mfma_f32_16x16x32_bf16 v[104:107], v[112:115], v[176:179], v[104:107]
  ds_read_b128 v[168:171], v6 offset:16384
  v_mfma_f32_16x16x32_bf16 v[40:43], v[116:119], v[144:147], v[40:43]
  ds_read_b64_tr_b16 v[136:137], v9 offset:24576
  v_mfma_f32_16x16x32_bf16 v[44:47], v[116:119], v[148:151], v[44:47]
  ds_read_b64_tr_b16 v[138:139], v9 offset:25600
  v_mfma_f32_16x16x32_bf16 v[48:51], v[116:119], v[152:155], v[48:51]
  ds_read_b128 v[172:175], v6 offset:18432
  v_mfma_f32_16x16x32_bf16 v[52:55], v[116:119], v[156:159], v[52:55]
  ds_read_b64_tr_b16 v[140:141], v10 offset:24576
  v_mfma_f32_16x16x32_bf16 v[92:95], v[148:151], v[148:151], v[92:95]
  ds_read_b64_tr_b16 v[142:143], v10 offset:25600
  v_mfma_f32_16x16x32_bf16 v[100:103], v[176:179], v[148:151], v[100:103]
  v_mfma_f32_16x16x32_bf16 v[108:111], v[116:119], v[176:179], v[108:111]
  v_mfma_f32_16x16x32_bf16 v[56:59], v[120:123], v[144:147], v[56:59]
  v_mfma_f32_16x16x32_bf16 v[60:63], v[120:123], v[148:151], v[60:63]
  v_mfma_f32_16x16x32_bf16 v[64:67], v[120:123], v[152:155], v[64:67]
  v_mfma_f32_16x16x32_bf16 v[68:71], v[120:123], v[156:159], v[68:71]
  s_waitcnt lgkmcnt(12)
  v_mfma_f32_16x16x32_bf16 v[72:75], v[124:127], v[144:147], v[72:75]
  v_mfma_f32_16x16x32_bf16 v[76:79], v[124:127], v[148:151], v[76:79]
  v_mfma_f32_16x16x32_bf16 v[80:83], v[124:127], v[152:155], v[80:83]
  v_mfma_f32_16x16x32_bf16 v[84:87], v[124:127], v[156:159], v[84:87]
  s_waitcnt lgkmcnt(0)
  s_barrier
  v_mfma_f32_16x16x32_bf16 v[24:27], v[128:131], v[160:163], v[24:27]
  ds_read_b128 v[144:147], v3 offset:32768
  v_mfma_f32_16x16x32_bf16 v[28:31], v[128:131], v[164:167], v[28:31]
  ds_read_b64_tr_b16 v[112:113], v7 offset:32768
  v_mfma_f32_16x16x32_bf16 v[32:35], v[128:131], v[168:171], v[32:35]
  ds_read_b64_tr_b16 v[114:115], v7 offset:33792
  v_mfma_f32_16x16x32_bf16 v[36:39], v[128:131], v[172:175], v[36:39]
  ds_read_b128 v[148:151], v3 offset:34816
  v_mfma_f32_16x16x32_bf16 v[88:91], v[160:163], v[160:163], v[88:91]
  ds_read_b64_tr_b16 v[116:117], v8 offset:32768
  v_mfma_f32_16x16x32_bf16 v[96:99], v[176:179], v[160:163], v[96:99]
  ds_read_b64_tr_b16 v[118:119], v8 offset:33792
  v_mfma_f32_16x16x32_bf16 v[104:107], v[128:131], v[176:179], v[104:107]
  ds_read_b128 v[152:155], v4 offset:32768
  v_mfma_f32_16x16x32_bf16 v[40:43], v[132:135], v[160:163], v[40:43]
  ds_read_b64_tr_b16 v[120:121], v9 offset:32768
  v_mfma_f32_16x16x32_bf16 v[44:47], v[132:135], v[164:167], v[44:47]
  ds_read_b64_tr_b16 v[122:123], v9 offset:33792
  v_mfma_f32_16x16x32_bf16 v[48:51], v[132:135], v[168:171], v[48:51]
  ds_read_b128 v[156:159], v4 offset:34816
  v_mfma_f32_16x16x32_bf16 v[52:55], v[132:135], v[172:175], v[52:55]
  ds_read_b64_tr_b16 v[124:125], v10 offset:32768
  v_mfma_f32_16x16x32_bf16 v[92:95], v[164:167], v[164:167], v[92:95]
  ds_read_b64_tr_b16 v[126:127], v10 offset:33792
  v_mfma_f32_16x16x32_bf16 v[100:103], v[176:179], v[164:167], v[100:103]
  v_mfma_f32_16x16x32_bf16 v[108:111], v[132:135], v[176:179], v[108:111]
  v_mfma_f32_16x16x32_bf16 v[56:59], v[136:139], v[160:163], v[56:59]
  v_mfma_f32_16x16x32_bf16 v[60:63], v[136:139], v[164:167], v[60:63]
  v_mfma_f32_16x16x32_bf16 v[64:67], v[136:139], v[168:171], v[64:67]
  v_mfma_f32_16x16x32_bf16 v[68:71], v[136:139], v[172:175], v[68:71]
  v_mfma_f32_16x16x32_bf16 v[72:75], v[140:143], v[160:163], v[72:75]
  v_mfma_f32_16x16x32_bf16 v[76:79], v[140:143], v[164:167], v[76:79]
  v_mfma_f32_16x16x32_bf16 v[80:83], v[140:143], v[168:171], v[80:83]
  v_mfma_f32_16x16x32_bf16 v[84:87], v[140:143], v[172:175], v[84:87]
  s_waitcnt lgkmcnt(9)
  v_mfma_f32_16x16x32_bf16 v[24:27], v[112:115], v[144:147], v[24:27]
  ds_read_b128 v[160:163], v5 offset:32768
  s_waitcnt lgkmcnt(9)
  v_mfma_f32_16x16x32_bf16 v[28:31], v[112:115], v[148:151], v[28:31]
  ds_read_b64_tr_b16 v[128:129], v7 offset:40960
  s_waitcnt lgkmcnt(7)
  v_mfma_f32_16x16x32_bf16 v[32:35], v[112:115], v[152:155], v[32:35]
  ds_read_b64_tr_b16 v[130:131], v7 offset:41984
  s_waitcnt lgkmcnt(5)
  v_mfma_f32_16x16x32_bf16 v[36:39], v[112:115], v[156:159], v[36:39]
  ds_read_b128 v[164:167], v5 offset:34816
  v_mfma_f32_16x16x32_bf16 v[88:91], v[144:147], v[144:147], v[88:91]
  ds_read_b64_tr_b16 v[132:133], v8 offset:40960
  v_mfma_f32_16x16x32_bf16 v[96:99], v[176:179], v[144:147], v[96:99]
  ds_read_b64_tr_b16 v[134:135], v8 offset:41984
  v_mfma_f32_16x16x32_bf16 v[104:107], v[112:115], v[176:179], v[104:107]
  ds_read_b128 v[168:171], v6 offset:32768
  v_mfma_f32_16x16x32_bf16 v[40:43], v[116:119], v[144:147], v[40:43]
  ds_read_b64_tr_b16 v[136:137], v9 offset:40960
  v_mfma_f32_16x16x32_bf16 v[44:47], v[116:119], v[148:151], v[44:47]
  ds_read_b64_tr_b16 v[138:139], v9 offset:41984
  v_mfma_f32_16x16x32_bf16 v[48:51], v[116:119], v[152:155], v[48:51]
  ds_read_b128 v[172:175], v6 offset:34816
  v_mfma_f32_16x16x32_bf16 v[52:55], v[116:119], v[156:159], v[52:55]
  ds_read_b64_tr_b16 v[140:141], v10 offset:40960
  v_mfma_f32_16x16x32_bf16 v[92:95], v[148:151], v[148:151], v[92:95]
  ds_read_b64_tr_b16 v[142:143], v10 offset:41984
  v_mfma_f32_16x16x32_bf16 v[100:103], v[176:179], v[148:151], v[100:103]
  v_mfma_f32_16x16x32_bf16 v[108:111], v[116:119], v[176:179], v[108:111]
  v_mfma_f32_16x16x32_bf16 v[56:59], v[120:123], v[144:147], v[56:59]
  v_mfma_f32_16x16x32_bf16 v[60:63], v[120:123], v[148:151], v[60:63]
  v_mfma_f32_16x16x32_bf16 v[64:67], v[120:123], v[152:155], v[64:67]
  v_mfma_f32_16x16x32_bf16 v[68:71], v[120:123], v[156:159], v[68:71]
  s_waitcnt lgkmcnt(12)
  v_mfma_f32_16x16x32_bf16 v[72:75], v[124:127], v[144:147], v[72:75]
  v_mfma_f32_16x16x32_bf16 v[76:79], v[124:127], v[148:151], v[76:79]
  v_mfma_f32_16x16x32_bf16 v[80:83], v[124:127], v[152:155], v[80:83]
  v_mfma_f32_16x16x32_bf16 v[84:87], v[124:127], v[156:159], v[84:87]
  s_waitcnt lgkmcnt(0)
  s_barrier
  v_mfma_f32_16x16x32_bf16 v[24:27], v[128:131], v[160:163], v[24:27]
  ds_read_b128 v[144:147], v3 offset:49152
  v_mfma_f32_16x16x32_bf16 v[28:31], v[128:131], v[164:167], v[28:31]
  ds_read_b64_tr_b16 v[112:113], v7 offset:49152
  v_mfma_f32_16x16x32_bf16 v[32:35], v[128:131], v[168:171], v[32:35]
  ds_read_b64_tr_b16 v[114:115], v7 offset:50176
  v_mfma_f32_16x16x32_bf16 v[36:39], v[128:131], v[172:175], v[36:39]
  ds_read_b128 v[148:151], v3 offset:51200
  v_mfma_f32_16x16x32_bf16 v[88:91], v[160:163], v[160:163], v[88:91]
  ds_read_b64_tr_b16 v[116:117], v8 offset:49152
  v_mfma_f32_16x16x32_bf16 v[96:99], v[176:179], v[160:163], v[96:99]
  ds_read_b64_tr_b16 v[118:119], v8 offset:50176
  v_mfma_f32_16x16x32_bf16 v[104:107], v[128:131], v[176:179], v[104:107]
  ds_read_b128 v[152:155], v4 offset:49152
  v_mfma_f32_16x16x32_bf16 v[40:43], v[132:135], v[160:163], v[40:43]
  ds_read_b64_tr_b16 v[120:121], v9 offset:49152
  v_mfma_f32_16x16x32_bf16 v[44:47], v[132:135], v[164:167], v[44:47]
  ds_read_b64_tr_b16 v[122:123], v9 offset:50176
  v_mfma_f32_16x16x32_bf16 v[48:51], v[132:135], v[168:171], v[48:51]
  ds_read_b128 v[156:159], v4 offset:51200
  v_mfma_f32_16x16x32_bf16 v[52:55], v[132:135], v[172:175], v[52:55]
  ds_read_b64_tr_b16 v[124:125], v10 offset:49152
  v_mfma_f32_16x16x32_bf16 v[92:95], v[164:167], v[164:167], v[92:95]
  ds_read_b64_tr_b16 v[126:127], v10 offset:50176
  v_mfma_f32_16x16x32_bf16 v[100:103], v[176:179], v[164:167], v[100:103]
  v_mfma_f32_16x16x32_bf16 v[108:111], v[132:135], v[176:179], v[108:111]
  v_mfma_f32_16x16x32_bf16 v[56:59], v[136:139], v[160:163], v[56:59]
  v_mfma_f32_16x16x32_bf16 v[60:63], v[136:139], v[164:167], v[60:63]
  v_mfma_f32_16x16x32_bf16 v[64:67], v[136:139], v[168:171], v[64:67]
  v_mfma_f32_16x16x32_bf16 v[68:71], v[136:139], v[172:175], v[68:71]
  v_mfma_f32_16x16x32_bf16 v[72:75], v[140:143], v[160:163], v[72:75]
  v_mfma_f32_16x16x32_bf16 v[76:79], v[140:143], v[164:167], v[76:79]
  v_mfma_f32_16x16x32_bf16 v[80:83], v[140:143], v[168:171], v[80:83]
  v_mfma_f32_16x16x32_bf16 v[84:87], v[140:143], v[172:175], v[84:87]
  s_waitcnt lgkmcnt(9)
  v_mfma_f32_16x16x32_bf16 v[24:27], v[112:115], v[144:147], v[24:27]
  ds_read_b128 v[160:163], v5 offset:49152
  s_waitcnt lgkmcnt(9)
  v_mfma_f32_16x16x32_bf16 v[28:31], v[112:115], v[148:151], v[28:31]
  ds_read_b64_tr_b16 v[128:129], v7 offset:57344
  s_waitcnt lgkmcnt(7)
  v_mfma_f32_16x16x32_bf16 v[32:35], v[112:115], v[152:155], v[32:35]
  ds_read_b64_tr_b16 v[130:131], v7 offset:58368
  s_waitcnt lgkmcnt(5)
  v_mfma_f32_16x16x32_bf16 v[36:39], v[112:115], v[156:159], v[36:39]
  ds_read_b128 v[164:167], v5 offset:51200
  v_mfma_f32_16x16x32_bf16 v[88:91], v[144:147], v[144:147], v[88:91]
  ds_read_b64_tr_b16 v[132:133], v8 offset:57344
  v_mfma_f32_16x16x32_bf16 v[96:99], v[176:179], v[144:147], v[96:99]
  ds_read_b64_tr_b16 v[134:135], v8 offset:58368
  v_mfma_f32_16x16x32_bf16 v[104:107], v[112:115], v[176:179], v[104:107]
  ds_read_b128 v[168:171], v6 offset:49152
  v_mfma_f32_16x16x32_bf16 v[40:43], v[116:119], v[144:147], v[40:43]
  ds_read_b64_tr_b16 v[136:137], v9 offset:57344
  v_mfma_f32_16x16x32_bf16 v[44:47], v[116:119], v[148:151], v[44:47]
  ds_read_b64_tr_b16 v[138:139], v9 offset:58368
  v_mfma_f32_16x16x32_bf16 v[48:51], v[116:119], v[152:155], v[48:51]
  ds_read_b128 v[172:175], v6 offset:51200
  v_mfma_f32_16x16x32_bf16 v[52:55], v[116:119], v[156:159], v[52:55]
  ds_read_b64_tr_b16 v[140:141], v10 offset:57344
  v_mfma_f32_16x16x32_bf16 v[92:95], v[148:151], v[148:151], v[92:95]
  ds_read_b64_tr_b16 v[142:143], v10 offset:58368
  v_mfma_f32_16x16x32_bf16 v[100:103], v[176:179], v[148:151], v[100:103]
  v_mfma_f32_16x16x32_bf16 v[108:111], v[116:119], v[176:179], v[108:111]
  v_mfma_f32_16x16x32_bf16 v[56:59], v[120:123], v[144:147], v[56:59]
  v_mfma_f32_16x16x32_bf16 v[60:63], v[120:123], v[148:151], v[60:63]
  v_mfma_f32_16x16x32_bf16 v[64:67], v[120:123], v[152:155], v[64:67]
  v_mfma_f32_16x16x32_bf16 v[68:71], v[120:123], v[156:159], v[68:71]
  s_waitcnt lgkmcnt(12)
  v_mfma_f32_16x16x32_bf16 v[72:75], v[124:127], v[144:147], v[72:75]
  v_mfma_f32_16x16x32_bf16 v[76:79], v[124:127], v[148:151], v[76:79]
  v_mfma_f32_16x16x32_bf16 v[80:83], v[124:127], v[152:155], v[80:83]
  v_mfma_f32_16x16x32_bf16 v[84:87], v[124:127], v[156:159], v[84:87]
  s_waitcnt lgkmcnt(0)
  s_barrier
  v_mfma_f32_16x16x32_bf16 v[24:27], v[128:131], v[160:163], v[24:27]
  ds_read_b128 v[144:147], v3 offset:0
  v_mfma_f32_16x16x32_bf16 v[28:31], v[128:131], v[164:167], v[28:31]
  ds_read_b64_tr_b16 v[112:113], v7 offset:0
  v_mfma_f32_16x16x32_bf16 v[32:35], v[128:131], v[168:171], v[32:35]
  ds_read_b64_tr_b16 v[114:115], v7 offset:1024
  v_mfma_f32_16x16x32_bf16 v[36:39], v[128:131], v[172:175], v[36:39]
  ds_read_b128 v[148:151], v3 offset:2048
  v_mfma_f32_16x16x32_bf16 v[88:91], v[160:163], v[160:163], v[88:91]
  ds_read_b64_tr_b16 v[116:117], v8 offset:0
  v_mfma_f32_16x16x32_bf16 v[96:99], v[176:179], v[160:163], v[96:99]
  ds_read_b64_tr_b16 v[118:119], v8 offset:1024
  v_mfma_f32_16x16x32_bf16 v[104:107], v[128:131], v[176:179], v[104:107]
  ds_read_b128 v[152:155], v4 offset:0
  v_mfma_f32_16x16x32_bf16 v[40:43], v[132:135], v[160:163], v[40:43]
  ds_read_b64_tr_b16 v[120:121], v9 offset:0
  v_mfma_f32_16x16x32_bf16 v[44:47], v[132:135], v[164:167], v[44:47]
  ds_read_b64_tr_b16 v[122:123], v9 offset:1024
  v_mfma_f32_16x16x32_bf16 v[48:51], v[132:135], v[168:171], v[48:51]
  ds_read_b128 v[156:159], v4 offset:2048
  v_mfma_f32_16x16x32_bf16 v[52:55], v[132:135], v[172:175], v[52:55]
  ds_read_b64_tr_b16 v[124:125], v10 offset:0
  v_mfma_f32_16x16x32_bf16 v[92:95], v[164:167], v[164:167], v[92:95]
  ds_read_b64_tr_b16 v[126:127], v10 offset:1024
  v_mfma_f32_16x16x32_bf16 v[100:103], v[176:179], v[164:167], v[100:103]
  v_mfma_f32_16x16x32_bf16 v[108:111], v[132:135], v[176:179], v[108:111]
  v_mfma_f32_16x16x32_bf16 v[56:59], v[136:139], v[160:163], v[56:59]
  v_mfma_f32_16x16x32_bf16 v[60:63], v[136:139], v[164:167], v[60:63]
  v_mfma_f32_16x16x32_bf16 v[64:67], v[136:139], v[168:171], v[64:67]
  v_mfma_f32_16x16x32_bf16 v[68:71], v[136:139], v[172:175], v[68:71]
  v_mfma_f32_16x16x32_bf16 v[72:75], v[140:143], v[160:163], v[72:75]
  v_mfma_f32_16x16x32_bf16 v[76:79], v[140:143], v[164:167], v[76:79]
  v_mfma_f32_16x16x32_bf16 v[80:83], v[140:143], v[168:171], v[80:83]
  v_mfma_f32_16x16x32_bf16 v[84:87], v[140:143], v[172:175], v[84:87]
  s_waitcnt lgkmcnt(9)
  v_mfma_f32_16x16x32_bf16 v[24:27], v[112:115], v[144:147], v[24:27]
  ds_read_b128 v[160:163], v5 offset:0
  s_waitcnt lgkmcnt(9)
  v_mfma_f32_16x16x32_bf16 v[28:31], v[112:115], v[148:151], v[28:31]
  ds_read_b64_tr_b16 v[128:129], v7 offset:8192
  s_waitcnt lgkmcnt(7)
  v_mfma_f32_16x16x32_bf16 v[32:35], v[112:115], v[152:155], v[32:35]
  ds_read_b64_tr_b16 v[130:131], v7 offset:9216
  s_waitcnt lgkmcnt(5)
  v_mfma_f32_16x16x32_bf16 v[36:39], v[112:115], v[156:159], v[36:39]
  ds_read_b128 v[164:167], v5 offset:2048
  v_mfma_f32_16x16x32_bf16 v[88:91], v[144:147], v[144:147], v[88:91]
  ds_read_b64_tr_b16 v[132:133], v8 offset:8192
  v_mfma_f32_16x16x32_bf16 v[96:99], v[176:179], v[144:147], v[96:99]
  ds_read_b64_tr_b16 v[134:135], v8 offset:9216
  v_mfma_f32_16x16x32_bf16 v[104:107], v[112:115], v[176:179], v[104:107]
  ds_read_b128 v[168:171], v6 offset:0
  v_mfma_f32_16x16x32_bf16 v[40:43], v[116:119], v[144:147], v[40:43]
  ds_read_b64_tr_b16 v[136:137], v9 offset:8192
  v_mfma_f32_16x16x32_bf16 v[44:47], v[116:119], v[148:151], v[44:47]
  ds_read_b64_tr_b16 v[138:139], v9 offset:9216
  v_mfma_f32_16x16x32_bf16 v[48:51], v[116:119], v[152:155], v[48:51]
  ds_read_b128 v[172:175], v6 offset:2048
  v_mfma_f32_16x16x32_bf16 v[52:55], v[116:119], v[156:159], v[52:55]
  ds_read_b64_tr_b16 v[140:141], v10 offset:8192
  v_mfma_f32_16x16x32_bf16 v[92:95], v[148:151], v[148:151], v[92:95]
  ds_read_b64_tr_b16 v[142:143], v10 offset:9216
  v_mfma_f32_16x16x32_bf16 v[100:103], v[176:179], v[148:151], v[100:103]
  v_mfma_f32_16x16x32_bf16 v[108:111], v[116:119], v[176:179], v[108:111]
  v_mfma_f32_16x16x32_bf16 v[56:59], v[120:123], v[144:147], v[56:59]
  v_mfma_f32_16x16x32_bf16 v[60:63], v[120:123], v[148:151], v[60:63]
  v_mfma_f32_16x16x32_bf16 v[64:67], v[120:123], v[152:155], v[64:67]
  v_mfma_f32_16x16x32_bf16 v[68:71], v[120:123], v[156:159], v[68:71]
  s_waitcnt lgkmcnt(12)
  v_mfma_f32_16x16x32_bf16 v[72:75], v[124:127], v[144:147], v[72:75]
  v_mfma_f32_16x16x32_bf16 v[76:79], v[124:127], v[148:151], v[76:79]
  v_mfma_f32_16x16x32_bf16 v[80:83], v[124:127], v[152:155], v[80:83]
  v_mfma_f32_16x16x32_bf16 v[84:87], v[124:127], v[156:159], v[84:87]
  s_waitcnt lgkmcnt(0)
  s_barrier
  v_mfma_f32_16x16x32_bf16 v[24:27], v[128:131], v[160:163], v[24:27]
  ds_read_b128 v[144:147], v3 offset:16384
  v_mfma_f32_16x16x32_bf16 v[28:31], v[128:131], v[164:167], v[28:31]
  ds_read_b64_tr_b16 v[112:113], v7 offset:16384
  v_mfma_f32_16x16x32_bf16 v[32:35], v[128:131], v[168:171], v[32:35]
  ds_read_b64_tr_b16 v[114:115], v7 offset:17408
  v_mfma_f32_16x16x32_bf16 v[36:39], v[128:131], v[172:175], v[36:39]
  ds_read_b128 v[148:151], v3 offset:18432
  v_mfma_f32_16x16x32_bf16 v[88:91], v[160:163], v[160:163], v[88:91]
  ds_read_b64_tr_b16 v[116:117], v8 offset:16384
  v_mfma_f32_16x16x32_bf16 v[96:99], v[176:179], v[160:163], v[96:99]
  ds_read_b64_tr_b16 v[118:119], v8 offset:17408
  v_mfma_f32_16x16x32_bf16 v[104:107], v[128:131], v[176:179], v[104:107]
  ds_read_b128 v[152:155], v4 offset:16384
  v_mfma_f32_16x16x32_bf16 v[40:43], v[132:135], v[160:163], v[40:43]
  ds_read_b64_tr_b16 v[120:121], v9 offset:16384
  v_mfma_f32_16x16x32_bf16 v[44:47], v[132:135], v[164:167], v[44:47]
  ds_read_b64_tr_b16 v[122:123], v9 offset:17408
  v_mfma_f32_16x16x32_bf16 v[48:51], v[132:135], v[168:171], v[48:51]
  ds_read_b128 v[156:159], v4 offset:18432
  v_mfma_f32_16x16x32_bf16 v[52:55], v[132:135], v[172:175], v[52:55]
  ds_read_b64_tr_b16 v[124:125], v10 offset:16384
  v_mfma_f32_16x16x32_bf16 v[92:95], v[164:167], v[164:167], v[92:95]
  ds_read_b64_tr_b16 v[126:127], v10 offset:17408
  v_mfma_f32_16x16x32_bf16 v[100:103], v[176:179], v[164:167], v[100:103]
  v_mfma_f32_16x16x32_bf16 v[108:111], v[132:135], v[176:179], v[108:111]
  v_mfma_f32_16x16x32_bf16 v[56:59], v[136:139], v[160:163], v[56:59]
  v_mfma_f32_16x16x32_bf16 v[60:63], v[136:139], v[164:167], v[60:63]
  v_mfma_f32_16x16x32_bf16 v[64:67], v[136:139], v[168:171], v[64:67]
  v_mfma_f32_16x16x32_bf16 v[68:71], v[136:139], v[172:175], v[68:71]
  v_mfma_f32_16x16x32_bf16 v[72:75], v[140:143], v[160:163], v[72:75]
  v_mfma_f32_16x16x32_bf16 v[76:79], v[140:143], v[164:167], v[76:79]
  v_mfma_f32_16x16x32_bf16 v[80:83], v[140:143], v[168:171], v[80:83]
  v_mfma_f32_16x16x32_bf16 v[84:87], v[140:143], v[172:175], v[84:87]
  s_waitcnt lgkmcnt(9)
  v_mfma_f32_16x16x32_bf16 v[24:27], v[112:115], v[144:147], v[24:27]
  ds_read_b128 v[160:163], v5 offset:16384
  s_waitcnt lgkmcnt(9)
  v_mfma_f32_16x16x32_bf16 v[28:31], v[112:115], v[148:151], v[28:31]
  ds_read_b64_tr_b16 v[128:129], v7 offset:24576
  s_waitcnt lgkmcnt(7)
  v_mfma_f32_16x16x32_bf16 v[32:35], v[112:115], v[152:155], v[32:35]
  ds_read_b64_tr_b16 v[130:131], v7 offset:25600
  s_waitcnt lgkmcnt(5)
  v_mfma_f32_16x16x32_bf16 v[36:39], v[112:115], v[156:159], v[36:39]
  ds_read_b128 v[164:167], v5 offset:18432
  v_mfma_f32_16x16x32_bf16 v[88:91], v[144:147], v[144:147], v[88:91]
  ds_read_b64_tr_b16 v[132:133], v8 offset:24576
  v_mfma_f32_16x16x32_bf16 v[96:99], v[176:179], v[144:147], v[96:99]
  ds_read_b64_tr_b16 v[134:135], v8 offset:25600
  v_mfma_f32_16x16x32_bf16 v[104:107], v[112:115], v[176:179], v[104:107]
  ds_read_b128 v[168:171], v6 offset:16384
  v_mfma_f32_16x16x32_bf16 v[40:43], v[116:119], v[144:147], v[40:43]
  ds_read_b64_tr_b16 v[136:137], v9 offset:24576
  v_mfma_f32_16x16x32_bf16 v[44:47], v[116:119], v[148:151], v[44:47]
  ds_read_b64_tr_b16 v[138:139], v9 offset:25600
  v_mfma_f32_16x16x32_bf16 v[48:51], v[116:119], v[152:155], v[48:51]
  ds_read_b128 v[172:175], v6 offset:18432
  v_mfma_f32_16x16x32_bf16 v[52:55], v[116:119], v[156:159], v[52:55]
  ds_read_b64_tr_b16 v[140:141], v10 offset:24576
  v_mfma_f32_16x16x32_bf16 v[92:95], v[148:151], v[148:151], v[92:95]
  ds_read_b64_tr_b16 v[142:143], v10 offset:25600
  v_mfma_f32_16x16x32_bf16 v[100:103], v[176:179], v[148:151], v[100:103]
  v_mfma_f32_16x16x32_bf16 v[108:111], v[116:119], v[176:179], v[108:111]
  v_mfma_f32_16x16x32_bf16 v[56:59], v[120:123], v[144:147], v[56:59]
  v_mfma_f32_16x16x32_bf16 v[60:63], v[120:123], v[148:151], v[60:63]
  v_mfma_f32_16x16x32_bf16 v[64:67], v[120:123], v[152:155], v[64:67]
  v_mfma_f32_16x16x32_bf16 v[68:71], v[120:123], v[156:159], v[68:71]
  s_waitcnt lgkmcnt(12)
  v_mfma_f32_16x16x32_bf16 v[72:75], v[124:127], v[144:147], v[72:75]
  v_mfma_f32_16x16x32_bf16 v[76:79], v[124:127], v[148:151], v[76:79]
  v_mfma_f32_16x16x32_bf16 v[80:83], v[124:127], v[152:155], v[80:83]
  v_mfma_f32_16x16x32_bf16 v[84:87], v[124:127], v[156:159], v[84:87]
  s_waitcnt lgkmcnt(0)
  s_barrier
  v_mfma_f32_16x16x32_bf16 v[24:27], v[128:131], v[160:163], v[24:27]
  v_mfma_f32_16x16x32_bf16 v[28:31], v[128:131], v[164:167], v[28:31]
  v_mfma_f32_16x16x32_bf16 v[32:35], v[128:131], v[168:171], v[32:35]
  v_mfma_f32_16x16x32_bf16 v[36:39], v[128:131], v[172:175], v[36:39]
  v_mfma_f32_16x16x32_bf16 v[88:91], v[160:163], v[160:163], v[88:91]
  v_mfma_f32_16x16x32_bf16 v[96:99], v[176:179], v[160:163], v[96:99]
  v_mfma_f32_16x16x32_bf16 v[104:107], v[128:131], v[176:179], v[104:107]
  v_mfma_f32_16x16x32_bf16 v[40:43], v[132:135], v[160:163], v[40:43]
  v_mfma_f32_16x16x32_bf16 v[44:47], v[132:135], v[164:167], v[44:47]
  v_mfma_f32_16x16x32_bf16 v[48:51], v[132:135], v[168:171], v[48:51]
  v_mfma_f32_16x16x32_bf16 v[52:55], v[132:135], v[172:175], v[52:55]
  v_mfma_f32_16x16x32_bf16 v[92:95], v[164:167], v[164:167], v[92:95]
  v_mfma_f32_16x16x32_bf16 v[100:103], v[176:179], v[164:167], v[100:103]
  v_mfma_f32_16x16x32_bf16 v[108:111], v[132:135], v[176:179], v[108:111]
  v_mfma_f32_16x16x32_bf16 v[56:59], v[136:139], v[160:163], v[56:59]
  v_mfma_f32_16x16x32_bf16 v[60:63], v[136:139], v[164:167], v[60:63]
  v_mfma_f32_16x16x32_bf16 v[64:67], v[136:139], v[168:171], v[64:67]
  v_mfma_f32_16x16x32_bf16 v[68:71], v[136:139], v[172:175], v[68:71]
  v_mfma_f32_16x16x32_bf16 v[72:75], v[140:143], v[160:163], v[72:75]
  v_mfma_f32_16x16x32_bf16 v[76:79], v[140:143], v[164:167], v[76:79]
  v_mfma_f32_16x16x32_bf16 v[80:83], v[140:143], v[168:171], v[80:83]
  v_mfma_f32_16x16x32_bf16 v[84:87], v[140:143], v[172:175], v[84:87]
  v_and_b32 v11, 3, v0
  v_cmp_eq_u32 s[30:31], 1, v11
  v_cmp_eq_u32 s[32:33], 2, v11
  v_cmp_eq_u32 s[34:35], 3, v11
  s_mov_b32 s26, 0x3acccccd
  s_mov_b32 s27, 0x3727c5ac
  s_cmp_lt_u32 s12, 5
  s_cselect_b32 s36, 0x3ea52b5c, 1.0
  v_cndmask_b32 v17, v88, v89, s[30:31]
  v_mul_f32 v16, s26, v96
  v_cndmask_b32 v17, v17, v90, s[32:33]
  v_cndmask_b32 v17, v17, v91, s[34:35]
  v_cndmask_b32 v19, v92, v93, s[30:31]
  v_mul_f32 v18, s26, v100
  v_cndmask_b32 v19, v19, v94, s[32:33]
  v_cndmask_b32 v19, v19, v95, s[34:35]
  v_mul_f32 v17, s26, v17
  v_fma_f32 v17, -v16, v16, v17
  v_max_f32 v17, 0, v17
  v_cvt_pk_bf16_f32 v17, v17, v17
  v_lshlrev_b32 v17, 16, v17
  v_add_f32 v17, s27, v17
  v_cvt_pk_bf16_f32 v17, v17, v17
  v_lshlrev_b32 v17, 16, v17
  v_sqrt_f32 v17, v17
  v_cvt_pk_bf16_f32 v16, v16, v16
  v_lshlrev_b32 v16, 16, v16
  v_cvt_pk_bf16_f32 v17, v17, v17
  v_lshlrev_b32 v17, 16, v17
  v_rcp_f32 v17, v17
  s_nop 0
  v_mul_f32 v17, s36, v17
  v_mul_f32 v19, s26, v19
  v_fma_f32 v19, -v18, v18, v19
  v_max_f32 v19, 0, v19
  v_cvt_pk_bf16_f32 v19, v19, v19
  v_lshlrev_b32 v19, 16, v19
  v_add_f32 v19, s27, v19
  v_cvt_pk_bf16_f32 v19, v19, v19
  v_lshlrev_b32 v19, 16, v19
  v_sqrt_f32 v19, v19
  v_cvt_pk_bf16_f32 v18, v18, v18
  v_lshlrev_b32 v18, 16, v18
  v_cvt_pk_bf16_f32 v19, v19, v19
  v_lshlrev_b32 v19, 16, v19
  v_rcp_f32 v19, v19
  s_nop 0
  v_mul_f32 v19, s36, v19
  v_lshlrev_b32 v12, 3, v2
  s_lshl_b32 s16, s18, 7
  s_lshl_b32 s17, s19, 7
  s_add_u32 s16, s16, 131072
  s_add_u32 s17, s17, 131072
  v_add_u32 v13, s16, v12
  v_add_u32 v14, s17, v12
  s_mov_b32 s38, 0x00F0000F
  s_mov_b32 s39, 0xF0000F00
  s_mov_b64 exec, s[38:39]
  ds_write_b64 v13, v[16:17] offset:0
  ds_write_b64 v13, v[18:19] offset:128
  s_mov_b64 exec, -1
  v_lshlrev_b32 v21, 4, v1
  s_lshl_b32 s16, s20, 7
  s_lshl_b32 s17, s21, 7
  s_add_u32 s16, s16, 132096
  s_add_u32 s17, s17, 132096
  v_add_u32 v22, s17, v21
  v_add_u32 v21, s16, v21
  s_mov_b32 s38, 0x00010001
  s_mov_b32 s39, 0x00010001
  s_mov_b64 exec, s[38:39]
  ds_write_b128 v21, v[104:107] offset:0
  ds_write_b128 v21, v[108:111] offset:64
  s_mov_b64 exec, -1
  s_mov_b32 s40, s8
  s_and_b32 s41, s9, 0xffff
  s_mov_b32 s42, 7864320
  s_mov_b32 s43, 0x00020000
  s_lshl_b32 s16, s12, 2
  s_add_u32 s16, s16, s20
  s_lshl_b32 s16, s16, 2
  v_add_u32 v11, s16, v1
  v_lshlrev_b32 v11, 15, v11
  v_lshl_add_u32 v11, v2, 4, v11
  s_lshl_b32 s16, s11, 3
  s_add_u32 s16, s16, s18
  s_lshl_b32 s16, s16, 8
  v_add_u32 v144, s16, v11
  s_lshl_b32 s16, s11, 3
  s_add_u32 s16, s16, s19
  s_lshl_b32 s16, s16, 8
  v_add_u32 v145, s16, v11
  s_lshl_b32 s16, s12, 2
  s_add_u32 s16, s16, s21
  s_lshl_b32 s16, s16, 2
  v_add_u32 v11, s16, v1
  v_lshlrev_b32 v11, 15, v11
  v_lshl_add_u32 v11, v2, 4, v11
  s_lshl_b32 s16, s11, 3
  s_add_u32 s16, s16, s18
  s_lshl_b32 s16, s16, 8
  v_add_u32 v146, s16, v11
  s_lshl_b32 s16, s11, 3
  s_add_u32 s16, s16, s19
  s_lshl_b32 s16, s16, 8
  v_add_u32 v147, s16, v11
  s_waitcnt lgkmcnt(0)
  s_barrier
  ds_read_b64 v[112:113], v13 offset:0
  ds_read_b64 v[114:115], v13 offset:128
  ds_read_b64 v[116:117], v14 offset:0
  ds_read_b64 v[118:119], v14 offset:128
  ds_read_b128 v[120:123], v22 offset:0
  ds_read_b128 v[124:127], v22 offset:64
  s_waitcnt lgkmcnt(5)
  v_pk_fma_f32 v[24:25], v[104:105], v[112:113], v[24:25] op_sel:[0,0,0] op_sel_hi:[1,0,1] neg_lo:[0,1,0] neg_hi:[0,1,0]
  v_pk_fma_f32 v[26:27], v[106:107], v[112:113], v[26:27] op_sel:[0,0,0] op_sel_hi:[1,0,1] neg_lo:[0,1,0] neg_hi:[0,1,0]
  v_pk_mul_f32 v[24:25], v[24:25], v[112:113] op_sel:[0,1] op_sel_hi:[1,1]
  v_pk_mul_f32 v[26:27], v[26:27], v[112:113] op_sel:[0,1] op_sel_hi:[1,1]
  v_cvt_pk_bf16_f32 v128, v24, v25
  v_cvt_pk_bf16_f32 v129, v26, v27
  v_pk_fma_f32 v[40:41], v[108:109], v[112:113], v[40:41] op_sel:[0,0,0] op_sel_hi:[1,0,1] neg_lo:[0,1,0] neg_hi:[0,1,0]
  v_pk_fma_f32 v[42:43], v[110:111], v[112:113], v[42:43] op_sel:[0,0,0] op_sel_hi:[1,0,1] neg_lo:[0,1,0] neg_hi:[0,1,0]
  v_pk_mul_f32 v[40:41], v[40:41], v[112:113] op_sel:[0,1] op_sel_hi:[1,1]
  v_pk_mul_f32 v[42:43], v[42:43], v[112:113] op_sel:[0,1] op_sel_hi:[1,1]
  v_cvt_pk_bf16_f32 v130, v40, v41
  v_cvt_pk_bf16_f32 v131, v42, v43
  buffer_store_dwordx4 v[128:131], v144, s[40:43], 0 offen offset:0 sc1
  s_waitcnt lgkmcnt(4)
  v_pk_fma_f32 v[28:29], v[104:105], v[114:115], v[28:29] op_sel:[0,0,0] op_sel_hi:[1,0,1] neg_lo:[0,1,0] neg_hi:[0,1,0]
  v_pk_fma_f32 v[30:31], v[106:107], v[114:115], v[30:31] op_sel:[0,0,0] op_sel_hi:[1,0,1] neg_lo:[0,1,0] neg_hi:[0,1,0]
  v_pk_mul_f32 v[28:29], v[28:29], v[114:115] op_sel:[0,1] op_sel_hi:[1,1]
  v_pk_mul_f32 v[30:31], v[30:31], v[114:115] op_sel:[0,1] op_sel_hi:[1,1]
  v_cvt_pk_bf16_f32 v132, v28, v29
  v_cvt_pk_bf16_f32 v133, v30, v31
  v_pk_fma_f32 v[44:45], v[108:109], v[114:115], v[44:45] op_sel:[0,0,0] op_sel_hi:[1,0,1] neg_lo:[0,1,0] neg_hi:[0,1,0]
  v_pk_fma_f32 v[46:47], v[110:111], v[114:115], v[46:47] op_sel:[0,0,0] op_sel_hi:[1,0,1] neg_lo:[0,1,0] neg_hi:[0,1,0]
  v_pk_mul_f32 v[44:45], v[44:45], v[114:115] op_sel:[0,1] op_sel_hi:[1,1]
  v_pk_mul_f32 v[46:47], v[46:47], v[114:115] op_sel:[0,1] op_sel_hi:[1,1]
  v_cvt_pk_bf16_f32 v134, v44, v45
  v_cvt_pk_bf16_f32 v135, v46, v47
  buffer_store_dwordx4 v[132:135], v144, s[40:43], 0 offen offset:256 sc1
  s_waitcnt lgkmcnt(3)
  v_pk_fma_f32 v[32:33], v[104:105], v[116:117], v[32:33] op_sel:[0,0,0] op_sel_hi:[1,0,1] neg_lo:[0,1,0] neg_hi:[0,1,0]
  v_pk_fma_f32 v[34:35], v[106:107], v[116:117], v[34:35] op_sel:[0,0,0] op_sel_hi:[1,0,1] neg_lo:[0,1,0] neg_hi:[0,1,0]
  v_pk_mul_f32 v[32:33], v[32:33], v[116:117] op_sel:[0,1] op_sel_hi:[1,1]
  v_pk_mul_f32 v[34:35], v[34:35], v[116:117] op_sel:[0,1] op_sel_hi:[1,1]
  v_cvt_pk_bf16_f32 v136, v32, v33
  v_cvt_pk_bf16_f32 v137, v34, v35
  v_pk_fma_f32 v[48:49], v[108:109], v[116:117], v[48:49] op_sel:[0,0,0] op_sel_hi:[1,0,1] neg_lo:[0,1,0] neg_hi:[0,1,0]
  v_pk_fma_f32 v[50:51], v[110:111], v[116:117], v[50:51] op_sel:[0,0,0] op_sel_hi:[1,0,1] neg_lo:[0,1,0] neg_hi:[0,1,0]
  v_pk_mul_f32 v[48:49], v[48:49], v[116:117] op_sel:[0,1] op_sel_hi:[1,1]
  v_pk_mul_f32 v[50:51], v[50:51], v[116:117] op_sel:[0,1] op_sel_hi:[1,1]
  v_cvt_pk_bf16_f32 v138, v48, v49
  v_cvt_pk_bf16_f32 v139, v50, v51
  buffer_store_dwordx4 v[136:139], v145, s[40:43], 0 offen offset:0 sc1
  s_waitcnt lgkmcnt(2)
  v_pk_fma_f32 v[36:37], v[104:105], v[118:119], v[36:37] op_sel:[0,0,0] op_sel_hi:[1,0,1] neg_lo:[0,1,0] neg_hi:[0,1,0]
  v_pk_fma_f32 v[38:39], v[106:107], v[118:119], v[38:39] op_sel:[0,0,0] op_sel_hi:[1,0,1] neg_lo:[0,1,0] neg_hi:[0,1,0]
  v_pk_mul_f32 v[36:37], v[36:37], v[118:119] op_sel:[0,1] op_sel_hi:[1,1]
  v_pk_mul_f32 v[38:39], v[38:39], v[118:119] op_sel:[0,1] op_sel_hi:[1,1]
  v_cvt_pk_bf16_f32 v140, v36, v37
  v_cvt_pk_bf16_f32 v141, v38, v39
  v_pk_fma_f32 v[52:53], v[108:109], v[118:119], v[52:53] op_sel:[0,0,0] op_sel_hi:[1,0,1] neg_lo:[0,1,0] neg_hi:[0,1,0]
  v_pk_fma_f32 v[54:55], v[110:111], v[118:119], v[54:55] op_sel:[0,0,0] op_sel_hi:[1,0,1] neg_lo:[0,1,0] neg_hi:[0,1,0]
  v_pk_mul_f32 v[52:53], v[52:53], v[118:119] op_sel:[0,1] op_sel_hi:[1,1]
  v_pk_mul_f32 v[54:55], v[54:55], v[118:119] op_sel:[0,1] op_sel_hi:[1,1]
  v_cvt_pk_bf16_f32 v142, v52, v53
  v_cvt_pk_bf16_f32 v143, v54, v55
  buffer_store_dwordx4 v[140:143], v145, s[40:43], 0 offen offset:256 sc1
  s_waitcnt lgkmcnt(1)
  v_pk_fma_f32 v[56:57], v[120:121], v[112:113], v[56:57] op_sel:[0,0,0] op_sel_hi:[1,0,1] neg_lo:[0,1,0] neg_hi:[0,1,0]
  v_pk_fma_f32 v[58:59], v[122:123], v[112:113], v[58:59] op_sel:[0,0,0] op_sel_hi:[1,0,1] neg_lo:[0,1,0] neg_hi:[0,1,0]
  v_pk_mul_f32 v[56:57], v[56:57], v[112:113] op_sel:[0,1] op_sel_hi:[1,1]
  v_pk_mul_f32 v[58:59], v[58:59], v[112:113] op_sel:[0,1] op_sel_hi:[1,1]
  v_cvt_pk_bf16_f32 v128, v56, v57
  v_cvt_pk_bf16_f32 v129, v58, v59
  s_waitcnt lgkmcnt(0)
  v_pk_fma_f32 v[72:73], v[124:125], v[112:113], v[72:73] op_sel:[0,0,0] op_sel_hi:[1,0,1] neg_lo:[0,1,0] neg_hi:[0,1,0]
  v_pk_fma_f32 v[74:75], v[126:127], v[112:113], v[74:75] op_sel:[0,0,0] op_sel_hi:[1,0,1] neg_lo:[0,1,0] neg_hi:[0,1,0]
  v_pk_mul_f32 v[72:73], v[72:73], v[112:113] op_sel:[0,1] op_sel_hi:[1,1]
  v_pk_mul_f32 v[74:75], v[74:75], v[112:113] op_sel:[0,1] op_sel_hi:[1,1]
  v_cvt_pk_bf16_f32 v130, v72, v73
  v_cvt_pk_bf16_f32 v131, v74, v75
  buffer_store_dwordx4 v[128:131], v146, s[40:43], 0 offen offset:0 sc1
  v_pk_fma_f32 v[60:61], v[120:121], v[114:115], v[60:61] op_sel:[0,0,0] op_sel_hi:[1,0,1] neg_lo:[0,1,0] neg_hi:[0,1,0]
  v_pk_fma_f32 v[62:63], v[122:123], v[114:115], v[62:63] op_sel:[0,0,0] op_sel_hi:[1,0,1] neg_lo:[0,1,0] neg_hi:[0,1,0]
  v_pk_mul_f32 v[60:61], v[60:61], v[114:115] op_sel:[0,1] op_sel_hi:[1,1]
  v_pk_mul_f32 v[62:63], v[62:63], v[114:115] op_sel:[0,1] op_sel_hi:[1,1]
  v_cvt_pk_bf16_f32 v132, v60, v61
  v_cvt_pk_bf16_f32 v133, v62, v63
  v_pk_fma_f32 v[76:77], v[124:125], v[114:115], v[76:77] op_sel:[0,0,0] op_sel_hi:[1,0,1] neg_lo:[0,1,0] neg_hi:[0,1,0]
  v_pk_fma_f32 v[78:79], v[126:127], v[114:115], v[78:79] op_sel:[0,0,0] op_sel_hi:[1,0,1] neg_lo:[0,1,0] neg_hi:[0,1,0]
  v_pk_mul_f32 v[76:77], v[76:77], v[114:115] op_sel:[0,1] op_sel_hi:[1,1]
  v_pk_mul_f32 v[78:79], v[78:79], v[114:115] op_sel:[0,1] op_sel_hi:[1,1]
  v_cvt_pk_bf16_f32 v134, v76, v77
  v_cvt_pk_bf16_f32 v135, v78, v79
  buffer_store_dwordx4 v[132:135], v146, s[40:43], 0 offen offset:256 sc1
  v_pk_fma_f32 v[64:65], v[120:121], v[116:117], v[64:65] op_sel:[0,0,0] op_sel_hi:[1,0,1] neg_lo:[0,1,0] neg_hi:[0,1,0]
  v_pk_fma_f32 v[66:67], v[122:123], v[116:117], v[66:67] op_sel:[0,0,0] op_sel_hi:[1,0,1] neg_lo:[0,1,0] neg_hi:[0,1,0]
  v_pk_mul_f32 v[64:65], v[64:65], v[116:117] op_sel:[0,1] op_sel_hi:[1,1]
  v_pk_mul_f32 v[66:67], v[66:67], v[116:117] op_sel:[0,1] op_sel_hi:[1,1]
  v_cvt_pk_bf16_f32 v136, v64, v65
  v_cvt_pk_bf16_f32 v137, v66, v67
  v_pk_fma_f32 v[80:81], v[124:125], v[116:117], v[80:81] op_sel:[0,0,0] op_sel_hi:[1,0,1] neg_lo:[0,1,0] neg_hi:[0,1,0]
  v_pk_fma_f32 v[82:83], v[126:127], v[116:117], v[82:83] op_sel:[0,0,0] op_sel_hi:[1,0,1] neg_lo:[0,1,0] neg_hi:[0,1,0]
  v_pk_mul_f32 v[80:81], v[80:81], v[116:117] op_sel:[0,1] op_sel_hi:[1,1]
  v_pk_mul_f32 v[82:83], v[82:83], v[116:117] op_sel:[0,1] op_sel_hi:[1,1]
  v_cvt_pk_bf16_f32 v138, v80, v81
  v_cvt_pk_bf16_f32 v139, v82, v83
  buffer_store_dwordx4 v[136:139], v147, s[40:43], 0 offen offset:0 sc1
  v_pk_fma_f32 v[68:69], v[120:121], v[118:119], v[68:69] op_sel:[0,0,0] op_sel_hi:[1,0,1] neg_lo:[0,1,0] neg_hi:[0,1,0]
  v_pk_fma_f32 v[70:71], v[122:123], v[118:119], v[70:71] op_sel:[0,0,0] op_sel_hi:[1,0,1] neg_lo:[0,1,0] neg_hi:[0,1,0]
  v_pk_mul_f32 v[68:69], v[68:69], v[118:119] op_sel:[0,1] op_sel_hi:[1,1]
  v_pk_mul_f32 v[70:71], v[70:71], v[118:119] op_sel:[0,1] op_sel_hi:[1,1]
  v_cvt_pk_bf16_f32 v140, v68, v69
  v_cvt_pk_bf16_f32 v141, v70, v71
  v_pk_fma_f32 v[84:85], v[124:125], v[118:119], v[84:85] op_sel:[0,0,0] op_sel_hi:[1,0,1] neg_lo:[0,1,0] neg_hi:[0,1,0]
  v_pk_fma_f32 v[86:87], v[126:127], v[118:119], v[86:87] op_sel:[0,0,0] op_sel_hi:[1,0,1] neg_lo:[0,1,0] neg_hi:[0,1,0]
  v_pk_mul_f32 v[84:85], v[84:85], v[118:119] op_sel:[0,1] op_sel_hi:[1,1]
  v_pk_mul_f32 v[86:87], v[86:87], v[118:119] op_sel:[0,1] op_sel_hi:[1,1]
  v_cvt_pk_bf16_f32 v142, v84, v85
  v_cvt_pk_bf16_f32 v143, v86, v87
  buffer_store_dwordx4 v[140:143], v147, s[40:43], 0 offen offset:256 sc1
L_postA_phF_kernel:
  s_load_dwordx2 s[6:7], s[0:1], 56
  s_and_b32 s13, s2, 7
  s_lshr_b32 s14, s2, 3
  s_lshr_b32 s12, s14, 4
  s_lshl_b32 s13, s13, 1
  s_add_u32 s12, s12, s13
  s_and_b32 s11, s14, 15
  s_and_b32 s14, s10, 1
  s_lshr_b32 s15, s10, 1
  s_waitcnt lgkmcnt(0)
  s_mov_b32 s20, s8
  s_and_b32 s21, s9, 0xffff
  s_mov_b32 s22, 7864320
  s_mov_b32 s23, 0x00020000
  v_lshlrev_b32 v7, 4, v0
  s_mul_i32 s16, s12, 5
  s_lshl_b32 s17, s11, 7
  s_sub_u32 s17, s17, 256
  s_lshl_b32 s17, s17, 4
  s_lshl_b32 s18, s10, 3
  s_add_u32 s18, s18, 0
  s_min_u32 s18, s18, 29
  s_mul_i32 s19, s18, 43
  s_lshr_b32 s19, s19, 8
  s_mul_i32 s26, s19, 6
  s_sub_u32 s26, s18, s26
  s_lshl_b32 s26, s26, 10
  s_mul_i32 s27, s19, 6208
  s_add_u32 s27, s27, s26
  s_add_u32 s40, s27, 0
  s_add_u32 s19, s19, s16
  s_add_u32 s19, s19, 80
  s_lshl_b32 s19, s19, 15
  s_add_u32 s26, s26, s17
  s_max_i32 s26, s26, 0
  s_add_u32 s41, s19, s26
  s_lshl_b32 s18, s10, 3
  s_add_u32 s18, s18, 1
  s_min_u32 s18, s18, 29
  s_mul_i32 s19, s18, 43
  s_lshr_b32 s19, s19, 8
  s_mul_i32 s26, s19, 6
  s_sub_u32 s26, s18, s26
  s_lshl_b32 s26, s26, 10
  s_mul_i32 s27, s19, 6208
  s_add_u32 s27, s27, s26
  s_add_u32 s42, s27, 0
  s_add_u32 s19, s19, s16
  s_add_u32 s19, s19, 80
  s_lshl_b32 s19, s19, 15
  s_add_u32 s26, s26, s17
  s_max_i32 s26, s26, 0
  s_add_u32 s43, s19, s26
  s_lshl_b32 s18, s10, 3
  s_add_u32 s18, s18, 2
  s_min_u32 s18, s18, 29
  s_mul_i32 s19, s18, 43
  s_lshr_b32 s19, s19, 8
  s_mul_i32 s26, s19, 6
  s_sub_u32 s26, s18, s26
  s_lshl_b32 s26, s26, 10
  s_mul_i32 s27, s19, 6208
  s_add_u32 s27, s27, s26
  s_add_u32 s44, s27, 0
  s_add_u32 s19, s19, s16
  s_add_u32 s19, s19, 80
  s_lshl_b32 s19, s19, 15
  s_add_u32 s26, s26, s17
  s_max_i32 s26, s26, 0
  s_add_u32 s45, s19, s26
  s_lshl_b32 s18, s10, 3
  s_add_u32 s18, s18, 3
  s_min_u32 s18, s18, 29
  s_mul_i32 s19, s18, 43
  s_lshr_b32 s19, s19, 8
  s_mul_i32 s26, s19, 6
  s_sub_u32 s26, s18, s26
  s_lshl_b32 s26, s26, 10
  s_mul_i32 s27, s19, 6208
  s_add_u32 s27, s27, s26
  s_add_u32 s46, s27, 0
  s_add_u32 s19, s19, s16
  s_add_u32 s19, s19, 80
  s_lshl_b32 s19, s19, 15
  s_add_u32 s26, s26, s17
  s_max_i32 s26, s26, 0
  s_add_u32 s47, s19, s26
  s_lshl_b32 s18, s10, 3
  s_add_u32 s18, s18, 4
  s_min_u32 s18, s18, 29
  s_mul_i32 s19, s18, 43
  s_lshr_b32 s19, s19, 8
  s_mul_i32 s26, s19, 6
  s_sub_u32 s26, s18, s26
  s_lshl_b32 s26, s26, 10
  s_mul_i32 s27, s19, 6208
  s_add_u32 s27, s27, s26
  s_add_u32 s48, s27, 0
  s_add_u32 s19, s19, s16
  s_add_u32 s19, s19, 80
  s_lshl_b32 s19, s19, 15
  s_add_u32 s26, s26, s17
  s_max_i32 s26, s26, 0
  s_add_u32 s49, s19, s26
  s_lshl_b32 s18, s10, 3
  s_add_u32 s18, s18, 5
  s_min_u32 s18, s18, 29
  s_mul_i32 s19, s18, 43
  s_lshr_b32 s19, s19, 8
  s_mul_i32 s26, s19, 6
  s_sub_u32 s26, s18, s26
  s_lshl_b32 s26, s26, 10
  s_mul_i32 s27, s19, 6208
  s_add_u32 s27, s27, s26
  s_add_u32 s50, s27, 0
  s_add_u32 s19, s19, s16
  s_add_u32 s19, s19, 80
  s_lshl_b32 s19, s19, 15
  s_add_u32 s26, s26, s17
  s_max_i32 s26, s26, 0
  s_add_u32 s51, s19, s26
  s_lshl_b32 s18, s10, 3
  s_add_u32 s18, s18, 6
  s_min_u32 s18, s18, 29
  s_mul_i32 s19, s18, 43
  s_lshr_b32 s19, s19, 8
  s_mul_i32 s26, s19, 6
  s_sub_u32 s26, s18, s26
  s_lshl_b32 s26, s26, 10
  s_mul_i32 s27, s19, 6208
  s_add_u32 s27, s27, s26
  s_add_u32 s52, s27, 0
  s_add_u32 s19, s19, s16
  s_add_u32 s19, s19, 80
  s_lshl_b32 s19, s19, 15
  s_add_u32 s26, s26, s17
  s_max_i32 s26, s26, 0
  s_add_u32 s53, s19, s26
  s_lshl_b32 s18, s10, 3
  s_add_u32 s18, s18, 7
  s_min_u32 s18, s18, 29
  s_mul_i32 s19, s18, 43
  s_lshr_b32 s19, s19, 8
  s_mul_i32 s26, s19, 6
  s_sub_u32 s26, s18, s26
  s_lshl_b32 s26, s26, 10
  s_mul_i32 s27, s19, 6208
  s_add_u32 s27, s27, s26
  s_add_u32 s54, s27, 0
  s_add_u32 s19, s19, s16
  s_add_u32 s19, s19, 80
  s_lshl_b32 s19, s19, 15
  s_add_u32 s26, s26, s17
  s_max_i32 s26, s26, 0
  s_add_u32 s55, s19, s26
  v_and_b32 v8, 31, v0
  v_lshrrev_b32 v9, 5, v0
  s_mul_i32 s18, s14, 3
  s_add_u32 s18, s18, s16
  v_add_u32 v10, s18, v9
  v_lshlrev_b32 v10, 15, v10
  s_lshl_b32 s19, s11, 1
  s_add_u32 s19, s19, s15
  s_lshl_b32 s19, s19, 10
  v_lshl_add_u32 v11, v8, 4, s19
  v_add_u32 v250, v10, v11
  s_add_u32 s18, s16, 2
  s_lshr_b32 s35, s18, 1
  s_and_b32 s35, s35, 1
  s_xor_b32 s35, s35, s14
  s_lshl_b32 s27, s18, 15
  s_lshl_b32 s28, s35, 3
  s_add_u32 s27, s27, s28
  v_add_u32 v251, s27, v11
  s_mul_i32 s18, s10, 100
  v_add_u32 v12, s18, v0
  s_lshl_b32 s19, s11, 7
  s_sub_u32 s19, 256, s19
  v_mov_b32 v220, 0x3f80
  v_mov_b32 v221, 0
  v_mov_b32 v223, 0
  v_mov_b32 v10, 0xf149
  v_cmp_gt_i32 vcc, s19, v12
  s_nop 1
  v_cndmask_b32 v222, 0, v10, vcc
  v_lshlrev_b32 v11, 4, v12
  ds_write_b128 v11, v[220:223] offset:62464
  v_add_u32 v12, 64, v12
  v_cmp_gt_i32 vcc, s19, v12
  s_nop 1
  v_cndmask_b32 v222, 0, v10, vcc
  v_lshlrev_b32 v11, 4, v12
  s_mov_b32 exec_lo, -1
  s_mov_b32 s30, -1
  s_mov_b32 s31, 0xf
  s_mov_b64 exec, s[30:31]
  ds_write_b128 v11, v[220:223] offset:62464
  s_mov_b64 exec, -1
  s_mul_i32 s18, s14, 3
  v_add_u32 v10, s18, v9
  v_mul_u32_u24 v10, 6208, v10
  s_lshl_b32 s19, s15, 10
  v_lshl_add_u32 v11, v8, 4, s19
  v_add_u32 v2, v10, v11
  s_lshl_b32 s28, s35, 3
  s_add_u32 s28, s28, 12416
  v_mov_b32 v10, s28
  v_mov_b32 v12, 62472
  v_cmp_eq_u32 vcc, 0, v9
  s_nop 1
  v_cndmask_b32 v10, v12, v10, vcc
  v_add_u32 v3, v10, v11
  v_and_b32 v10, 3, v0
  v_lshrrev_b32 v11, 2, v0
  v_and_b32 v11, 3, v11
  v_lshl_add_u32 v11, v9, 2, v11
  v_lshlrev_b32 v11, 4, v11
  v_add_u32 v11, s19, v11
  v_lshrrev_b32 v12, 1, v10
  s_mul_i32 s18, s14, 3
  v_add_u32 v12, s18, v12
  v_add_u32 v13, s16, v12
  v_lshrrev_b32 v13, 1, v13
  v_xor_b32 v13, v13, v10
  v_and_b32 v13, 1, v13
  v_mul_u32_u24 v12, 6208, v12
  v_lshl_add_u32 v12, v13, 3, v12
  v_add_u32 v12, 31232, v12
  s_lshl_b32 s28, s35, 3
  s_add_u32 s28, s28, 43648
  s_lshl_b32 s29, s14, 7
  s_sub_u32 s29, 62656, s29
  v_mov_b32 v13, s29
  v_mov_b32 v14, s28
  v_cmp_eq_u32 vcc, 0, v10
  s_nop 1
  v_cndmask_b32 v13, v13, v14, vcc
  v_bfe_u32 v14, v0, 4, 1
  v_cmp_eq_u32 vcc, 0, v14
  s_nop 1
  v_cndmask_b32 v12, v13, v12, vcc
  v_add_u32 v4, v12, v11
  v_lshlrev_b32 v10, 2, v9
  v_sub_u32 v10, v8, v10
  v_mov_b32 v11, 0xf149f2ca
  v_cmp_gt_i32 vcc, 0, v10
  s_nop 1
  v_cndmask_b32 v160, 0, -1, vcc
  v_cmp_gt_i32 vcc, 1, v10
  s_nop 1
  v_cndmask_b32 v161, 0, -1, vcc
  v_cmp_gt_i32 vcc, 2, v10
  s_nop 1
  v_cndmask_b32 v162, 0, -1, vcc
  v_cmp_gt_i32 vcc, 3, v10
  s_nop 1
  v_cndmask_b32 v163, 0, -1, vcc
  v_cmp_gt_i32 vcc, 8, v10
  s_nop 1
  v_cndmask_b32 v164, 0, -1, vcc
  v_cmp_gt_i32 vcc, 9, v10
  s_nop 1
  v_cndmask_b32 v165, 0, -1, vcc
  v_cmp_gt_i32 vcc, 10, v10
  s_nop 1
  v_cndmask_b32 v166, 0, -1, vcc
  v_cmp_gt_i32 vcc, 11, v10
  s_nop 1
  v_cndmask_b32 v167, 0, -1, vcc
  v_cmp_gt_i32 vcc, 16, v10
  s_nop 1
  v_cndmask_b32 v168, 0, -1, vcc
  v_cmp_gt_i32 vcc, 17, v10
  s_nop 1
  v_cndmask_b32 v169, 0, -1, vcc
  v_cmp_gt_i32 vcc, 18, v10
  s_nop 1
  v_cndmask_b32 v170, 0, -1, vcc
  v_cmp_gt_i32 vcc, 19, v10
  s_nop 1
  v_cndmask_b32 v171, 0, -1, vcc
  v_cmp_gt_i32 vcc, 24, v10
  s_nop 1
  v_cndmask_b32 v172, 0, -1, vcc
  v_cmp_gt_i32 vcc, 25, v10
  s_nop 1
  v_cndmask_b32 v173, 0, -1, vcc
  v_cmp_gt_i32 vcc, 26, v10
  s_nop 1
  v_cndmask_b32 v174, 0, -1, vcc
  v_cmp_gt_i32 vcc, 27, v10
  s_nop 1
  v_cndmask_b32 v175, 0, -1, vcc
  s_mov_b32 s36, 0xffff
  v_bfi_b32 v176, s36, v160, v161
  v_bfi_b32 v177, s36, v162, v163
  v_bfi_b32 v178, s36, v164, v165
  v_bfi_b32 v179, s36, v166, v167
  v_bfi_b32 v180, s36, v168, v169
  v_bfi_b32 v181, s36, v170, v171
  v_bfi_b32 v182, s36, v172, v173
  v_bfi_b32 v183, s36, v174, v175
  s_add_u32 s24, s8, 8388608
  s_addc_u32 s25, s9, 0
  s_and_b32 s25, s25, 0xffff
  s_mov_b32 s26, 2621440
  s_mov_b32 s27, 0x00020000
  s_lshl_b32 s18, s11, 1
  s_add_u32 s18, s18, s15
  s_lshl_b32 s18, s18, 2
  v_lshrrev_b32 v10, 4, v8
  v_add_u32 v10, s18, v10
  v_mul_u32_u24 v10, 20480, v10
  v_and_b32 v11, 15, v0
  v_lshl_add_u32 v10, v11, 4, v10
  s_lshl_b32 s18, s12, 10
  s_lshl_b32 s19, s14, 9
  s_add_u32 s18, s18, s19
  v_lshl_add_u32 v5, v9, 8, v10
  v_add_u32 v5, s18, v5
  s_lshr_b32 s18, s12, 2
  s_add_u32 s18, s18, 16
  s_lshl_b32 s18, s18, 10
  s_and_b32 s19, s12, 3
  s_lshl_b32 s19, s19, 8
  s_add_u32 s18, s18, s19
  s_lshl_b32 s19, s14, 3
  s_add_u32 s18, s18, s19
  v_add_u32 v6, s18, v10
  v_mov_b32 v11, 0x40000000
  v_cmp_eq_u32 vcc, 0, v9
  s_nop 1
  v_cndmask_b32 v6, v11, v6, vcc
  s_lshl_b32 s18, s15, 10
  s_lshl_b32 s19, s14, 3
  s_add_u32 s18, s18, s19
  s_add_u32 s18, s18, 155648
  v_lshl_add_u32 v6, v8, 4, s18
  s_mov_b32 s30, -1
  s_mov_b32 s31, 0
  s_waitcnt vmcnt(8)
  v_lshlrev_b32 v252, 4, v0
  s_waitcnt vmcnt(0)
  s_barrier
  s_barrier
  s_mov_b32 m0, s40
  s_nop 0
  buffer_load_dwordx4 v252, s[20:23], s41 offen lds
  s_mov_b32 m0, s42
  s_nop 0
  buffer_load_dwordx4 v252, s[20:23], s43 offen lds
  s_mov_b32 m0, s44
  s_nop 0
  buffer_load_dwordx4 v252, s[20:23], s45 offen lds
  s_mov_b32 m0, s46
  s_nop 0
  buffer_load_dwordx4 v252, s[20:23], s47 offen lds
  s_mov_b32 m0, s48
  s_nop 0
  buffer_load_dwordx4 v252, s[20:23], s49 offen lds
  s_mov_b32 m0, s50
  s_nop 0
  buffer_load_dwordx4 v252, s[20:23], s51 offen lds
  s_mov_b32 m0, s52
  s_nop 0
  buffer_load_dwordx4 v252, s[20:23], s53 offen lds
  s_mov_b32 m0, s54
  s_nop 0
  buffer_load_dwordx4 v252, s[20:23], s55 offen lds
  buffer_load_dwordx4 v[208:211], v250, s[20:23], 0 offen offset:0
  buffer_load_dwordx4 v[214:217], v250, s[20:23], 0 offen offset:512
  buffer_load_dwordx2 v[212:213], v251, s[20:23], 0 offen offset:0
  buffer_load_dwordx2 v[218:219], v251, s[20:23], 0 offen offset:512
  v_cmp_eq_u32 vcc, 0, v9
  s_waitcnt vmcnt(0)
  v_mov_b32 v11, 0x3f80
  v_cndmask_b32 v212, v11, v212, vcc
  v_cndmask_b32 v213, 0, v213, vcc
  v_cndmask_b32 v218, v11, v218, vcc
  v_cndmask_b32 v219, 0, v219, vcc
  s_waitcnt lgkmcnt(0)
  s_barrier
  ds_read_b128 v[220:223], v2 offset:0
  ds_read_b64 v[224:225], v3 offset:0
  s_waitcnt lgkmcnt(1)
  v_mfma_f32_32x32x16_bf16 v[16:31], v[220:223], v[208:211], 0
  ds_read_b128 v[226:229], v2 offset:512
  ds_read_b64 v[230:231], v3 offset:512
  s_waitcnt lgkmcnt(2)
  v_mfma_f32_32x32x8_bf16 v[16:31], v[224:225], v[212:213], v[16:31]
  s_waitcnt lgkmcnt(1)
  v_mfma_f32_32x32x16_bf16 v[32:47], v[226:229], v[208:211], 0
  ds_read_b128 v[220:223], v2 offset:1024
  ds_read_b64 v[224:225], v3 offset:1024
  s_waitcnt lgkmcnt(2)
  v_mfma_f32_32x32x8_bf16 v[32:47], v[230:231], v[212:213], v[32:47]
  s_waitcnt lgkmcnt(1)
  v_mfma_f32_32x32x16_bf16 v[48:63], v[220:223], v[208:211], 0
  ds_read_b128 v[226:229], v2 offset:1536
  ds_read_b64 v[230:231], v3 offset:1536
  s_waitcnt lgkmcnt(2)
  v_mfma_f32_32x32x8_bf16 v[48:63], v[224:225], v[212:213], v[48:63]
  s_waitcnt lgkmcnt(1)
  v_mfma_f32_32x32x16_bf16 v[64:79], v[226:229], v[208:211], 0
  ds_read_b128 v[220:223], v2 offset:2048
  ds_read_b64 v[224:225], v3 offset:2048
  s_nop 1
  v_max_f32 v248, v32, v33
  v_max_f32 v249, v34, v35
  v_max3_f32 v248, v36, v37, v248
  v_max3_f32 v249, v38, v39, v249
  s_waitcnt lgkmcnt(2)
  v_mfma_f32_32x32x8_bf16 v[64:79], v[230:231], v[212:213], v[64:79]
  v_max3_f32 v248, v40, v41, v248
  v_max3_f32 v249, v42, v43, v249
  v_max3_f32 v248, v44, v45, v248
  v_max3_f32 v249, v46, v47, v249
  s_waitcnt lgkmcnt(1)
  v_mfma_f32_32x32x16_bf16 v[80:95], v[220:223], v[208:211], 0
  ds_read_b128 v[226:229], v2 offset:2560
  ds_read_b64 v[230:231], v3 offset:2560
  v_max3_f32 v248, v48, v49, v248
  v_max3_f32 v249, v50, v51, v249
  v_max3_f32 v248, v52, v53, v248
  v_max3_f32 v249, v54, v55, v249
  s_waitcnt lgkmcnt(2)
  v_mfma_f32_32x32x8_bf16 v[80:95], v[224:225], v[212:213], v[80:95]
  v_max3_f32 v248, v56, v57, v248
  v_max3_f32 v249, v58, v59, v249
  v_max3_f32 v248, v60, v61, v248
  v_max3_f32 v249, v62, v63, v249
  s_waitcnt lgkmcnt(1)
  v_mfma_f32_32x32x16_bf16 v[96:111], v[226:229], v[208:211], 0
  ds_read_b128 v[220:223], v2 offset:3072
  ds_read_b64 v[224:225], v3 offset:3072
  v_max3_f32 v248, v64, v65, v248
  v_max3_f32 v249, v66, v67, v249
  v_max3_f32 v248, v68, v69, v248
  v_max3_f32 v249, v70, v71, v249
  s_waitcnt lgkmcnt(2)
  v_mfma_f32_32x32x8_bf16 v[96:111], v[230:231], v[212:213], v[96:111]
  v_max3_f32 v248, v72, v73, v248
  v_max3_f32 v249, v74, v75, v249
  v_max3_f32 v248, v76, v77, v248
  v_max3_f32 v249, v78, v79, v249
  s_waitcnt lgkmcnt(1)
  v_mfma_f32_32x32x16_bf16 v[112:127], v[220:223], v[208:211], 0
  ds_read_b128 v[226:229], v2 offset:3584
  ds_read_b64 v[230:231], v3 offset:3584
  v_max3_f32 v248, v80, v81, v248
  v_max3_f32 v249, v82, v83, v249
  v_max3_f32 v248, v84, v85, v248
  v_max3_f32 v249, v86, v87, v249
  s_waitcnt lgkmcnt(2)
  v_mfma_f32_32x32x8_bf16 v[112:127], v[224:225], v[212:213], v[112:127]
  v_max3_f32 v248, v88, v89, v248
  v_max3_f32 v249, v90, v91, v249
  v_max3_f32 v248, v92, v93, v248
  v_max3_f32 v249, v94, v95, v249
  s_waitcnt lgkmcnt(1)
  v_mfma_f32_32x32x16_bf16 v[128:143], v[226:229], v[208:211], 0
  ds_read_b128 v[220:223], v2 offset:4096
  ds_read_b64 v[224:225], v3 offset:4096
  v_max3_f32 v248, v96, v97, v248
  v_max3_f32 v249, v98, v99, v249
  v_max3_f32 v248, v100, v101, v248
  v_max3_f32 v249, v102, v103, v249
  s_waitcnt lgkmcnt(2)
  v_mfma_f32_32x32x8_bf16 v[128:143], v[230:231], v[212:213], v[128:143]
  v_max3_f32 v248, v104, v105, v248
  v_max3_f32 v249, v106, v107, v249
  v_max3_f32 v248, v108, v109, v248
  v_max3_f32 v249, v110, v111, v249
  s_waitcnt lgkmcnt(1)
  v_mfma_f32_32x32x16_bf16 v[144:159], v[220:223], v[208:211], 0
  v_max3_f32 v248, v112, v113, v248
  v_max3_f32 v249, v114, v115, v249
  v_max3_f32 v248, v116, v117, v248
  v_max3_f32 v249, v118, v119, v249
  s_waitcnt lgkmcnt(0)
  v_mfma_f32_32x32x8_bf16 v[144:159], v[224:225], v[212:213], v[144:159]
  v_max3_f32 v248, v120, v121, v248
  v_max3_f32 v249, v122, v123, v249
  v_max3_f32 v248, v124, v125, v248
  v_max3_f32 v249, v126, v127, v249
  s_barrier
  ds_read_b64_tr_b16 v[232:233], v4 offset:0
  ds_read_b64_tr_b16 v[234:235], v4 offset:128
  ds_read_b64_tr_b16 v[236:237], v4 offset:256
  ds_read_b64_tr_b16 v[238:239], v4 offset:384
  v_max3_f32 v248, v128, v129, v248
  v_max3_f32 v249, v130, v131, v249
  v_max3_f32 v248, v132, v133, v248
  v_max3_f32 v249, v134, v135, v249
  v_max3_f32 v248, v136, v137, v248
  v_max3_f32 v249, v138, v139, v249
  v_max3_f32 v248, v140, v141, v248
  v_max3_f32 v249, v142, v143, v249
  v_bfi_b32 v16, v160, v16, v144
  v_bfi_b32 v17, v161, v17, v145
  v_bfi_b32 v18, v162, v18, v146
  v_bfi_b32 v19, v163, v19, v147
  v_bfi_b32 v20, v164, v20, v148
  v_bfi_b32 v21, v165, v21, v149
  v_bfi_b32 v22, v166, v22, v150
  v_bfi_b32 v23, v167, v23, v151
  v_bfi_b32 v24, v168, v24, v152
  v_bfi_b32 v25, v169, v25, v153
  v_bfi_b32 v26, v170, v26, v154
  v_bfi_b32 v27, v171, v27, v155
  v_bfi_b32 v28, v172, v28, v156
  v_bfi_b32 v29, v173, v29, v157
  v_bfi_b32 v30, v174, v30, v158
  v_bfi_b32 v31, v175, v31, v159
  v_max3_f32 v248, v16, v17, v248
  v_max3_f32 v249, v18, v19, v249
  v_max3_f32 v248, v20, v21, v248
  v_max3_f32 v249, v22, v23, v249
  v_max3_f32 v248, v24, v25, v248
  v_max3_f32 v249, v26, v27, v249
  v_max3_f32 v248, v28, v29, v248
  v_max3_f32 v249, v30, v31, v249
  v_max_f32 v248, v248, v249
  v_mov_b32 v249, v248
  s_nop 1
  v_permlane32_swap_b32 v248, v249
  v_max_f32 v248, v248, v249
  v_pk_add_f32 v[16:17], v[16:17], v[248:249] op_sel_hi:[1,0] neg_lo:[0,1] neg_hi:[0,1]
  v_pk_add_f32 v[18:19], v[18:19], v[248:249] op_sel_hi:[1,0] neg_lo:[0,1] neg_hi:[0,1]
  v_pk_add_f32 v[20:21], v[20:21], v[248:249] op_sel_hi:[1,0] neg_lo:[0,1] neg_hi:[0,1]
  v_pk_add_f32 v[22:23], v[22:23], v[248:249] op_sel_hi:[1,0] neg_lo:[0,1] neg_hi:[0,1]
  v_exp_f32 v16, v16
  v_exp_f32 v17, v17
  v_exp_f32 v18, v18
  v_exp_f32 v19, v19
  v_exp_f32 v20, v20
  v_exp_f32 v21, v21
  v_exp_f32 v22, v22
  v_exp_f32 v23, v23
  v_cvt_pk_bf16_f32 v16, v16, v17
  v_cvt_pk_bf16_f32 v17, v18, v19
  v_cvt_pk_bf16_f32 v18, v20, v21
  v_cvt_pk_bf16_f32 v19, v22, v23
  v_bfi_b32 v144, v176, 0, v16
  v_bfi_b32 v145, v177, 0, v17
  v_bfi_b32 v146, v178, 0, v18
  v_bfi_b32 v147, v179, 0, v19
  v_and_b32 v16, v176, v16
  v_and_b32 v17, v177, v17
  v_and_b32 v18, v178, v18
  v_and_b32 v19, v179, v19
  v_pk_add_f32 v[24:25], v[24:25], v[248:249] op_sel_hi:[1,0] neg_lo:[0,1] neg_hi:[0,1]
  v_pk_add_f32 v[26:27], v[26:27], v[248:249] op_sel_hi:[1,0] neg_lo:[0,1] neg_hi:[0,1]
  v_pk_add_f32 v[28:29], v[28:29], v[248:249] op_sel_hi:[1,0] neg_lo:[0,1] neg_hi:[0,1]
  v_pk_add_f32 v[30:31], v[30:31], v[248:249] op_sel_hi:[1,0] neg_lo:[0,1] neg_hi:[0,1]
  s_waitcnt lgkmcnt(2)
  v_mfma_f32_32x32x16_bf16 v[192:207], v[232:235], v[16:19], 0
  ds_read_b64_tr_b16 v[240:241], v4 offset:512
  ds_read_b64_tr_b16 v[242:243], v4 offset:640
  v_exp_f32 v24, v24
  v_exp_f32 v25, v25
  v_exp_f32 v26, v26
  v_exp_f32 v27, v27
  v_exp_f32 v28, v28
  v_exp_f32 v29, v29
  v_exp_f32 v30, v30
  v_exp_f32 v31, v31
  v_cvt_pk_bf16_f32 v20, v24, v25
  v_cvt_pk_bf16_f32 v21, v26, v27
  v_cvt_pk_bf16_f32 v22, v28, v29
  v_cvt_pk_bf16_f32 v23, v30, v31
  v_bfi_b32 v148, v180, 0, v20
  v_bfi_b32 v149, v181, 0, v21
  v_bfi_b32 v150, v182, 0, v22
  v_bfi_b32 v151, v183, 0, v23
  v_and_b32 v20, v180, v20
  v_and_b32 v21, v181, v21
  v_and_b32 v22, v182, v22
  v_and_b32 v23, v183, v23
  v_pk_add_f32 v[32:33], v[32:33], v[248:249] op_sel_hi:[1,0] neg_lo:[0,1] neg_hi:[0,1]
  v_pk_add_f32 v[34:35], v[34:35], v[248:249] op_sel_hi:[1,0] neg_lo:[0,1] neg_hi:[0,1]
  v_pk_add_f32 v[36:37], v[36:37], v[248:249] op_sel_hi:[1,0] neg_lo:[0,1] neg_hi:[0,1]
  v_pk_add_f32 v[38:39], v[38:39], v[248:249] op_sel_hi:[1,0] neg_lo:[0,1] neg_hi:[0,1]
  s_waitcnt lgkmcnt(2)
  v_mfma_f32_32x32x16_bf16 v[192:207], v[236:239], v[20:23], v[192:207]
  ds_read_b64_tr_b16 v[244:245], v4 offset:768
  ds_read_b64_tr_b16 v[246:247], v4 offset:896
  v_exp_f32 v32, v32
  v_exp_f32 v33, v33
  v_exp_f32 v34, v34
  v_exp_f32 v35, v35
  v_exp_f32 v36, v36
  v_exp_f32 v37, v37
  v_exp_f32 v38, v38
  v_exp_f32 v39, v39
  v_cvt_pk_bf16_f32 v32, v32, v33
  v_cvt_pk_bf16_f32 v33, v34, v35
  v_cvt_pk_bf16_f32 v34, v36, v37
  v_cvt_pk_bf16_f32 v35, v38, v39
  v_pk_add_f32 v[40:41], v[40:41], v[248:249] op_sel_hi:[1,0] neg_lo:[0,1] neg_hi:[0,1]
  v_pk_add_f32 v[42:43], v[42:43], v[248:249] op_sel_hi:[1,0] neg_lo:[0,1] neg_hi:[0,1]
  v_pk_add_f32 v[44:45], v[44:45], v[248:249] op_sel_hi:[1,0] neg_lo:[0,1] neg_hi:[0,1]
  v_pk_add_f32 v[46:47], v[46:47], v[248:249] op_sel_hi:[1,0] neg_lo:[0,1] neg_hi:[0,1]
  s_waitcnt lgkmcnt(2)
  v_mfma_f32_32x32x16_bf16 v[192:207], v[240:243], v[32:35], v[192:207]
  ds_read_b64_tr_b16 v[232:233], v4 offset:1024
  ds_read_b64_tr_b16 v[234:235], v4 offset:1152
  v_exp_f32 v40, v40
  v_exp_f32 v41, v41
  v_exp_f32 v42, v42
  v_exp_f32 v43, v43
  v_exp_f32 v44, v44
  v_exp_f32 v45, v45
  v_exp_f32 v46, v46
  v_exp_f32 v47, v47
  v_cvt_pk_bf16_f32 v36, v40, v41
  v_cvt_pk_bf16_f32 v37, v42, v43
  v_cvt_pk_bf16_f32 v38, v44, v45
  v_cvt_pk_bf16_f32 v39, v46, v47
  v_pk_add_f32 v[48:49], v[48:49], v[248:249] op_sel_hi:[1,0] neg_lo:[0,1] neg_hi:[0,1]
  v_pk_add_f32 v[50:51], v[50:51], v[248:249] op_sel_hi:[1,0] neg_lo:[0,1] neg_hi:[0,1]
  v_pk_add_f32 v[52:53], v[52:53], v[248:249] op_sel_hi:[1,0] neg_lo:[0,1] neg_hi:[0,1]
  v_pk_add_f32 v[54:55], v[54:55], v[248:249] op_sel_hi:[1,0] neg_lo:[0,1] neg_hi:[0,1]
  s_waitcnt lgkmcnt(2)
  v_mfma_f32_32x32x16_bf16 v[192:207], v[244:247], v[36:39], v[192:207]
  ds_read_b64_tr_b16 v[236:237], v4 offset:1280
  ds_read_b64_tr_b16 v[238:239], v4 offset:1408
  v_exp_f32 v48, v48
  v_exp_f32 v49, v49
  v_exp_f32 v50, v50
  v_exp_f32 v51, v51
  v_exp_f32 v52, v52
  v_exp_f32 v53, v53
  v_exp_f32 v54, v54
  v_exp_f32 v55, v55
  v_cvt_pk_bf16_f32 v48, v48, v49
  v_cvt_pk_bf16_f32 v49, v50, v51
  v_cvt_pk_bf16_f32 v50, v52, v53
  v_cvt_pk_bf16_f32 v51, v54, v55
  v_pk_add_f32 v[56:57], v[56:57], v[248:249] op_sel_hi:[1,0] neg_lo:[0,1] neg_hi:[0,1]
  v_pk_add_f32 v[58:59], v[58:59], v[248:249] op_sel_hi:[1,0] neg_lo:[0,1] neg_hi:[0,1]
  v_pk_add_f32 v[60:61], v[60:61], v[248:249] op_sel_hi:[1,0] neg_lo:[0,1] neg_hi:[0,1]
  v_pk_add_f32 v[62:63], v[62:63], v[248:249] op_sel_hi:[1,0] neg_lo:[0,1] neg_hi:[0,1]
  s_waitcnt lgkmcnt(2)
  v_mfma_f32_32x32x16_bf16 v[192:207], v[232:235], v[48:51], v[192:207]
  ds_read_b64_tr_b16 v[240:241], v4 offset:1536
  ds_read_b64_tr_b16 v[242:243], v4 offset:1664
  v_exp_f32 v56, v56
  v_exp_f32 v57, v57
  v_exp_f32 v58, v58
  v_exp_f32 v59, v59
  v_exp_f32 v60, v60
  v_exp_f32 v61, v61
  v_exp_f32 v62, v62
  v_exp_f32 v63, v63
  v_cvt_pk_bf16_f32 v52, v56, v57
  v_cvt_pk_bf16_f32 v53, v58, v59
  v_cvt_pk_bf16_f32 v54, v60, v61
  v_cvt_pk_bf16_f32 v55, v62, v63
  v_pk_add_f32 v[64:65], v[64:65], v[248:249] op_sel_hi:[1,0] neg_lo:[0,1] neg_hi:[0,1]
  v_pk_add_f32 v[66:67], v[66:67], v[248:249] op_sel_hi:[1,0] neg_lo:[0,1] neg_hi:[0,1]
  v_pk_add_f32 v[68:69], v[68:69], v[248:249] op_sel_hi:[1,0] neg_lo:[0,1] neg_hi:[0,1]
  v_pk_add_f32 v[70:71], v[70:71], v[248:249] op_sel_hi:[1,0] neg_lo:[0,1] neg_hi:[0,1]
  s_waitcnt lgkmcnt(2)
  v_mfma_f32_32x32x16_bf16 v[192:207], v[236:239], v[52:55], v[192:207]
  ds_read_b64_tr_b16 v[244:245], v4 offset:1792
  ds_read_b64_tr_b16 v[246:247], v4 offset:1920
  v_exp_f32 v64, v64
  v_exp_f32 v65, v65
  v_exp_f32 v66, v66
  v_exp_f32 v67, v67
  v_exp_f32 v68, v68
  v_exp_f32 v69, v69
  v_exp_f32 v70, v70
  v_exp_f32 v71, v71
  v_cvt_pk_bf16_f32 v64, v64, v65
  v_cvt_pk_bf16_f32 v65, v66, v67
  v_cvt_pk_bf16_f32 v66, v68, v69
  v_cvt_pk_bf16_f32 v67, v70, v71
  v_pk_add_f32 v[72:73], v[72:73], v[248:249] op_sel_hi:[1,0] neg_lo:[0,1] neg_hi:[0,1]
  v_pk_add_f32 v[74:75], v[74:75], v[248:249] op_sel_hi:[1,0] neg_lo:[0,1] neg_hi:[0,1]
  v_pk_add_f32 v[76:77], v[76:77], v[248:249] op_sel_hi:[1,0] neg_lo:[0,1] neg_hi:[0,1]
  v_pk_add_f32 v[78:79], v[78:79], v[248:249] op_sel_hi:[1,0] neg_lo:[0,1] neg_hi:[0,1]
  s_waitcnt lgkmcnt(2)
  v_mfma_f32_32x32x16_bf16 v[192:207], v[240:243], v[64:67], v[192:207]
  ds_read_b64_tr_b16 v[232:233], v4 offset:2048
  ds_read_b64_tr_b16 v[234:235], v4 offset:2176
  v_exp_f32 v72, v72
  v_exp_f32 v73, v73
  v_exp_f32 v74, v74
  v_exp_f32 v75, v75
  v_exp_f32 v76, v76
  v_exp_f32 v77, v77
  v_exp_f32 v78, v78
  v_exp_f32 v79, v79
  v_cvt_pk_bf16_f32 v68, v72, v73
  v_cvt_pk_bf16_f32 v69, v74, v75
  v_cvt_pk_bf16_f32 v70, v76, v77
  v_cvt_pk_bf16_f32 v71, v78, v79
  v_pk_add_f32 v[80:81], v[80:81], v[248:249] op_sel_hi:[1,0] neg_lo:[0,1] neg_hi:[0,1]
  v_pk_add_f32 v[82:83], v[82:83], v[248:249] op_sel_hi:[1,0] neg_lo:[0,1] neg_hi:[0,1]
  v_pk_add_f32 v[84:85], v[84:85], v[248:249] op_sel_hi:[1,0] neg_lo:[0,1] neg_hi:[0,1]
  v_pk_add_f32 v[86:87], v[86:87], v[248:249] op_sel_hi:[1,0] neg_lo:[0,1] neg_hi:[0,1]
  s_waitcnt lgkmcnt(2)
  v_mfma_f32_32x32x16_bf16 v[192:207], v[244:247], v[68:71], v[192:207]
  ds_read_b64_tr_b16 v[236:237], v4 offset:2304
  ds_read_b64_tr_b16 v[238:239], v4 offset:2432
  v_exp_f32 v80, v80
  v_exp_f32 v81, v81
  v_exp_f32 v82, v82
  v_exp_f32 v83, v83
  v_exp_f32 v84, v84
  v_exp_f32 v85, v85
  v_exp_f32 v86, v86
  v_exp_f32 v87, v87
  v_cvt_pk_bf16_f32 v80, v80, v81
  v_cvt_pk_bf16_f32 v81, v82, v83
  v_cvt_pk_bf16_f32 v82, v84, v85
  v_cvt_pk_bf16_f32 v83, v86, v87
  v_pk_add_f32 v[88:89], v[88:89], v[248:249] op_sel_hi:[1,0] neg_lo:[0,1] neg_hi:[0,1]
  v_pk_add_f32 v[90:91], v[90:91], v[248:249] op_sel_hi:[1,0] neg_lo:[0,1] neg_hi:[0,1]
  v_pk_add_f32 v[92:93], v[92:93], v[248:249] op_sel_hi:[1,0] neg_lo:[0,1] neg_hi:[0,1]
  v_pk_add_f32 v[94:95], v[94:95], v[248:249] op_sel_hi:[1,0] neg_lo:[0,1] neg_hi:[0,1]
  s_waitcnt lgkmcnt(2)
  v_mfma_f32_32x32x16_bf16 v[192:207], v[232:235], v[80:83], v[192:207]
  ds_read_b64_tr_b16 v[240:241], v4 offset:2560
  ds_read_b64_tr_b16 v[242:243], v4 offset:2688
  v_exp_f32 v88, v88
  v_exp_f32 v89, v89
  v_exp_f32 v90, v90
  v_exp_f32 v91, v91
  v_exp_f32 v92, v92
  v_exp_f32 v93, v93
  v_exp_f32 v94, v94
  v_exp_f32 v95, v95
  v_cvt_pk_bf16_f32 v84, v88, v89
  v_cvt_pk_bf16_f32 v85, v90, v91
  v_cvt_pk_bf16_f32 v86, v92, v93
  v_cvt_pk_bf16_f32 v87, v94, v95
  v_pk_add_f32 v[96:97], v[96:97], v[248:249] op_sel_hi:[1,0] neg_lo:[0,1] neg_hi:[0,1]
  v_pk_add_f32 v[98:99], v[98:99], v[248:249] op_sel_hi:[1,0] neg_lo:[0,1] neg_hi:[0,1]
  v_pk_add_f32 v[100:101], v[100:101], v[248:249] op_sel_hi:[1,0] neg_lo:[0,1] neg_hi:[0,1]
  v_pk_add_f32 v[102:103], v[102:103], v[248:249] op_sel_hi:[1,0] neg_lo:[0,1] neg_hi:[0,1]
  s_waitcnt lgkmcnt(2)
  v_mfma_f32_32x32x16_bf16 v[192:207], v[236:239], v[84:87], v[192:207]
  ds_read_b64_tr_b16 v[244:245], v4 offset:2816
  ds_read_b64_tr_b16 v[246:247], v4 offset:2944
  v_exp_f32 v96, v96
  v_exp_f32 v97, v97
  v_exp_f32 v98, v98
  v_exp_f32 v99, v99
  v_exp_f32 v100, v100
  v_exp_f32 v101, v101
  v_exp_f32 v102, v102
  v_exp_f32 v103, v103
  v_cvt_pk_bf16_f32 v96, v96, v97
  v_cvt_pk_bf16_f32 v97, v98, v99
  v_cvt_pk_bf16_f32 v98, v100, v101
  v_cvt_pk_bf16_f32 v99, v102, v103
  v_pk_add_f32 v[104:105], v[104:105], v[248:249] op_sel_hi:[1,0] neg_lo:[0,1] neg_hi:[0,1]
  v_pk_add_f32 v[106:107], v[106:107], v[248:249] op_sel_hi:[1,0] neg_lo:[0,1] neg_hi:[0,1]
  v_pk_add_f32 v[108:109], v[108:109], v[248:249] op_sel_hi:[1,0] neg_lo:[0,1] neg_hi:[0,1]
  v_pk_add_f32 v[110:111], v[110:111], v[248:249] op_sel_hi:[1,0] neg_lo:[0,1] neg_hi:[0,1]
  s_waitcnt lgkmcnt(2)
  v_mfma_f32_32x32x16_bf16 v[192:207], v[240:243], v[96:99], v[192:207]
  ds_read_b64_tr_b16 v[232:233], v4 offset:3072
  ds_read_b64_tr_b16 v[234:235], v4 offset:3200
  v_exp_f32 v104, v104
  v_exp_f32 v105, v105
  v_exp_f32 v106, v106
  v_exp_f32 v107, v107
  v_exp_f32 v108, v108
  v_exp_f32 v109, v109
  v_exp_f32 v110, v110
  v_exp_f32 v111, v111
  v_cvt_pk_bf16_f32 v100, v104, v105
  v_cvt_pk_bf16_f32 v101, v106, v107
  v_cvt_pk_bf16_f32 v102, v108, v109
  v_cvt_pk_bf16_f32 v103, v110, v111
  v_pk_add_f32 v[112:113], v[112:113], v[248:249] op_sel_hi:[1,0] neg_lo:[0,1] neg_hi:[0,1]
  v_pk_add_f32 v[114:115], v[114:115], v[248:249] op_sel_hi:[1,0] neg_lo:[0,1] neg_hi:[0,1]
  v_pk_add_f32 v[116:117], v[116:117], v[248:249] op_sel_hi:[1,0] neg_lo:[0,1] neg_hi:[0,1]
  v_pk_add_f32 v[118:119], v[118:119], v[248:249] op_sel_hi:[1,0] neg_lo:[0,1] neg_hi:[0,1]
  s_waitcnt lgkmcnt(2)
  v_mfma_f32_32x32x16_bf16 v[192:207], v[244:247], v[100:103], v[192:207]
  ds_read_b64_tr_b16 v[236:237], v4 offset:3328
  ds_read_b64_tr_b16 v[238:239], v4 offset:3456
  v_exp_f32 v112, v112
  v_exp_f32 v113, v113
  v_exp_f32 v114, v114
  v_exp_f32 v115, v115
  v_exp_f32 v116, v116
  v_exp_f32 v117, v117
  v_exp_f32 v118, v118
  v_exp_f32 v119, v119
  v_cvt_pk_bf16_f32 v112, v112, v113
  v_cvt_pk_bf16_f32 v113, v114, v115
  v_cvt_pk_bf16_f32 v114, v116, v117
  v_cvt_pk_bf16_f32 v115, v118, v119
  v_pk_add_f32 v[120:121], v[120:121], v[248:249] op_sel_hi:[1,0] neg_lo:[0,1] neg_hi:[0,1]
  v_pk_add_f32 v[122:123], v[122:123], v[248:249] op_sel_hi:[1,0] neg_lo:[0,1] neg_hi:[0,1]
  v_pk_add_f32 v[124:125], v[124:125], v[248:249] op_sel_hi:[1,0] neg_lo:[0,1] neg_hi:[0,1]
  v_pk_add_f32 v[126:127], v[126:127], v[248:249] op_sel_hi:[1,0] neg_lo:[0,1] neg_hi:[0,1]
  s_waitcnt lgkmcnt(2)
  v_mfma_f32_32x32x16_bf16 v[192:207], v[232:235], v[112:115], v[192:207]
  ds_read_b64_tr_b16 v[240:241], v4 offset:3584
  ds_read_b64_tr_b16 v[242:243], v4 offset:3712
  v_exp_f32 v120, v120
  v_exp_f32 v121, v121
  v_exp_f32 v122, v122
  v_exp_f32 v123, v123
  v_exp_f32 v124, v124
  v_exp_f32 v125, v125
  v_exp_f32 v126, v126
  v_exp_f32 v127, v127
  v_cvt_pk_bf16_f32 v116, v120, v121
  v_cvt_pk_bf16_f32 v117, v122, v123
  v_cvt_pk_bf16_f32 v118, v124, v125
  v_cvt_pk_bf16_f32 v119, v126, v127
  v_pk_add_f32 v[128:129], v[128:129], v[248:249] op_sel_hi:[1,0] neg_lo:[0,1] neg_hi:[0,1]
  v_pk_add_f32 v[130:131], v[130:131], v[248:249] op_sel_hi:[1,0] neg_lo:[0,1] neg_hi:[0,1]
  v_pk_add_f32 v[132:133], v[132:133], v[248:249] op_sel_hi:[1,0] neg_lo:[0,1] neg_hi:[0,1]
  v_pk_add_f32 v[134:135], v[134:135], v[248:249] op_sel_hi:[1,0] neg_lo:[0,1] neg_hi:[0,1]
  s_waitcnt lgkmcnt(2)
  v_mfma_f32_32x32x16_bf16 v[192:207], v[236:239], v[116:119], v[192:207]
  ds_read_b64_tr_b16 v[244:245], v4 offset:3840
  ds_read_b64_tr_b16 v[246:247], v4 offset:3968
  v_exp_f32 v128, v128
  v_exp_f32 v129, v129
  v_exp_f32 v130, v130
  v_exp_f32 v131, v131
  v_exp_f32 v132, v132
  v_exp_f32 v133, v133
  v_exp_f32 v134, v134
  v_exp_f32 v135, v135
  v_cvt_pk_bf16_f32 v128, v128, v129
  v_cvt_pk_bf16_f32 v129, v130, v131
  v_cvt_pk_bf16_f32 v130, v132, v133
  v_cvt_pk_bf16_f32 v131, v134, v135
  v_pk_add_f32 v[136:137], v[136:137], v[248:249] op_sel_hi:[1,0] neg_lo:[0,1] neg_hi:[0,1]
  v_pk_add_f32 v[138:139], v[138:139], v[248:249] op_sel_hi:[1,0] neg_lo:[0,1] neg_hi:[0,1]
  v_pk_add_f32 v[140:141], v[140:141], v[248:249] op_sel_hi:[1,0] neg_lo:[0,1] neg_hi:[0,1]
  v_pk_add_f32 v[142:143], v[142:143], v[248:249] op_sel_hi:[1,0] neg_lo:[0,1] neg_hi:[0,1]
  s_waitcnt lgkmcnt(2)
  v_mfma_f32_32x32x16_bf16 v[192:207], v[240:243], v[128:131], v[192:207]
  ds_read_b64_tr_b16 v[232:233], v4 offset:4096
  ds_read_b64_tr_b16 v[234:235], v4 offset:4224
  v_exp_f32 v136, v136
  v_exp_f32 v137, v137
  v_exp_f32 v138, v138
  v_exp_f32 v139, v139
  v_exp_f32 v140, v140
  v_exp_f32 v141, v141
  v_exp_f32 v142, v142
  v_exp_f32 v143, v143
  v_cvt_pk_bf16_f32 v132, v136, v137
  v_cvt_pk_bf16_f32 v133, v138, v139
  v_cvt_pk_bf16_f32 v134, v140, v141
  v_cvt_pk_bf16_f32 v135, v142, v143
  s_waitcnt lgkmcnt(2)
  s_nop 0
  v_mfma_f32_32x32x16_bf16 v[192:207], v[244:247], v[132:135], v[192:207]
  ds_read_b64_tr_b16 v[236:237], v4 offset:4352
  ds_read_b64_tr_b16 v[238:239], v4 offset:4480
  s_waitcnt lgkmcnt(2)
  v_mfma_f32_32x32x16_bf16 v[192:207], v[232:235], v[144:147], v[192:207]
  s_waitcnt lgkmcnt(0)
  v_mfma_f32_32x32x16_bf16 v[192:207], v[236:239], v[148:151], v[192:207]
  ds_read_b128 v[220:223], v2 offset:512
  ds_read_b64 v[224:225], v3 offset:512
  s_waitcnt lgkmcnt(1)
  v_mfma_f32_32x32x16_bf16 v[16:31], v[220:223], v[214:217], 0
  ds_read_b128 v[226:229], v2 offset:1024
  ds_read_b64 v[230:231], v3 offset:1024
  s_waitcnt lgkmcnt(2)
  v_mfma_f32_32x32x8_bf16 v[16:31], v[224:225], v[218:219], v[16:31]
  s_waitcnt lgkmcnt(1)
  v_mfma_f32_32x32x16_bf16 v[32:47], v[226:229], v[214:217], 0
  ds_read_b128 v[220:223], v2 offset:1536
  ds_read_b64 v[224:225], v3 offset:1536
  s_waitcnt lgkmcnt(2)
  v_mfma_f32_32x32x8_bf16 v[32:47], v[230:231], v[218:219], v[32:47]
  v_rcp_f32 v15, v204
  s_nop 0
  v_mul_f32 v192, v192, v15
  v_mul_f32 v193, v193, v15
  v_mul_f32 v194, v194, v15
  s_waitcnt lgkmcnt(1)
  v_mfma_f32_32x32x16_bf16 v[48:63], v[220:223], v[214:217], 0
  ds_read_b128 v[226:229], v2 offset:2048
  ds_read_b64 v[230:231], v3 offset:2048
  s_waitcnt lgkmcnt(2)
  v_mfma_f32_32x32x8_bf16 v[48:63], v[224:225], v[218:219], v[48:63]
  v_mul_f32 v195, v195, v15
  v_mul_f32 v196, v196, v15
  v_mul_f32 v197, v197, v15
  v_mul_f32 v198, v198, v15
  s_waitcnt lgkmcnt(1)
  v_mfma_f32_32x32x16_bf16 v[64:79], v[226:229], v[214:217], 0
  ds_read_b128 v[220:223], v2 offset:2560
  ds_read_b64 v[224:225], v3 offset:2560
  v_max_f32 v248, v32, v33
  v_max_f32 v249, v34, v35
  v_max3_f32 v248, v36, v37, v248
  v_max3_f32 v249, v38, v39, v249
  s_waitcnt lgkmcnt(2)
  v_mfma_f32_32x32x8_bf16 v[64:79], v[230:231], v[218:219], v[64:79]
  v_max3_f32 v248, v40, v41, v248
  v_max3_f32 v249, v42, v43, v249
  v_max3_f32 v248, v44, v45, v248
  v_max3_f32 v249, v46, v47, v249
  v_mul_f32 v199, v199, v15
  v_mul_f32 v200, v200, v15
  v_mul_f32 v201, v201, v15
  v_mul_f32 v202, v202, v15
  s_waitcnt lgkmcnt(1)
  v_mfma_f32_32x32x16_bf16 v[80:95], v[220:223], v[214:217], 0
  ds_read_b128 v[226:229], v2 offset:3072
  ds_read_b64 v[230:231], v3 offset:3072
  v_max3_f32 v248, v48, v49, v248
  v_max3_f32 v249, v50, v51, v249
  v_max3_f32 v248, v52, v53, v248
  v_max3_f32 v249, v54, v55, v249
  s_waitcnt lgkmcnt(2)
  v_mfma_f32_32x32x8_bf16 v[80:95], v[224:225], v[218:219], v[80:95]
  v_max3_f32 v248, v56, v57, v248
  v_max3_f32 v249, v58, v59, v249
  v_max3_f32 v248, v60, v61, v248
  v_max3_f32 v249, v62, v63, v249
  v_mul_f32 v203, v203, v15
  v_cvt_pk_bf16_f32 v192, v192, v193
  v_cvt_pk_bf16_f32 v193, v194, v195
  v_cvt_pk_bf16_f32 v194, v196, v197
  s_waitcnt lgkmcnt(1)
  v_mfma_f32_32x32x16_bf16 v[96:111], v[226:229], v[214:217], 0
  ds_read_b128 v[220:223], v2 offset:3584
  ds_read_b64 v[224:225], v3 offset:3584
  v_max3_f32 v248, v64, v65, v248
  v_max3_f32 v249, v66, v67, v249
  v_max3_f32 v248, v68, v69, v248
  v_max3_f32 v249, v70, v71, v249
  s_waitcnt lgkmcnt(2)
  v_mfma_f32_32x32x8_bf16 v[96:111], v[230:231], v[218:219], v[96:111]
  v_max3_f32 v248, v72, v73, v248
  v_max3_f32 v249, v74, v75, v249
  v_max3_f32 v248, v76, v77, v248
  v_max3_f32 v249, v78, v79, v249
  v_cvt_pk_bf16_f32 v195, v198, v199
  v_cvt_pk_bf16_f32 v196, v200, v201
  v_cvt_pk_bf16_f32 v197, v202, v203
  s_mov_b32 s34, 40960
  s_waitcnt lgkmcnt(1)
  v_mfma_f32_32x32x16_bf16 v[112:127], v[220:223], v[214:217], 0
  ds_read_b128 v[226:229], v2 offset:4096
  ds_read_b64 v[230:231], v3 offset:4096
  v_max3_f32 v248, v80, v81, v248
  v_max3_f32 v249, v82, v83, v249
  v_max3_f32 v248, v84, v85, v248
  v_max3_f32 v249, v86, v87, v249
  s_waitcnt lgkmcnt(2)
  v_mfma_f32_32x32x8_bf16 v[112:127], v[224:225], v[218:219], v[112:127]
  v_max3_f32 v248, v88, v89, v248
  v_max3_f32 v249, v90, v91, v249
  v_max3_f32 v248, v92, v93, v248
  v_max3_f32 v249, v94, v95, v249
  buffer_store_dwordx4 v[192:195], v5, s[24:27], 0 offen sc1
  s_mov_b64 exec, s[30:31]
  ds_write_b64 v6, v[196:197] offset:0
  s_mov_b64 exec, -1
  s_waitcnt lgkmcnt(2)
  v_mfma_f32_32x32x16_bf16 v[128:143], v[226:229], v[214:217], 0
  ds_read_b128 v[220:223], v2 offset:4608
  ds_read_b64 v[224:225], v3 offset:4608
  v_max3_f32 v248, v96, v97, v248
  v_max3_f32 v249, v98, v99, v249
  v_max3_f32 v248, v100, v101, v248
  v_max3_f32 v249, v102, v103, v249
  s_waitcnt lgkmcnt(3)
  v_mfma_f32_32x32x8_bf16 v[128:143], v[230:231], v[218:219], v[128:143]
  v_max3_f32 v248, v104, v105, v248
  v_max3_f32 v249, v106, v107, v249
  v_max3_f32 v248, v108, v109, v248
  v_max3_f32 v249, v110, v111, v249
  s_waitcnt lgkmcnt(1)
  v_mfma_f32_32x32x16_bf16 v[144:159], v[220:223], v[214:217], 0
  v_max3_f32 v248, v112, v113, v248
  v_max3_f32 v249, v114, v115, v249
  v_max3_f32 v248, v116, v117, v248
  v_max3_f32 v249, v118, v119, v249
  s_waitcnt lgkmcnt(0)
  v_mfma_f32_32x32x8_bf16 v[144:159], v[224:225], v[218:219], v[144:159]
  v_max3_f32 v248, v120, v121, v248
  v_max3_f32 v249, v122, v123, v249
  v_max3_f32 v248, v124, v125, v248
  v_max3_f32 v249, v126, v127, v249
  ds_read_b64_tr_b16 v[232:233], v4 offset:512
  ds_read_b64_tr_b16 v[234:235], v4 offset:640
  ds_read_b64_tr_b16 v[236:237], v4 offset:768
  ds_read_b64_tr_b16 v[238:239], v4 offset:896
  v_max3_f32 v248, v128, v129, v248
  v_max3_f32 v249, v130, v131, v249
  v_max3_f32 v248, v132, v133, v248
  v_max3_f32 v249, v134, v135, v249
  v_max3_f32 v248, v136, v137, v248
  v_max3_f32 v249, v138, v139, v249
  v_max3_f32 v248, v140, v141, v248
  v_max3_f32 v249, v142, v143, v249
  v_bfi_b32 v16, v160, v16, v144
  v_bfi_b32 v17, v161, v17, v145
  v_bfi_b32 v18, v162, v18, v146
  v_bfi_b32 v19, v163, v19, v147
  v_bfi_b32 v20, v164, v20, v148
  v_bfi_b32 v21, v165, v21, v149
  v_bfi_b32 v22, v166, v22, v150
  v_bfi_b32 v23, v167, v23, v151
  v_bfi_b32 v24, v168, v24, v152
  v_bfi_b32 v25, v169, v25, v153
  v_bfi_b32 v26, v170, v26, v154
  v_bfi_b32 v27, v171, v27, v155
  v_bfi_b32 v28, v172, v28, v156
  v_bfi_b32 v29, v173, v29, v157
  v_bfi_b32 v30, v174, v30, v158
  v_bfi_b32 v31, v175, v31, v159
  v_max3_f32 v248, v16, v17, v248
  v_max3_f32 v249, v18, v19, v249
  v_max3_f32 v248, v20, v21, v248
  v_max3_f32 v249, v22, v23, v249
  v_max3_f32 v248, v24, v25, v248
  v_max3_f32 v249, v26, v27, v249
  v_max3_f32 v248, v28, v29, v248
  v_max3_f32 v249, v30, v31, v249
  v_max_f32 v248, v248, v249
  v_mov_b32 v249, v248
  s_nop 1
  v_permlane32_swap_b32 v248, v249
  v_max_f32 v248, v248, v249
  v_pk_add_f32 v[16:17], v[16:17], v[248:249] op_sel_hi:[1,0] neg_lo:[0,1] neg_hi:[0,1]
  v_pk_add_f32 v[18:19], v[18:19], v[248:249] op_sel_hi:[1,0] neg_lo:[0,1] neg_hi:[0,1]
  v_pk_add_f32 v[20:21], v[20:21], v[248:249] op_sel_hi:[1,0] neg_lo:[0,1] neg_hi:[0,1]
  v_pk_add_f32 v[22:23], v[22:23], v[248:249] op_sel_hi:[1,0] neg_lo:[0,1] neg_hi:[0,1]
  v_exp_f32 v16, v16
  v_exp_f32 v17, v17
  v_exp_f32 v18, v18
  v_exp_f32 v19, v19
  v_exp_f32 v20, v20
  v_exp_f32 v21, v21
  v_exp_f32 v22, v22
  v_exp_f32 v23, v23
  v_cvt_pk_bf16_f32 v16, v16, v17
  v_cvt_pk_bf16_f32 v17, v18, v19
  v_cvt_pk_bf16_f32 v18, v20, v21
  v_cvt_pk_bf16_f32 v19, v22, v23
  v_bfi_b32 v144, v176, 0, v16
  v_bfi_b32 v145, v177, 0, v17
  v_bfi_b32 v146, v178, 0, v18
  v_bfi_b32 v147, v179, 0, v19
  v_and_b32 v16, v176, v16
  v_and_b32 v17, v177, v17
  v_and_b32 v18, v178, v18
  v_and_b32 v19, v179, v19
  v_pk_add_f32 v[24:25], v[24:25], v[248:249] op_sel_hi:[1,0] neg_lo:[0,1] neg_hi:[0,1]
  v_pk_add_f32 v[26:27], v[26:27], v[248:249] op_sel_hi:[1,0] neg_lo:[0,1] neg_hi:[0,1]
  v_pk_add_f32 v[28:29], v[28:29], v[248:249] op_sel_hi:[1,0] neg_lo:[0,1] neg_hi:[0,1]
  v_pk_add_f32 v[30:31], v[30:31], v[248:249] op_sel_hi:[1,0] neg_lo:[0,1] neg_hi:[0,1]
  s_waitcnt lgkmcnt(2)
  v_mfma_f32_32x32x16_bf16 v[192:207], v[232:235], v[16:19], 0
  ds_read_b64_tr_b16 v[240:241], v4 offset:1024
  ds_read_b64_tr_b16 v[242:243], v4 offset:1152
  v_exp_f32 v24, v24
  v_exp_f32 v25, v25
  v_exp_f32 v26, v26
  v_exp_f32 v27, v27
  v_exp_f32 v28, v28
  v_exp_f32 v29, v29
  v_exp_f32 v30, v30
  v_exp_f32 v31, v31
  v_cvt_pk_bf16_f32 v20, v24, v25
  v_cvt_pk_bf16_f32 v21, v26, v27
  v_cvt_pk_bf16_f32 v22, v28, v29
  v_cvt_pk_bf16_f32 v23, v30, v31
  v_bfi_b32 v148, v180, 0, v20
  v_bfi_b32 v149, v181, 0, v21
  v_bfi_b32 v150, v182, 0, v22
  v_bfi_b32 v151, v183, 0, v23
  v_and_b32 v20, v180, v20
  v_and_b32 v21, v181, v21
  v_and_b32 v22, v182, v22
  v_and_b32 v23, v183, v23
  v_pk_add_f32 v[32:33], v[32:33], v[248:249] op_sel_hi:[1,0] neg_lo:[0,1] neg_hi:[0,1]
  v_pk_add_f32 v[34:35], v[34:35], v[248:249] op_sel_hi:[1,0] neg_lo:[0,1] neg_hi:[0,1]
  v_pk_add_f32 v[36:37], v[36:37], v[248:249] op_sel_hi:[1,0] neg_lo:[0,1] neg_hi:[0,1]
  v_pk_add_f32 v[38:39], v[38:39], v[248:249] op_sel_hi:[1,0] neg_lo:[0,1] neg_hi:[0,1]
  s_waitcnt lgkmcnt(2)
  v_mfma_f32_32x32x16_bf16 v[192:207], v[236:239], v[20:23], v[192:207]
  ds_read_b64_tr_b16 v[244:245], v4 offset:1280
  ds_read_b64_tr_b16 v[246:247], v4 offset:1408
  v_exp_f32 v32, v32
  v_exp_f32 v33, v33
  v_exp_f32 v34, v34
  v_exp_f32 v35, v35
  v_exp_f32 v36, v36
  v_exp_f32 v37, v37
  v_exp_f32 v38, v38
  v_exp_f32 v39, v39
  v_cvt_pk_bf16_f32 v32, v32, v33
  v_cvt_pk_bf16_f32 v33, v34, v35
  v_cvt_pk_bf16_f32 v34, v36, v37
  v_cvt_pk_bf16_f32 v35, v38, v39
  v_pk_add_f32 v[40:41], v[40:41], v[248:249] op_sel_hi:[1,0] neg_lo:[0,1] neg_hi:[0,1]
  v_pk_add_f32 v[42:43], v[42:43], v[248:249] op_sel_hi:[1,0] neg_lo:[0,1] neg_hi:[0,1]
  v_pk_add_f32 v[44:45], v[44:45], v[248:249] op_sel_hi:[1,0] neg_lo:[0,1] neg_hi:[0,1]
  v_pk_add_f32 v[46:47], v[46:47], v[248:249] op_sel_hi:[1,0] neg_lo:[0,1] neg_hi:[0,1]
  s_waitcnt lgkmcnt(2)
  v_mfma_f32_32x32x16_bf16 v[192:207], v[240:243], v[32:35], v[192:207]
  ds_read_b64_tr_b16 v[232:233], v4 offset:1536
  ds_read_b64_tr_b16 v[234:235], v4 offset:1664
  v_exp_f32 v40, v40
  v_exp_f32 v41, v41
  v_exp_f32 v42, v42
  v_exp_f32 v43, v43
  v_exp_f32 v44, v44
  v_exp_f32 v45, v45
  v_exp_f32 v46, v46
  v_exp_f32 v47, v47
  v_cvt_pk_bf16_f32 v36, v40, v41
  v_cvt_pk_bf16_f32 v37, v42, v43
  v_cvt_pk_bf16_f32 v38, v44, v45
  v_cvt_pk_bf16_f32 v39, v46, v47
  v_pk_add_f32 v[48:49], v[48:49], v[248:249] op_sel_hi:[1,0] neg_lo:[0,1] neg_hi:[0,1]
  v_pk_add_f32 v[50:51], v[50:51], v[248:249] op_sel_hi:[1,0] neg_lo:[0,1] neg_hi:[0,1]
  v_pk_add_f32 v[52:53], v[52:53], v[248:249] op_sel_hi:[1,0] neg_lo:[0,1] neg_hi:[0,1]
  v_pk_add_f32 v[54:55], v[54:55], v[248:249] op_sel_hi:[1,0] neg_lo:[0,1] neg_hi:[0,1]
  s_waitcnt lgkmcnt(2)
  v_mfma_f32_32x32x16_bf16 v[192:207], v[244:247], v[36:39], v[192:207]
  ds_read_b64_tr_b16 v[236:237], v4 offset:1792
  ds_read_b64_tr_b16 v[238:239], v4 offset:1920
  v_exp_f32 v48, v48
  v_exp_f32 v49, v49
  v_exp_f32 v50, v50
  v_exp_f32 v51, v51
  v_exp_f32 v52, v52
  v_exp_f32 v53, v53
  v_exp_f32 v54, v54
  v_exp_f32 v55, v55
  v_cvt_pk_bf16_f32 v48, v48, v49
  v_cvt_pk_bf16_f32 v49, v50, v51
  v_cvt_pk_bf16_f32 v50, v52, v53
  v_cvt_pk_bf16_f32 v51, v54, v55
  v_pk_add_f32 v[56:57], v[56:57], v[248:249] op_sel_hi:[1,0] neg_lo:[0,1] neg_hi:[0,1]
  v_pk_add_f32 v[58:59], v[58:59], v[248:249] op_sel_hi:[1,0] neg_lo:[0,1] neg_hi:[0,1]
  v_pk_add_f32 v[60:61], v[60:61], v[248:249] op_sel_hi:[1,0] neg_lo:[0,1] neg_hi:[0,1]
  v_pk_add_f32 v[62:63], v[62:63], v[248:249] op_sel_hi:[1,0] neg_lo:[0,1] neg_hi:[0,1]
  s_waitcnt lgkmcnt(2)
  v_mfma_f32_32x32x16_bf16 v[192:207], v[232:235], v[48:51], v[192:207]
  ds_read_b64_tr_b16 v[240:241], v4 offset:2048
  ds_read_b64_tr_b16 v[242:243], v4 offset:2176
  v_exp_f32 v56, v56
  v_exp_f32 v57, v57
  v_exp_f32 v58, v58
  v_exp_f32 v59, v59
  v_exp_f32 v60, v60
  v_exp_f32 v61, v61
  v_exp_f32 v62, v62
  v_exp_f32 v63, v63
  v_cvt_pk_bf16_f32 v52, v56, v57
  v_cvt_pk_bf16_f32 v53, v58, v59
  v_cvt_pk_bf16_f32 v54, v60, v61
  v_cvt_pk_bf16_f32 v55, v62, v63
  v_pk_add_f32 v[64:65], v[64:65], v[248:249] op_sel_hi:[1,0] neg_lo:[0,1] neg_hi:[0,1]
  v_pk_add_f32 v[66:67], v[66:67], v[248:249] op_sel_hi:[1,0] neg_lo:[0,1] neg_hi:[0,1]
  v_pk_add_f32 v[68:69], v[68:69], v[248:249] op_sel_hi:[1,0] neg_lo:[0,1] neg_hi:[0,1]
  v_pk_add_f32 v[70:71], v[70:71], v[248:249] op_sel_hi:[1,0] neg_lo:[0,1] neg_hi:[0,1]
  s_waitcnt lgkmcnt(2)
  v_mfma_f32_32x32x16_bf16 v[192:207], v[236:239], v[52:55], v[192:207]
  ds_read_b64_tr_b16 v[244:245], v4 offset:2304
  ds_read_b64_tr_b16 v[246:247], v4 offset:2432
  v_exp_f32 v64, v64
  v_exp_f32 v65, v65
  v_exp_f32 v66, v66
  v_exp_f32 v67, v67
  v_exp_f32 v68, v68
  v_exp_f32 v69, v69
  v_exp_f32 v70, v70
  v_exp_f32 v71, v71
  v_cvt_pk_bf16_f32 v64, v64, v65
  v_cvt_pk_bf16_f32 v65, v66, v67
  v_cvt_pk_bf16_f32 v66, v68, v69
  v_cvt_pk_bf16_f32 v67, v70, v71
  v_pk_add_f32 v[72:73], v[72:73], v[248:249] op_sel_hi:[1,0] neg_lo:[0,1] neg_hi:[0,1]
  v_pk_add_f32 v[74:75], v[74:75], v[248:249] op_sel_hi:[1,0] neg_lo:[0,1] neg_hi:[0,1]
  v_pk_add_f32 v[76:77], v[76:77], v[248:249] op_sel_hi:[1,0] neg_lo:[0,1] neg_hi:[0,1]
  v_pk_add_f32 v[78:79], v[78:79], v[248:249] op_sel_hi:[1,0] neg_lo:[0,1] neg_hi:[0,1]
  s_waitcnt lgkmcnt(2)
  v_mfma_f32_32x32x16_bf16 v[192:207], v[240:243], v[64:67], v[192:207]
  ds_read_b64_tr_b16 v[232:233], v4 offset:2560
  ds_read_b64_tr_b16 v[234:235], v4 offset:2688
  v_exp_f32 v72, v72
  v_exp_f32 v73, v73
  v_exp_f32 v74, v74
  v_exp_f32 v75, v75
  v_exp_f32 v76, v76
  v_exp_f32 v77, v77
  v_exp_f32 v78, v78
  v_exp_f32 v79, v79
  v_cvt_pk_bf16_f32 v68, v72, v73
  v_cvt_pk_bf16_f32 v69, v74, v75
  v_cvt_pk_bf16_f32 v70, v76, v77
  v_cvt_pk_bf16_f32 v71, v78, v79
  v_pk_add_f32 v[80:81], v[80:81], v[248:249] op_sel_hi:[1,0] neg_lo:[0,1] neg_hi:[0,1]
  v_pk_add_f32 v[82:83], v[82:83], v[248:249] op_sel_hi:[1,0] neg_lo:[0,1] neg_hi:[0,1]
  v_pk_add_f32 v[84:85], v[84:85], v[248:249] op_sel_hi:[1,0] neg_lo:[0,1] neg_hi:[0,1]
  v_pk_add_f32 v[86:87], v[86:87], v[248:249] op_sel_hi:[1,0] neg_lo:[0,1] neg_hi:[0,1]
  s_waitcnt lgkmcnt(2)
  v_mfma_f32_32x32x16_bf16 v[192:207], v[244:247], v[68:71], v[192:207]
  ds_read_b64_tr_b16 v[236:237], v4 offset:2816
  ds_read_b64_tr_b16 v[238:239], v4 offset:2944
  v_exp_f32 v80, v80
  v_exp_f32 v81, v81
  v_exp_f32 v82, v82
  v_exp_f32 v83, v83
  v_exp_f32 v84, v84
  v_exp_f32 v85, v85
  v_exp_f32 v86, v86
  v_exp_f32 v87, v87
  v_cvt_pk_bf16_f32 v80, v80, v81
  v_cvt_pk_bf16_f32 v81, v82, v83
  v_cvt_pk_bf16_f32 v82, v84, v85
  v_cvt_pk_bf16_f32 v83, v86, v87
  v_pk_add_f32 v[88:89], v[88:89], v[248:249] op_sel_hi:[1,0] neg_lo:[0,1] neg_hi:[0,1]
  v_pk_add_f32 v[90:91], v[90:91], v[248:249] op_sel_hi:[1,0] neg_lo:[0,1] neg_hi:[0,1]
  v_pk_add_f32 v[92:93], v[92:93], v[248:249] op_sel_hi:[1,0] neg_lo:[0,1] neg_hi:[0,1]
  v_pk_add_f32 v[94:95], v[94:95], v[248:249] op_sel_hi:[1,0] neg_lo:[0,1] neg_hi:[0,1]
  s_waitcnt lgkmcnt(2)
  v_mfma_f32_32x32x16_bf16 v[192:207], v[232:235], v[80:83], v[192:207]
  ds_read_b64_tr_b16 v[240:241], v4 offset:3072
  ds_read_b64_tr_b16 v[242:243], v4 offset:3200
  v_exp_f32 v88, v88
  v_exp_f32 v89, v89
  v_exp_f32 v90, v90
  v_exp_f32 v91, v91
  v_exp_f32 v92, v92
  v_exp_f32 v93, v93
  v_exp_f32 v94, v94
  v_exp_f32 v95, v95
  v_cvt_pk_bf16_f32 v84, v88, v89
  v_cvt_pk_bf16_f32 v85, v90, v91
  v_cvt_pk_bf16_f32 v86, v92, v93
  v_cvt_pk_bf16_f32 v87, v94, v95
  v_pk_add_f32 v[96:97], v[96:97], v[248:249] op_sel_hi:[1,0] neg_lo:[0,1] neg_hi:[0,1]
  v_pk_add_f32 v[98:99], v[98:99], v[248:249] op_sel_hi:[1,0] neg_lo:[0,1] neg_hi:[0,1]
  v_pk_add_f32 v[100:101], v[100:101], v[248:249] op_sel_hi:[1,0] neg_lo:[0,1] neg_hi:[0,1]
  v_pk_add_f32 v[102:103], v[102:103], v[248:249] op_sel_hi:[1,0] neg_lo:[0,1] neg_hi:[0,1]
  s_waitcnt lgkmcnt(2)
  v_mfma_f32_32x32x16_bf16 v[192:207], v[236:239], v[84:87], v[192:207]
  ds_read_b64_tr_b16 v[244:245], v4 offset:3328
  ds_read_b64_tr_b16 v[246:247], v4 offset:3456
  v_exp_f32 v96, v96
  v_exp_f32 v97, v97
  v_exp_f32 v98, v98
  v_exp_f32 v99, v99
  v_exp_f32 v100, v100
  v_exp_f32 v101, v101
  v_exp_f32 v102, v102
  v_exp_f32 v103, v103
  v_cvt_pk_bf16_f32 v96, v96, v97
  v_cvt_pk_bf16_f32 v97, v98, v99
  v_cvt_pk_bf16_f32 v98, v100, v101
  v_cvt_pk_bf16_f32 v99, v102, v103
  v_pk_add_f32 v[104:105], v[104:105], v[248:249] op_sel_hi:[1,0] neg_lo:[0,1] neg_hi:[0,1]
  v_pk_add_f32 v[106:107], v[106:107], v[248:249] op_sel_hi:[1,0] neg_lo:[0,1] neg_hi:[0,1]
  v_pk_add_f32 v[108:109], v[108:109], v[248:249] op_sel_hi:[1,0] neg_lo:[0,1] neg_hi:[0,1]
  v_pk_add_f32 v[110:111], v[110:111], v[248:249] op_sel_hi:[1,0] neg_lo:[0,1] neg_hi:[0,1]
  s_waitcnt lgkmcnt(2)
  v_mfma_f32_32x32x16_bf16 v[192:207], v[240:243], v[96:99], v[192:207]
  ds_read_b64_tr_b16 v[232:233], v4 offset:3584
  ds_read_b64_tr_b16 v[234:235], v4 offset:3712
  v_exp_f32 v104, v104
  v_exp_f32 v105, v105
  v_exp_f32 v106, v106
  v_exp_f32 v107, v107
  v_exp_f32 v108, v108
  v_exp_f32 v109, v109
  v_exp_f32 v110, v110
  v_exp_f32 v111, v111
  v_cvt_pk_bf16_f32 v100, v104, v105
  v_cvt_pk_bf16_f32 v101, v106, v107
  v_cvt_pk_bf16_f32 v102, v108, v109
  v_cvt_pk_bf16_f32 v103, v110, v111
  v_pk_add_f32 v[112:113], v[112:113], v[248:249] op_sel_hi:[1,0] neg_lo:[0,1] neg_hi:[0,1]
  v_pk_add_f32 v[114:115], v[114:115], v[248:249] op_sel_hi:[1,0] neg_lo:[0,1] neg_hi:[0,1]
  v_pk_add_f32 v[116:117], v[116:117], v[248:249] op_sel_hi:[1,0] neg_lo:[0,1] neg_hi:[0,1]
  v_pk_add_f32 v[118:119], v[118:119], v[248:249] op_sel_hi:[1,0] neg_lo:[0,1] neg_hi:[0,1]
  s_waitcnt lgkmcnt(2)
  v_mfma_f32_32x32x16_bf16 v[192:207], v[244:247], v[100:103], v[192:207]
  ds_read_b64_tr_b16 v[236:237], v4 offset:3840
  ds_read_b64_tr_b16 v[238:239], v4 offset:3968
  v_exp_f32 v112, v112
  v_exp_f32 v113, v113
  v_exp_f32 v114, v114
  v_exp_f32 v115, v115
  v_exp_f32 v116, v116
  v_exp_f32 v117, v117
  v_exp_f32 v118, v118
  v_exp_f32 v119, v119
  v_cvt_pk_bf16_f32 v112, v112, v113
  v_cvt_pk_bf16_f32 v113, v114, v115
  v_cvt_pk_bf16_f32 v114, v116, v117
  v_cvt_pk_bf16_f32 v115, v118, v119
  v_pk_add_f32 v[120:121], v[120:121], v[248:249] op_sel_hi:[1,0] neg_lo:[0,1] neg_hi:[0,1]
  v_pk_add_f32 v[122:123], v[122:123], v[248:249] op_sel_hi:[1,0] neg_lo:[0,1] neg_hi:[0,1]
  v_pk_add_f32 v[124:125], v[124:125], v[248:249] op_sel_hi:[1,0] neg_lo:[0,1] neg_hi:[0,1]
  v_pk_add_f32 v[126:127], v[126:127], v[248:249] op_sel_hi:[1,0] neg_lo:[0,1] neg_hi:[0,1]
  s_waitcnt lgkmcnt(2)
  v_mfma_f32_32x32x16_bf16 v[192:207], v[232:235], v[112:115], v[192:207]
  ds_read_b64_tr_b16 v[240:241], v4 offset:4096
  ds_read_b64_tr_b16 v[242:243], v4 offset:4224
  v_exp_f32 v120, v120
  v_exp_f32 v121, v121
  v_exp_f32 v122, v122
  v_exp_f32 v123, v123
  v_exp_f32 v124, v124
  v_exp_f32 v125, v125
  v_exp_f32 v126, v126
  v_exp_f32 v127, v127
  v_cvt_pk_bf16_f32 v116, v120, v121
  v_cvt_pk_bf16_f32 v117, v122, v123
  v_cvt_pk_bf16_f32 v118, v124, v125
  v_cvt_pk_bf16_f32 v119, v126, v127
  v_pk_add_f32 v[128:129], v[128:129], v[248:249] op_sel_hi:[1,0] neg_lo:[0,1] neg_hi:[0,1]
  v_pk_add_f32 v[130:131], v[130:131], v[248:249] op_sel_hi:[1,0] neg_lo:[0,1] neg_hi:[0,1]
  v_pk_add_f32 v[132:133], v[132:133], v[248:249] op_sel_hi:[1,0] neg_lo:[0,1] neg_hi:[0,1]
  v_pk_add_f32 v[134:135], v[134:135], v[248:249] op_sel_hi:[1,0] neg_lo:[0,1] neg_hi:[0,1]
  s_waitcnt lgkmcnt(2)
  v_mfma_f32_32x32x16_bf16 v[192:207], v[236:239], v[116:119], v[192:207]
  ds_read_b64_tr_b16 v[244:245], v4 offset:4352
  ds_read_b64_tr_b16 v[246:247], v4 offset:4480
  v_exp_f32 v128, v128
  v_exp_f32 v129, v129
  v_exp_f32 v130, v130
  v_exp_f32 v131, v131
  v_exp_f32 v132, v132
  v_exp_f32 v133, v133
  v_exp_f32 v134, v134
  v_exp_f32 v135, v135
  v_cvt_pk_bf16_f32 v128, v128, v129
  v_cvt_pk_bf16_f32 v129, v130, v131
  v_cvt_pk_bf16_f32 v130, v132, v133
  v_cvt_pk_bf16_f32 v131, v134, v135
  v_pk_add_f32 v[136:137], v[136:137], v[248:249] op_sel_hi:[1,0] neg_lo:[0,1] neg_hi:[0,1]
  v_pk_add_f32 v[138:139], v[138:139], v[248:249] op_sel_hi:[1,0] neg_lo:[0,1] neg_hi:[0,1]
  v_pk_add_f32 v[140:141], v[140:141], v[248:249] op_sel_hi:[1,0] neg_lo:[0,1] neg_hi:[0,1]
  v_pk_add_f32 v[142:143], v[142:143], v[248:249] op_sel_hi:[1,0] neg_lo:[0,1] neg_hi:[0,1]
  s_waitcnt lgkmcnt(2)
  v_mfma_f32_32x32x16_bf16 v[192:207], v[240:243], v[128:131], v[192:207]
  ds_read_b64_tr_b16 v[232:233], v4 offset:4608
  ds_read_b64_tr_b16 v[234:235], v4 offset:4736
  v_exp_f32 v136, v136
  v_exp_f32 v137, v137
  v_exp_f32 v138, v138
  v_exp_f32 v139, v139
  v_exp_f32 v140, v140
  v_exp_f32 v141, v141
  v_exp_f32 v142, v142
  v_exp_f32 v143, v143
  v_cvt_pk_bf16_f32 v132, v136, v137
  v_cvt_pk_bf16_f32 v133, v138, v139
  v_cvt_pk_bf16_f32 v134, v140, v141
  v_cvt_pk_bf16_f32 v135, v142, v143
  s_waitcnt lgkmcnt(2)
  s_nop 0
  v_mfma_f32_32x32x16_bf16 v[192:207], v[244:247], v[132:135], v[192:207]
  ds_read_b64_tr_b16 v[236:237], v4 offset:4864
  ds_read_b64_tr_b16 v[238:239], v4 offset:4992
  s_waitcnt lgkmcnt(2)
  v_mfma_f32_32x32x16_bf16 v[192:207], v[232:235], v[144:147], v[192:207]
  s_waitcnt lgkmcnt(0)
  v_mfma_f32_32x32x16_bf16 v[192:207], v[236:239], v[148:151], v[192:207]
  s_nop 11
  v_rcp_f32 v15, v204
  s_nop 0
  v_mul_f32 v192, v192, v15
  v_mul_f32 v193, v193, v15
  v_mul_f32 v194, v194, v15
  v_mul_f32 v195, v195, v15
  v_mul_f32 v196, v196, v15
  v_mul_f32 v197, v197, v15
  v_mul_f32 v198, v198, v15
  v_mul_f32 v199, v199, v15
  v_mul_f32 v200, v200, v15
  v_mul_f32 v201, v201, v15
  v_mul_f32 v202, v202, v15
  v_mul_f32 v203, v203, v15
  v_cvt_pk_bf16_f32 v192, v192, v193
  v_cvt_pk_bf16_f32 v193, v194, v195
  v_cvt_pk_bf16_f32 v194, v196, v197
  v_cvt_pk_bf16_f32 v195, v198, v199
  v_cvt_pk_bf16_f32 v196, v200, v201
  v_cvt_pk_bf16_f32 v197, v202, v203
  buffer_store_dwordx4 v[192:195], v5, s[24:27], s34 offen sc1
  s_mov_b64 exec, s[30:31]
  ds_write_b64 v6, v[196:197] offset:512
  s_mov_b64 exec, -1
  s_lshl_b32 s18, s11, 3
  s_lshl_b32 s19, s10, 1
  s_add_u32 s18, s18, s19
  v_bfe_u32 v10, v0, 4, 1
  v_add_u32 v10, s18, v10
  v_mul_u32_u24 v10, 20480, v10
  v_and_b32 v11, 15, v0
  v_lshl_add_u32 v10, v11, 4, v10
  s_lshr_b32 s18, s12, 2
  s_add_u32 s18, s18, 16
  s_lshl_b32 s18, s18, 10
  s_and_b32 s19, s12, 3
  s_lshl_b32 s19, s19, 8
  s_add_u32 s18, s18, s19
  v_add_u32 v10, s18, v10
  s_lshl_b32 s19, s10, 9
  s_add_u32 s19, s19, 155648
  v_lshl_add_u32 v11, v0, 4, s19
  s_waitcnt lgkmcnt(0)
  s_barrier
  s_mov_b64 exec, s[30:31]
  ds_read_b128 v[220:223], v11
  s_waitcnt lgkmcnt(0)
  buffer_store_dwordx4 v[220:223], v10, s[24:27], 0 offen sc1
  s_mov_b64 exec, -1
  s_and_b32 s13, s2, 7
  s_lshr_b32 s14, s2, 3
  s_and_b32 s11, s13, 3
  s_lshl_b32 s11, s11, 3
  s_and_b32 s15, s14, 7
  s_add_u32 s11, s11, s15
  s_lshr_b32 s12, s13, 2
  s_lshl_b32 s12, s12, 2
  s_lshr_b32 s15, s14, 3
  s_add_u32 s12, s12, s15
  s_mov_b32 s44, 0
  v_lshlrev_b32 v1, 4, v0
  s_lshl_b32 s16, s11, 2
  s_add_u32 s16, s16, s10
  s_mul_i32 s16, s16, 20480
  v_add_u32 v2, s16, v1
  s_mul_i32 s17, s44, 4096
  s_waitcnt lgkmcnt(0)
  s_add_u32 s24, s8, 8388608
  s_addc_u32 s25, s9, 0
  s_and_b32 s25, s25, 0xffff
  s_mov_b32 s26, 2621440
  s_mov_b32 s27, 0x00020000
  s_waitcnt vmcnt(0)
  s_barrier
  s_barrier
  buffer_load_dwordx4 v[88:91], v2, s[24:27], s17 offen
  buffer_load_dwordx4 v[92:95], v2, s[24:27], s17 offen offset:1024
  buffer_load_dwordx4 v[96:99], v2, s[24:27], s17 offen offset:2048
  buffer_load_dwordx4 v[100:103], v2, s[24:27], s17 offen offset:3072
  s_add_u32 s17, s17, 4096
  s_cmp_eq_u32 s17, 20480
  s_cselect_b32 s17, 0, s17
  buffer_load_dwordx4 v[104:107], v2, s[24:27], s17 offen
  buffer_load_dwordx4 v[108:111], v2, s[24:27], s17 offen offset:1024
  buffer_load_dwordx4 v[112:115], v2, s[24:27], s17 offen offset:2048
  buffer_load_dwordx4 v[116:119], v2, s[24:27], s17 offen offset:3072
  s_add_u32 s17, s17, 4096
  s_cmp_eq_u32 s17, 20480
  s_cselect_b32 s17, 0, s17
  v_and_b32 v7, 15, v0
  v_lshrrev_b32 v8, 4, v0
  s_lshl_b32 s16, s11, 6
  s_lshl_b32 s18, s10, 4
  s_add_u32 s16, s16, s18
  v_add_u32 v9, s16, v7
  v_mul_u32_u24 v3, 1280, v9
  s_mul_i32 s18, s12, 160
  v_lshl_add_u32 v3, v8, 3, v3
  v_add_u32 v3, s18, v3
  v_lshrrev_b32 v10, 5, v9
  v_mul_u32_u24 v10, 40960, v10
  v_and_b32 v11, 31, v9
  v_lshl_add_u32 v10, v11, 4, v10
  v_lshrrev_b32 v11, 1, v8
  v_lshl_add_u32 v10, v11, 9, v10
  v_and_b32 v11, 1, v8
  v_lshl_add_u32 v10, v11, 10, v10
  s_mul_i32 s18, s12, 5120
  v_add_u32 v4, s18, v10
  v_mov_b32 v10, 0x40000000
  v_cmp_eq_u32 vcc, 0, v11
  s_nop 1
  v_cndmask_b32 v26, v10, v4, vcc
  s_lshl_b32 s18, s11, 2
  s_add_u32 s18, s18, s10
  s_lshl_b32 s18, s18, 3
  s_add_u32 s18, s18, s12
  s_lshl_b32 s18, s18, 7
  v_lshl_add_u32 v5, v7, 3, s18
  v_cmp_eq_u32 vcc, 0, v8
  s_nop 1
  v_cndmask_b32 v5, v10, v5, vcc
  s_mov_b32 s32, s4
  s_and_b32 s33, s5, 0xffff
  s_mov_b32 s34, 2621440
  s_mov_b32 s35, 0x00020000
  s_add_u32 s40, s8, 14680064
  s_addc_u32 s41, s9, 0
  s_and_b32 s41, s41, 0xffff
  s_mov_b32 s42, 131072
  s_mov_b32 s43, 0x00020000
  s_add_u32 s36, s8, 11534336
  s_addc_u32 s37, s9, 0
  s_and_b32 s37, s37, 0xffff
  s_mov_b32 s38, 2621440
  s_mov_b32 s39, 0x00020000
  v_add_u32 v15, 65536, v1
  s_barrier
  ds_read_b128 v[48:51], v1 offset:0
  ds_read_b128 v[52:55], v1 offset:1024
  ds_read_b128 v[56:59], v1 offset:2048
  ds_read_b128 v[60:63], v1 offset:3072
  ds_read_b128 v[64:67], v1 offset:4096
  s_waitcnt vmcnt(7) lgkmcnt(4)
  v_mfma_f32_16x16x32_bf16 v[28:31], v[48:51], v[88:91], 0
  ds_read_b128 v[68:71], v1 offset:5120
  s_waitcnt lgkmcnt(4)
  v_mfma_f32_16x16x32_bf16 v[32:35], v[52:55], v[88:91], 0
  ds_read_b128 v[72:75], v1 offset:6144
  s_waitcnt lgkmcnt(4)
  v_mfma_f32_16x16x32_bf16 v[36:39], v[56:59], v[88:91], 0
  ds_read_b128 v[76:79], v1 offset:7168
  s_waitcnt lgkmcnt(4)
  v_mfma_f32_16x16x32_bf16 v[40:43], v[60:63], v[88:91], 0
  ds_read_b128 v[80:83], v1 offset:8192
  s_waitcnt lgkmcnt(4)
  v_mfma_f32_16x16x32_bf16 v[44:47], v[64:67], v[88:91], 0
  ds_read_b128 v[84:87], v1 offset:9216
  buffer_load_dwordx4 v[88:91], v2, s[24:27], s17 offen
  s_waitcnt vmcnt(7) lgkmcnt(4)
  v_mfma_f32_16x16x32_bf16 v[28:31], v[68:71], v[92:95], v[28:31]
  ds_read_b128 v[48:51], v1 offset:10240
  s_waitcnt lgkmcnt(4)
  v_mfma_f32_16x16x32_bf16 v[32:35], v[72:75], v[92:95], v[32:35]
  ds_read_b128 v[52:55], v1 offset:11264
  s_waitcnt lgkmcnt(4)
  v_mfma_f32_16x16x32_bf16 v[36:39], v[76:79], v[92:95], v[36:39]
  ds_read_b128 v[56:59], v1 offset:12288
  s_waitcnt lgkmcnt(4)
  v_mfma_f32_16x16x32_bf16 v[40:43], v[80:83], v[92:95], v[40:43]
  ds_read_b128 v[60:63], v1 offset:13312
  s_waitcnt lgkmcnt(4)
  v_mfma_f32_16x16x32_bf16 v[44:47], v[84:87], v[92:95], v[44:47]
  ds_read_b128 v[64:67], v1 offset:14336
  buffer_load_dwordx4 v[92:95], v2, s[24:27], s17 offen offset:1024
  s_waitcnt vmcnt(7) lgkmcnt(4)
  v_mfma_f32_16x16x32_bf16 v[28:31], v[48:51], v[96:99], v[28:31]
  ds_read_b128 v[68:71], v1 offset:15360
  s_waitcnt lgkmcnt(4)
  v_mfma_f32_16x16x32_bf16 v[32:35], v[52:55], v[96:99], v[32:35]
  ds_read_b128 v[72:75], v1 offset:16384
  s_waitcnt lgkmcnt(4)
  v_mfma_f32_16x16x32_bf16 v[36:39], v[56:59], v[96:99], v[36:39]
  ds_read_b128 v[76:79], v1 offset:17408
  s_waitcnt lgkmcnt(4)
  v_mfma_f32_16x16x32_bf16 v[40:43], v[60:63], v[96:99], v[40:43]
  ds_read_b128 v[80:83], v1 offset:18432
  s_waitcnt lgkmcnt(4)
  v_mfma_f32_16x16x32_bf16 v[44:47], v[64:67], v[96:99], v[44:47]
  ds_read_b128 v[84:87], v1 offset:19456
  buffer_load_dwordx4 v[96:99], v2, s[24:27], s17 offen offset:2048
  s_waitcnt lgkmcnt(0)
  s_barrier
  s_waitcnt vmcnt(7)
  v_mfma_f32_16x16x32_bf16 v[28:31], v[68:71], v[100:103], v[28:31]
  ds_read_b128 v[48:51], v1 offset:20480
  v_mfma_f32_16x16x32_bf16 v[32:35], v[72:75], v[100:103], v[32:35]
  ds_read_b128 v[52:55], v1 offset:21504
  v_mfma_f32_16x16x32_bf16 v[36:39], v[76:79], v[100:103], v[36:39]
  ds_read_b128 v[56:59], v1 offset:22528
  v_mfma_f32_16x16x32_bf16 v[40:43], v[80:83], v[100:103], v[40:43]
  ds_read_b128 v[60:63], v1 offset:23552
  v_mfma_f32_16x16x32_bf16 v[44:47], v[84:87], v[100:103], v[44:47]
  ds_read_b128 v[64:67], v1 offset:24576
  buffer_load_dwordx4 v[100:103], v2, s[24:27], s17 offen offset:3072
  s_add_u32 s17, s17, 4096
  s_cmp_eq_u32 s17, 20480
  s_cselect_b32 s17, 0, s17
  s_waitcnt vmcnt(7) lgkmcnt(4)
  v_mfma_f32_16x16x32_bf16 v[28:31], v[48:51], v[104:107], v[28:31]
  ds_read_b128 v[68:71], v1 offset:25600
  s_waitcnt lgkmcnt(4)
  v_mfma_f32_16x16x32_bf16 v[32:35], v[52:55], v[104:107], v[32:35]
  ds_read_b128 v[72:75], v1 offset:26624
  s_waitcnt lgkmcnt(4)
  v_mfma_f32_16x16x32_bf16 v[36:39], v[56:59], v[104:107], v[36:39]
  ds_read_b128 v[76:79], v1 offset:27648
  s_waitcnt lgkmcnt(4)
  v_mfma_f32_16x16x32_bf16 v[40:43], v[60:63], v[104:107], v[40:43]
  ds_read_b128 v[80:83], v1 offset:28672
  s_waitcnt lgkmcnt(4)
  v_mfma_f32_16x16x32_bf16 v[44:47], v[64:67], v[104:107], v[44:47]
  ds_read_b128 v[84:87], v1 offset:29696
  buffer_load_dwordx4 v[104:107], v2, s[24:27], s17 offen
  s_waitcnt vmcnt(7) lgkmcnt(4)
  v_mfma_f32_16x16x32_bf16 v[28:31], v[68:71], v[108:111], v[28:31]
  ds_read_b128 v[48:51], v1 offset:30720
  s_waitcnt lgkmcnt(4)
  v_mfma_f32_16x16x32_bf16 v[32:35], v[72:75], v[108:111], v[32:35]
  ds_read_b128 v[52:55], v1 offset:31744
  s_waitcnt lgkmcnt(4)
  v_mfma_f32_16x16x32_bf16 v[36:39], v[76:79], v[108:111], v[36:39]
  ds_read_b128 v[56:59], v1 offset:32768
  s_waitcnt lgkmcnt(4)
  v_mfma_f32_16x16x32_bf16 v[40:43], v[80:83], v[108:111], v[40:43]
  ds_read_b128 v[60:63], v1 offset:33792
  s_waitcnt lgkmcnt(4)
  v_mfma_f32_16x16x32_bf16 v[44:47], v[84:87], v[108:111], v[44:47]
  ds_read_b128 v[64:67], v1 offset:34816
  buffer_load_dwordx4 v[108:111], v2, s[24:27], s17 offen offset:1024
  s_waitcnt vmcnt(7) lgkmcnt(4)
  v_mfma_f32_16x16x32_bf16 v[28:31], v[48:51], v[112:115], v[28:31]
  ds_read_b128 v[68:71], v1 offset:35840
  s_waitcnt lgkmcnt(4)
  v_mfma_f32_16x16x32_bf16 v[32:35], v[52:55], v[112:115], v[32:35]
  ds_read_b128 v[72:75], v1 offset:36864
  s_waitcnt lgkmcnt(4)
  v_mfma_f32_16x16x32_bf16 v[36:39], v[56:59], v[112:115], v[36:39]
  ds_read_b128 v[76:79], v1 offset:37888
  s_waitcnt lgkmcnt(4)
  v_mfma_f32_16x16x32_bf16 v[40:43], v[60:63], v[112:115], v[40:43]
  ds_read_b128 v[80:83], v1 offset:38912
  s_waitcnt lgkmcnt(4)
  v_mfma_f32_16x16x32_bf16 v[44:47], v[64:67], v[112:115], v[44:47]
  ds_read_b128 v[84:87], v1 offset:39936
  buffer_load_dwordx4 v[112:115], v2, s[24:27], s17 offen offset:2048
  s_waitcnt lgkmcnt(0)
  s_barrier
  s_waitcnt vmcnt(7)
  v_mfma_f32_16x16x32_bf16 v[28:31], v[68:71], v[116:119], v[28:31]
  ds_read_b128 v[48:51], v1 offset:40960
  v_mfma_f32_16x16x32_bf16 v[32:35], v[72:75], v[116:119], v[32:35]
  ds_read_b128 v[52:55], v1 offset:41984
  v_mfma_f32_16x16x32_bf16 v[36:39], v[76:79], v[116:119], v[36:39]
  ds_read_b128 v[56:59], v1 offset:43008
  v_mfma_f32_16x16x32_bf16 v[40:43], v[80:83], v[116:119], v[40:43]
  ds_read_b128 v[60:63], v1 offset:44032
  v_mfma_f32_16x16x32_bf16 v[44:47], v[84:87], v[116:119], v[44:47]
  ds_read_b128 v[64:67], v1 offset:45056
  buffer_load_dwordx4 v[116:119], v2, s[24:27], s17 offen offset:3072
  s_add_u32 s17, s17, 4096
  s_cmp_eq_u32 s17, 20480
  s_cselect_b32 s17, 0, s17
  s_waitcnt vmcnt(7) lgkmcnt(4)
  v_mfma_f32_16x16x32_bf16 v[28:31], v[48:51], v[88:91], v[28:31]
  ds_read_b128 v[68:71], v1 offset:46080
  s_waitcnt lgkmcnt(4)
  v_mfma_f32_16x16x32_bf16 v[32:35], v[52:55], v[88:91], v[32:35]
  ds_read_b128 v[72:75], v1 offset:47104
  s_waitcnt lgkmcnt(4)
  v_mfma_f32_16x16x32_bf16 v[36:39], v[56:59], v[88:91], v[36:39]
  ds_read_b128 v[76:79], v1 offset:48128
  s_waitcnt lgkmcnt(4)
  v_mfma_f32_16x16x32_bf16 v[40:43], v[60:63], v[88:91], v[40:43]
  ds_read_b128 v[80:83], v1 offset:49152
  s_waitcnt lgkmcnt(4)
  v_mfma_f32_16x16x32_bf16 v[44:47], v[64:67], v[88:91], v[44:47]
  ds_read_b128 v[84:87], v1 offset:50176
  buffer_load_dwordx4 v[88:91], v2, s[24:27], s17 offen
  s_waitcnt vmcnt(7) lgkmcnt(4)
  v_mfma_f32_16x16x32_bf16 v[28:31], v[68:71], v[92:95], v[28:31]
  ds_read_b128 v[48:51], v1 offset:51200
  s_waitcnt lgkmcnt(4)
  v_mfma_f32_16x16x32_bf16 v[32:35], v[72:75], v[92:95], v[32:35]
  ds_read_b128 v[52:55], v1 offset:52224
  s_waitcnt lgkmcnt(4)
  v_mfma_f32_16x16x32_bf16 v[36:39], v[76:79], v[92:95], v[36:39]
  ds_read_b128 v[56:59], v1 offset:53248
  s_waitcnt lgkmcnt(4)
  v_mfma_f32_16x16x32_bf16 v[40:43], v[80:83], v[92:95], v[40:43]
  ds_read_b128 v[60:63], v1 offset:54272
  s_waitcnt lgkmcnt(4)
  v_mfma_f32_16x16x32_bf16 v[44:47], v[84:87], v[92:95], v[44:47]
  ds_read_b128 v[64:67], v1 offset:55296
  buffer_load_dwordx4 v[92:95], v2, s[24:27], s17 offen offset:1024
  s_waitcnt vmcnt(7) lgkmcnt(4)
  v_mfma_f32_16x16x32_bf16 v[28:31], v[48:51], v[96:99], v[28:31]
  ds_read_b128 v[68:71], v1 offset:56320
  s_waitcnt lgkmcnt(4)
  v_mfma_f32_16x16x32_bf16 v[32:35], v[52:55], v[96:99], v[32:35]
  ds_read_b128 v[72:75], v1 offset:57344
  s_waitcnt lgkmcnt(4)
  v_mfma_f32_16x16x32_bf16 v[36:39], v[56:59], v[96:99], v[36:39]
  ds_read_b128 v[76:79], v1 offset:58368
  s_waitcnt lgkmcnt(4)
  v_mfma_f32_16x16x32_bf16 v[40:43], v[60:63], v[96:99], v[40:43]
  ds_read_b128 v[80:83], v1 offset:59392
  s_waitcnt lgkmcnt(4)
  v_mfma_f32_16x16x32_bf16 v[44:47], v[64:67], v[96:99], v[44:47]
  ds_read_b128 v[84:87], v1 offset:60416
  buffer_load_dwordx4 v[96:99], v2, s[24:27], s17 offen offset:2048
  s_waitcnt lgkmcnt(0)
  s_barrier
  s_waitcnt vmcnt(7)
  v_mfma_f32_16x16x32_bf16 v[28:31], v[68:71], v[100:103], v[28:31]
  ds_read_b128 v[48:51], v1 offset:61440
  v_mfma_f32_16x16x32_bf16 v[32:35], v[72:75], v[100:103], v[32:35]
  ds_read_b128 v[52:55], v1 offset:62464
  v_mfma_f32_16x16x32_bf16 v[36:39], v[76:79], v[100:103], v[36:39]
  ds_read_b128 v[56:59], v1 offset:63488
  v_mfma_f32_16x16x32_bf16 v[40:43], v[80:83], v[100:103], v[40:43]
  ds_read_b128 v[60:63], v1 offset:64512
  v_mfma_f32_16x16x32_bf16 v[44:47], v[84:87], v[100:103], v[44:47]
  ds_read_b128 v[64:67], v15 offset:0
  buffer_load_dwordx4 v[100:103], v2, s[24:27], s17 offen offset:3072
  s_add_u32 s17, s17, 4096
  s_cmp_eq_u32 s17, 20480
  s_cselect_b32 s17, 0, s17
  s_waitcnt vmcnt(7) lgkmcnt(4)
  v_mfma_f32_16x16x32_bf16 v[28:31], v[48:51], v[104:107], v[28:31]
  ds_read_b128 v[68:71], v15 offset:1024
  s_waitcnt lgkmcnt(4)
  v_mfma_f32_16x16x32_bf16 v[32:35], v[52:55], v[104:107], v[32:35]
  ds_read_b128 v[72:75], v15 offset:2048
  s_waitcnt lgkmcnt(4)
  v_mfma_f32_16x16x32_bf16 v[36:39], v[56:59], v[104:107], v[36:39]
  ds_read_b128 v[76:79], v15 offset:3072
  s_waitcnt lgkmcnt(4)
  v_mfma_f32_16x16x32_bf16 v[40:43], v[60:63], v[104:107], v[40:43]
  ds_read_b128 v[80:83], v15 offset:4096
  s_waitcnt lgkmcnt(4)
  v_mfma_f32_16x16x32_bf16 v[44:47], v[64:67], v[104:107], v[44:47]
  ds_read_b128 v[84:87], v15 offset:5120
  s_waitcnt vmcnt(6) lgkmcnt(4)
  v_mfma_f32_16x16x32_bf16 v[28:31], v[68:71], v[108:111], v[28:31]
  ds_read_b128 v[48:51], v15 offset:6144
  s_waitcnt lgkmcnt(4)
  v_mfma_f32_16x16x32_bf16 v[32:35], v[72:75], v[108:111], v[32:35]
  ds_read_b128 v[52:55], v15 offset:7168
  s_waitcnt lgkmcnt(4)
  v_mfma_f32_16x16x32_bf16 v[36:39], v[76:79], v[108:111], v[36:39]
  ds_read_b128 v[56:59], v15 offset:8192
  s_waitcnt lgkmcnt(4)
  v_mfma_f32_16x16x32_bf16 v[40:43], v[80:83], v[108:111], v[40:43]
  ds_read_b128 v[60:63], v15 offset:9216
  s_waitcnt lgkmcnt(4)
  v_mfma_f32_16x16x32_bf16 v[44:47], v[84:87], v[108:111], v[44:47]
  ds_read_b128 v[64:67], v15 offset:10240
  s_waitcnt vmcnt(5) lgkmcnt(4)
  v_mfma_f32_16x16x32_bf16 v[28:31], v[48:51], v[112:115], v[28:31]
  ds_read_b128 v[68:71], v15 offset:11264
  s_waitcnt lgkmcnt(4)
  v_mfma_f32_16x16x32_bf16 v[32:35], v[52:55], v[112:115], v[32:35]
  ds_read_b128 v[72:75], v15 offset:12288
  s_waitcnt lgkmcnt(4)
  v_mfma_f32_16x16x32_bf16 v[36:39], v[56:59], v[112:115], v[36:39]
  ds_read_b128 v[76:79], v15 offset:13312
  s_waitcnt lgkmcnt(4)
  v_mfma_f32_16x16x32_bf16 v[40:43], v[60:63], v[112:115], v[40:43]
  ds_read_b128 v[80:83], v15 offset:14336
  s_waitcnt lgkmcnt(4)
  v_mfma_f32_16x16x32_bf16 v[44:47], v[64:67], v[112:115], v[44:47]
  ds_read_b128 v[84:87], v15 offset:15360
  s_waitcnt lgkmcnt(0)
  s_barrier
  s_waitcnt vmcnt(4)
  v_mfma_f32_16x16x32_bf16 v[28:31], v[68:71], v[116:119], v[28:31]
  ds_read_b128 v[48:51], v15 offset:16384
  v_mfma_f32_16x16x32_bf16 v[32:35], v[72:75], v[116:119], v[32:35]
  ds_read_b128 v[52:55], v15 offset:17408
  v_mfma_f32_16x16x32_bf16 v[36:39], v[76:79], v[116:119], v[36:39]
  ds_read_b128 v[56:59], v15 offset:18432
  v_mfma_f32_16x16x32_bf16 v[40:43], v[80:83], v[116:119], v[40:43]
  ds_read_b128 v[60:63], v15 offset:19456
  v_mfma_f32_16x16x32_bf16 v[44:47], v[84:87], v[116:119], v[44:47]
  ds_read_b128 v[64:67], v15 offset:20480
  s_waitcnt vmcnt(3) lgkmcnt(4)
  v_mfma_f32_16x16x32_bf16 v[28:31], v[48:51], v[88:91], v[28:31]
  ds_read_b128 v[68:71], v15 offset:21504
  s_waitcnt lgkmcnt(4)
  v_mfma_f32_16x16x32_bf16 v[32:35], v[52:55], v[88:91], v[32:35]
  ds_read_b128 v[72:75], v15 offset:22528
  s_waitcnt lgkmcnt(4)
  v_mfma_f32_16x16x32_bf16 v[36:39], v[56:59], v[88:91], v[36:39]
  ds_read_b128 v[76:79], v15 offset:23552
  s_waitcnt lgkmcnt(4)
  v_mfma_f32_16x16x32_bf16 v[40:43], v[60:63], v[88:91], v[40:43]
  ds_read_b128 v[80:83], v15 offset:24576
  s_waitcnt lgkmcnt(4)
  v_mfma_f32_16x16x32_bf16 v[44:47], v[64:67], v[88:91], v[44:47]
  ds_read_b128 v[84:87], v15 offset:25600
  buffer_load_dwordx2 v[16:17], v3, s[32:35], 0 offen offset:0
  buffer_load_dwordx2 v[18:19], v3, s[32:35], 0 offen offset:32
  buffer_load_dwordx2 v[20:21], v3, s[32:35], 0 offen offset:64
  buffer_load_dwordx2 v[22:23], v3, s[32:35], 0 offen offset:96
  buffer_load_dwordx2 v[24:25], v3, s[32:35], 0 offen offset:128
  s_waitcnt vmcnt(7) lgkmcnt(4)
  v_mfma_f32_16x16x32_bf16 v[28:31], v[68:71], v[92:95], v[28:31]
  ds_read_b128 v[48:51], v15 offset:26624
  s_waitcnt lgkmcnt(4)
  v_mfma_f32_16x16x32_bf16 v[32:35], v[72:75], v[92:95], v[32:35]
  ds_read_b128 v[52:55], v15 offset:27648
  s_waitcnt lgkmcnt(4)
  v_mfma_f32_16x16x32_bf16 v[36:39], v[76:79], v[92:95], v[36:39]
  ds_read_b128 v[56:59], v15 offset:28672
  s_waitcnt lgkmcnt(4)
  v_mfma_f32_16x16x32_bf16 v[40:43], v[80:83], v[92:95], v[40:43]
  ds_read_b128 v[60:63], v15 offset:29696
  s_waitcnt lgkmcnt(4)
  v_mfma_f32_16x16x32_bf16 v[44:47], v[84:87], v[92:95], v[44:47]
  ds_read_b128 v[64:67], v15 offset:30720
  s_waitcnt vmcnt(6) lgkmcnt(4)
  v_mfma_f32_16x16x32_bf16 v[28:31], v[48:51], v[96:99], v[28:31]
  ds_read_b128 v[68:71], v15 offset:31744
  s_waitcnt lgkmcnt(4)
  v_mfma_f32_16x16x32_bf16 v[32:35], v[52:55], v[96:99], v[32:35]
  ds_read_b128 v[72:75], v15 offset:32768
  s_waitcnt lgkmcnt(4)
  v_mfma_f32_16x16x32_bf16 v[36:39], v[56:59], v[96:99], v[36:39]
  ds_read_b128 v[76:79], v15 offset:33792
  s_waitcnt lgkmcnt(4)
  v_mfma_f32_16x16x32_bf16 v[40:43], v[60:63], v[96:99], v[40:43]
  ds_read_b128 v[80:83], v15 offset:34816
  s_waitcnt lgkmcnt(4)
  v_mfma_f32_16x16x32_bf16 v[44:47], v[64:67], v[96:99], v[44:47]
  ds_read_b128 v[84:87], v15 offset:35840
  s_waitcnt lgkmcnt(0)
  s_barrier
  s_waitcnt vmcnt(5)
  v_mfma_f32_16x16x32_bf16 v[28:31], v[68:71], v[100:103], v[28:31]
  v_mfma_f32_16x16x32_bf16 v[32:35], v[72:75], v[100:103], v[32:35]
  v_mfma_f32_16x16x32_bf16 v[36:39], v[76:79], v[100:103], v[36:39]
  v_mfma_f32_16x16x32_bf16 v[40:43], v[80:83], v[100:103], v[40:43]
  v_mfma_f32_16x16x32_bf16 v[44:47], v[84:87], v[100:103], v[44:47]
  s_nop 3
  v_cvt_pk_bf16_f32 v48, v28, v29
  v_cvt_pk_bf16_f32 v49, v30, v31
  v_lshlrev_b32 v28, 16, v48
  v_and_b32 v29, 0xffff0000, v48
  s_waitcnt vmcnt(4)
  v_lshlrev_b32 v50, 16, v16
  v_and_b32 v51, 0xffff0000, v16
  v_lshlrev_b32 v30, 16, v49
  v_and_b32 v31, 0xffff0000, v49
  v_lshlrev_b32 v52, 16, v17
  v_and_b32 v53, 0xffff0000, v17
  v_pk_add_f32 v[28:29], v[28:29], v[50:51]
  v_pk_add_f32 v[30:31], v[30:31], v[52:53]
  v_cvt_pk_bf16_f32 v200, v28, v29
  v_cvt_pk_bf16_f32 v201, v30, v31
  v_lshlrev_b32 v28, 16, v200
  v_and_b32 v29, 0xffff0000, v200
  v_lshlrev_b32 v30, 16, v201
  v_and_b32 v31, 0xffff0000, v201
  v_mov_b32 v56, v28
  v_mul_f32 v57, v28, v28
  v_add_f32 v56, v56, v29
  v_fmac_f32 v57, v29, v29
  v_add_f32 v56, v56, v30
  v_fmac_f32 v57, v30, v30
  v_add_f32 v56, v56, v31
  v_fmac_f32 v57, v31, v31
  v_cvt_pk_bf16_f32 v48, v32, v33
  v_cvt_pk_bf16_f32 v49, v34, v35
  v_lshlrev_b32 v32, 16, v48
  v_and_b32 v33, 0xffff0000, v48
  s_waitcnt vmcnt(3)
  v_lshlrev_b32 v50, 16, v18
  v_and_b32 v51, 0xffff0000, v18
  v_lshlrev_b32 v34, 16, v49
  v_and_b32 v35, 0xffff0000, v49
  v_lshlrev_b32 v52, 16, v19
  v_and_b32 v53, 0xffff0000, v19
  v_pk_add_f32 v[32:33], v[32:33], v[50:51]
  v_pk_add_f32 v[34:35], v[34:35], v[52:53]
  v_cvt_pk_bf16_f32 v202, v32, v33
  v_cvt_pk_bf16_f32 v203, v34, v35
  v_mov_b32 v72, v200
  v_mov_b32 v74, v202
  v_mov_b32 v73, v201
  v_mov_b32 v75, v203
  v_permlane16_swap_b32 v72, v74
  s_nop 0
  v_permlane16_swap_b32 v73, v75
  s_mov_b32 s30, 0
  buffer_store_dwordx4 v[72:75], v4, s[36:39], s30 offen sc1
  v_lshlrev_b32 v32, 16, v202
  v_and_b32 v33, 0xffff0000, v202
  v_lshlrev_b32 v34, 16, v203
  v_and_b32 v35, 0xffff0000, v203
  v_add_f32 v56, v56, v32
  v_fmac_f32 v57, v32, v32
  v_add_f32 v56, v56, v33
  v_fmac_f32 v57, v33, v33
  v_add_f32 v56, v56, v34
  v_fmac_f32 v57, v34, v34
  v_add_f32 v56, v56, v35
  v_fmac_f32 v57, v35, v35
  v_cvt_pk_bf16_f32 v48, v36, v37
  v_cvt_pk_bf16_f32 v49, v38, v39
  v_lshlrev_b32 v36, 16, v48
  v_and_b32 v37, 0xffff0000, v48
  s_waitcnt vmcnt(3)
  v_lshlrev_b32 v50, 16, v20
  v_and_b32 v51, 0xffff0000, v20
  v_lshlrev_b32 v38, 16, v49
  v_and_b32 v39, 0xffff0000, v49
  v_lshlrev_b32 v52, 16, v21
  v_and_b32 v53, 0xffff0000, v21
  v_pk_add_f32 v[36:37], v[36:37], v[50:51]
  v_pk_add_f32 v[38:39], v[38:39], v[52:53]
  v_cvt_pk_bf16_f32 v204, v36, v37
  v_cvt_pk_bf16_f32 v205, v38, v39
  v_lshlrev_b32 v36, 16, v204
  v_and_b32 v37, 0xffff0000, v204
  v_lshlrev_b32 v38, 16, v205
  v_and_b32 v39, 0xffff0000, v205
  v_add_f32 v56, v56, v36
  v_fmac_f32 v57, v36, v36
  v_add_f32 v56, v56, v37
  v_fmac_f32 v57, v37, v37
  v_add_f32 v56, v56, v38
  v_fmac_f32 v57, v38, v38
  v_add_f32 v56, v56, v39
  v_fmac_f32 v57, v39, v39
  v_cvt_pk_bf16_f32 v48, v40, v41
  v_cvt_pk_bf16_f32 v49, v42, v43
  v_lshlrev_b32 v40, 16, v48
  v_and_b32 v41, 0xffff0000, v48
  s_waitcnt vmcnt(2)
  v_lshlrev_b32 v50, 16, v22
  v_and_b32 v51, 0xffff0000, v22
  v_lshlrev_b32 v42, 16, v49
  v_and_b32 v43, 0xffff0000, v49
  v_lshlrev_b32 v52, 16, v23
  v_and_b32 v53, 0xffff0000, v23
  v_pk_add_f32 v[40:41], v[40:41], v[50:51]
  v_pk_add_f32 v[42:43], v[42:43], v[52:53]
  v_cvt_pk_bf16_f32 v206, v40, v41
  v_cvt_pk_bf16_f32 v207, v42, v43
  v_mov_b32 v76, v204
  v_mov_b32 v78, v206
  v_mov_b32 v77, v205
  v_mov_b32 v79, v207
  v_permlane16_swap_b32 v76, v78
  s_nop 0
  v_permlane16_swap_b32 v77, v79
  s_mov_b32 s30, 2048
  buffer_store_dwordx4 v[76:79], v4, s[36:39], s30 offen sc1
  v_lshlrev_b32 v40, 16, v206
  v_and_b32 v41, 0xffff0000, v206
  v_lshlrev_b32 v42, 16, v207
  v_and_b32 v43, 0xffff0000, v207
  v_add_f32 v56, v56, v40
  v_fmac_f32 v57, v40, v40
  v_add_f32 v56, v56, v41
  v_fmac_f32 v57, v41, v41
  v_add_f32 v56, v56, v42
  v_fmac_f32 v57, v42, v42
  v_add_f32 v56, v56, v43
  v_fmac_f32 v57, v43, v43
  v_cvt_pk_bf16_f32 v48, v44, v45
  v_cvt_pk_bf16_f32 v49, v46, v47
  v_lshlrev_b32 v44, 16, v48
  v_and_b32 v45, 0xffff0000, v48
  s_waitcnt vmcnt(2)
  v_lshlrev_b32 v50, 16, v24
  v_and_b32 v51, 0xffff0000, v24
  v_lshlrev_b32 v46, 16, v49
  v_and_b32 v47, 0xffff0000, v49
  v_lshlrev_b32 v52, 16, v25
  v_and_b32 v53, 0xffff0000, v25
  v_pk_add_f32 v[44:45], v[44:45], v[50:51]
  v_pk_add_f32 v[46:47], v[46:47], v[52:53]
  v_cvt_pk_bf16_f32 v208, v44, v45
  v_cvt_pk_bf16_f32 v209, v46, v47
  v_mov_b32 v80, v208
  v_mov_b32 v82, v208
  v_mov_b32 v81, v209
  v_mov_b32 v83, v209
  v_permlane16_swap_b32 v80, v82
  s_nop 0
  v_permlane16_swap_b32 v81, v83
  s_mov_b32 s30, 4096
  buffer_store_dwordx4 v[80:83], v26, s[36:39], s30 offen sc1
  v_lshlrev_b32 v44, 16, v208
  v_and_b32 v45, 0xffff0000, v208
  v_lshlrev_b32 v46, 16, v209
  v_and_b32 v47, 0xffff0000, v209
  v_add_f32 v56, v56, v44
  v_fmac_f32 v57, v44, v44
  v_add_f32 v56, v56, v45
  v_fmac_f32 v57, v45, v45
  v_add_f32 v56, v56, v46
  v_fmac_f32 v57, v46, v46
  v_add_f32 v56, v56, v47
  v_fmac_f32 v57, v47, v47
  v_mov_b32 v48, v56
  s_nop 1
  v_permlane32_swap_b32 v56, v48
  v_add_f32 v56, v56, v48
  v_mov_b32 v48, v56
  s_nop 1
  v_permlane16_swap_b32 v56, v48
  v_add_f32 v56, v56, v48
  v_mov_b32 v48, v57
  s_nop 1
  v_permlane32_swap_b32 v57, v48
  v_add_f32 v57, v57, v48
  v_mov_b32 v48, v57
  s_nop 1
  v_permlane16_swap_b32 v57, v48
  v_add_f32 v57, v57, v48
  buffer_store_dwordx2 v[56:57], v5, s[40:43], 0 offen sc1
  s_and_b32 s11, s13, 1
  s_lshl_b32 s11, s11, 3
  s_and_b32 s15, s14, 7
  s_add_u32 s11, s11, s15
  s_lshr_b32 s12, s13, 1
  s_lshl_b32 s12, s12, 2
  s_lshr_b32 s29, s14, 3
  s_add_u32 s12, s12, s29
  s_mov_b32 s33, s12
  s_mul_i32 s12, s12, 27
  s_lshr_b32 s12, s12, 2
  v_lshrrev_b32 v6, 4, v0
  v_and_b32 v7, 15, v0
  v_lshrrev_b32 v8, 1, v6
  v_and_b32 v9, 1, v6
  v_lshlrev_b32 v10, 4, v7
  v_lshl_add_u32 v10, v8, 10, v10
  v_lshl_add_u32 v1, v9, 8, v10
  v_lshl_add_u32 v2, v9, 9, v10
  s_lshl_b32 s17, s10, 11
  s_add_u32 s17, s17, 14336
  v_add_u32 v2, s17, v2
  v_add_u32 v188, 65536, v1
  v_add_u32 v189, 131072, v1
  v_add_u32 v190, 65536, v2
  v_add_u32 v191, 131072, v2
  s_lshl_b32 s16, s11, 2
  s_add_u32 s16, s16, s10
  s_lshl_b32 s17, s16, 11
  v_lshl_add_u32 v10, v7, 3, s17
  v_lshl_add_u32 v3, v6, 8, v10
  s_lshl_b32 s17, s16, 1
  v_add_u32 v10, s17, v9
  v_mul_u32_u24 v10, 55296, v10
  v_lshl_add_u32 v10, v8, 8, v10
  v_lshl_add_u32 v4, v7, 4, v10
  v_lshlrev_b32 v5, 4, v6
  v_add_u32 v5, 157696, v5
  s_waitcnt lgkmcnt(0)
  s_add_u32 s24, s8, 14680064
  s_addc_u32 s25, s9, 0
  s_and_b32 s25, s25, 0xffff
  s_mov_b32 s26, 131072
  s_mov_b32 s27, 0x00020000
  s_add_u32 s28, s8, 16777216
  s_addc_u32 s29, s9, 0
  s_and_b32 s29, s29, 0xffff
  s_mov_b32 s30, 7077888
  s_mov_b32 s31, 0x00020000
  s_mov_b32 s36, 0x3acccccd
  s_mov_b32 s37, 0x3727c5ac
  s_waitcnt vmcnt(0)
  s_barrier
  s_barrier
  s_barrier
  ds_read_b128 v[160:163], v2
  ds_read_b128 v[164:167], v2 offset:256
  ds_read_b128 v[128:131], v1
  ds_read_b128 v[132:135], v1 offset:512
  ds_read_b128 v[136:139], v1 offset:2048
  ds_read_b128 v[140:143], v1 offset:2560
  ds_read_b128 v[144:147], v1 offset:4096
  ds_read_b128 v[148:151], v1 offset:4608
  s_waitcnt lgkmcnt(5)
  v_mfma_f32_16x16x32_bf16 v[16:19], v[128:131], v[160:163], 0
  ds_read_b128 v[152:155], v1 offset:6144
  v_mfma_f32_16x16x32_bf16 v[72:75], v[128:131], v[164:167], 0
  s_waitcnt lgkmcnt(5)
  v_mfma_f32_16x16x32_bf16 v[20:23], v[132:135], v[160:163], 0
  ds_read_b128 v[156:159], v1 offset:6656
  v_mfma_f32_16x16x32_bf16 v[76:79], v[132:135], v[164:167], 0
  s_waitcnt lgkmcnt(5)
  v_mfma_f32_16x16x32_bf16 v[24:27], v[136:139], v[160:163], 0
  ds_read_b128 v[128:131], v1 offset:8192
  v_mfma_f32_16x16x32_bf16 v[80:83], v[136:139], v[164:167], 0
  s_waitcnt lgkmcnt(5)
  v_mfma_f32_16x16x32_bf16 v[28:31], v[140:143], v[160:163], 0
  ds_read_b128 v[132:135], v1 offset:8704
  v_mfma_f32_16x16x32_bf16 v[84:87], v[140:143], v[164:167], 0
  s_waitcnt lgkmcnt(5)
  v_mfma_f32_16x16x32_bf16 v[32:35], v[144:147], v[160:163], 0
  ds_read_b128 v[136:139], v1 offset:10240
  v_mfma_f32_16x16x32_bf16 v[88:91], v[144:147], v[164:167], 0
  s_waitcnt lgkmcnt(5)
  v_mfma_f32_16x16x32_bf16 v[36:39], v[148:151], v[160:163], 0
  ds_read_b128 v[140:143], v1 offset:10752
  v_mfma_f32_16x16x32_bf16 v[92:95], v[148:151], v[164:167], 0
  s_waitcnt lgkmcnt(5)
  v_mfma_f32_16x16x32_bf16 v[40:43], v[152:155], v[160:163], 0
  ds_read_b128 v[144:147], v1 offset:12288
  v_mfma_f32_16x16x32_bf16 v[96:99], v[152:155], v[164:167], 0
  s_waitcnt lgkmcnt(5)
  v_mfma_f32_16x16x32_bf16 v[44:47], v[156:159], v[160:163], 0
  ds_read_b128 v[148:151], v1 offset:12800
  v_mfma_f32_16x16x32_bf16 v[100:103], v[156:159], v[164:167], 0
  s_barrier
  ds_read_b128 v[168:171], v2 offset:22528
  ds_read_b128 v[172:175], v2 offset:22784
  s_waitcnt lgkmcnt(7)
  v_mfma_f32_16x16x32_bf16 v[48:51], v[128:131], v[160:163], 0
  ds_read_b128 v[152:155], v1 offset:22528
  v_mfma_f32_16x16x32_bf16 v[104:107], v[128:131], v[164:167], 0
  s_waitcnt lgkmcnt(7)
  v_mfma_f32_16x16x32_bf16 v[52:55], v[132:135], v[160:163], 0
  ds_read_b128 v[156:159], v1 offset:23040
  v_mfma_f32_16x16x32_bf16 v[108:111], v[132:135], v[164:167], 0
  s_waitcnt lgkmcnt(7)
  v_mfma_f32_16x16x32_bf16 v[56:59], v[136:139], v[160:163], 0
  ds_read_b128 v[128:131], v1 offset:24576
  v_mfma_f32_16x16x32_bf16 v[112:115], v[136:139], v[164:167], 0
  s_waitcnt lgkmcnt(7)
  v_mfma_f32_16x16x32_bf16 v[60:63], v[140:143], v[160:163], 0
  ds_read_b128 v[132:135], v1 offset:25088
  v_mfma_f32_16x16x32_bf16 v[116:119], v[140:143], v[164:167], 0
  s_waitcnt lgkmcnt(7)
  v_mfma_f32_16x16x32_bf16 v[64:67], v[144:147], v[160:163], 0
  ds_read_b128 v[136:139], v1 offset:26624
  v_mfma_f32_16x16x32_bf16 v[120:123], v[144:147], v[164:167], 0
  s_waitcnt lgkmcnt(7)
  v_mfma_f32_16x16x32_bf16 v[68:71], v[148:151], v[160:163], 0
  ds_read_b128 v[140:143], v1 offset:27136
  v_mfma_f32_16x16x32_bf16 v[124:127], v[148:151], v[164:167], 0
  s_waitcnt lgkmcnt(5)
  v_mfma_f32_16x16x32_bf16 v[16:19], v[152:155], v[168:171], v[16:19]
  ds_read_b128 v[144:147], v1 offset:28672
  v_mfma_f32_16x16x32_bf16 v[72:75], v[152:155], v[172:175], v[72:75]
  s_waitcnt lgkmcnt(5)
  v_mfma_f32_16x16x32_bf16 v[20:23], v[156:159], v[168:171], v[20:23]
  ds_read_b128 v[148:151], v1 offset:29184
  v_mfma_f32_16x16x32_bf16 v[76:79], v[156:159], v[172:175], v[76:79]
  s_waitcnt lgkmcnt(5)
  v_mfma_f32_16x16x32_bf16 v[24:27], v[128:131], v[168:171], v[24:27]
  ds_read_b128 v[152:155], v1 offset:30720
  v_mfma_f32_16x16x32_bf16 v[80:83], v[128:131], v[172:175], v[80:83]
  s_waitcnt lgkmcnt(5)
  v_mfma_f32_16x16x32_bf16 v[28:31], v[132:135], v[168:171], v[28:31]
  ds_read_b128 v[156:159], v1 offset:31232
  v_mfma_f32_16x16x32_bf16 v[84:87], v[132:135], v[172:175], v[84:87]
  s_waitcnt lgkmcnt(5)
  v_mfma_f32_16x16x32_bf16 v[32:35], v[136:139], v[168:171], v[32:35]
  ds_read_b128 v[128:131], v1 offset:32768
  v_mfma_f32_16x16x32_bf16 v[88:91], v[136:139], v[172:175], v[88:91]
  s_waitcnt lgkmcnt(5)
  v_mfma_f32_16x16x32_bf16 v[36:39], v[140:143], v[168:171], v[36:39]
  ds_read_b128 v[132:135], v1 offset:33280
  v_mfma_f32_16x16x32_bf16 v[92:95], v[140:143], v[172:175], v[92:95]
  s_waitcnt lgkmcnt(5)
  v_mfma_f32_16x16x32_bf16 v[40:43], v[144:147], v[168:171], v[40:43]
  ds_read_b128 v[136:139], v1 offset:34816
  v_mfma_f32_16x16x32_bf16 v[96:99], v[144:147], v[172:175], v[96:99]
  s_waitcnt lgkmcnt(5)
  v_mfma_f32_16x16x32_bf16 v[44:47], v[148:151], v[168:171], v[44:47]
  ds_read_b128 v[140:143], v1 offset:35328
  v_mfma_f32_16x16x32_bf16 v[100:103], v[148:151], v[172:175], v[100:103]
  s_barrier
  ds_read_b128 v[160:163], v2 offset:45056
  ds_read_b128 v[164:167], v2 offset:45312
  s_waitcnt lgkmcnt(7)
  v_mfma_f32_16x16x32_bf16 v[48:51], v[152:155], v[168:171], v[48:51]
  ds_read_b128 v[144:147], v1 offset:45056
  v_mfma_f32_16x16x32_bf16 v[104:107], v[152:155], v[172:175], v[104:107]
  s_waitcnt lgkmcnt(7)
  v_mfma_f32_16x16x32_bf16 v[52:55], v[156:159], v[168:171], v[52:55]
  ds_read_b128 v[148:151], v1 offset:45568
  v_mfma_f32_16x16x32_bf16 v[108:111], v[156:159], v[172:175], v[108:111]
  s_waitcnt lgkmcnt(7)
  v_mfma_f32_16x16x32_bf16 v[56:59], v[128:131], v[168:171], v[56:59]
  ds_read_b128 v[152:155], v1 offset:47104
  v_mfma_f32_16x16x32_bf16 v[112:115], v[128:131], v[172:175], v[112:115]
  s_waitcnt lgkmcnt(7)
  v_mfma_f32_16x16x32_bf16 v[60:63], v[132:135], v[168:171], v[60:63]
  ds_read_b128 v[156:159], v1 offset:47616
  v_mfma_f32_16x16x32_bf16 v[116:119], v[132:135], v[172:175], v[116:119]
  s_waitcnt lgkmcnt(7)
  v_mfma_f32_16x16x32_bf16 v[64:67], v[136:139], v[168:171], v[64:67]
  ds_read_b128 v[128:131], v1 offset:49152
  v_mfma_f32_16x16x32_bf16 v[120:123], v[136:139], v[172:175], v[120:123]
  s_waitcnt lgkmcnt(7)
  v_mfma_f32_16x16x32_bf16 v[68:71], v[140:143], v[168:171], v[68:71]
  ds_read_b128 v[132:135], v1 offset:49664
  v_mfma_f32_16x16x32_bf16 v[124:127], v[140:143], v[172:175], v[124:127]
  s_waitcnt lgkmcnt(5)
  v_mfma_f32_16x16x32_bf16 v[16:19], v[144:147], v[160:163], v[16:19]
  ds_read_b128 v[136:139], v1 offset:51200
  v_mfma_f32_16x16x32_bf16 v[72:75], v[144:147], v[164:167], v[72:75]
  s_waitcnt lgkmcnt(5)
  v_mfma_f32_16x16x32_bf16 v[20:23], v[148:151], v[160:163], v[20:23]
  ds_read_b128 v[140:143], v1 offset:51712
  v_mfma_f32_16x16x32_bf16 v[76:79], v[148:151], v[164:167], v[76:79]
  s_waitcnt lgkmcnt(5)
  v_mfma_f32_16x16x32_bf16 v[24:27], v[152:155], v[160:163], v[24:27]
  ds_read_b128 v[144:147], v1 offset:53248
  v_mfma_f32_16x16x32_bf16 v[80:83], v[152:155], v[164:167], v[80:83]
  s_waitcnt lgkmcnt(5)
  v_mfma_f32_16x16x32_bf16 v[28:31], v[156:159], v[160:163], v[28:31]
  ds_read_b128 v[148:151], v1 offset:53760
  v_mfma_f32_16x16x32_bf16 v[84:87], v[156:159], v[164:167], v[84:87]
  s_waitcnt lgkmcnt(5)
  v_mfma_f32_16x16x32_bf16 v[32:35], v[128:131], v[160:163], v[32:35]
  ds_read_b128 v[152:155], v1 offset:55296
  v_mfma_f32_16x16x32_bf16 v[88:91], v[128:131], v[164:167], v[88:91]
  s_waitcnt lgkmcnt(5)
  v_mfma_f32_16x16x32_bf16 v[36:39], v[132:135], v[160:163], v[36:39]
  ds_read_b128 v[156:159], v1 offset:55808
  v_mfma_f32_16x16x32_bf16 v[92:95], v[132:135], v[164:167], v[92:95]
  s_waitcnt lgkmcnt(5)
  v_mfma_f32_16x16x32_bf16 v[40:43], v[136:139], v[160:163], v[40:43]
  ds_read_b128 v[128:131], v1 offset:57344
  v_mfma_f32_16x16x32_bf16 v[96:99], v[136:139], v[164:167], v[96:99]
  s_waitcnt lgkmcnt(5)
  v_mfma_f32_16x16x32_bf16 v[44:47], v[140:143], v[160:163], v[44:47]
  ds_read_b128 v[132:135], v1 offset:57856
  v_mfma_f32_16x16x32_bf16 v[100:103], v[140:143], v[164:167], v[100:103]
  s_barrier
  ds_read_b128 v[168:171], v190 offset:2048
  ds_read_b128 v[172:175], v190 offset:2304
  s_waitcnt lgkmcnt(7)
  v_mfma_f32_16x16x32_bf16 v[48:51], v[144:147], v[160:163], v[48:51]
  ds_read_b128 v[136:139], v188 offset:2048
  v_mfma_f32_16x16x32_bf16 v[104:107], v[144:147], v[164:167], v[104:107]
  s_waitcnt lgkmcnt(7)
  v_mfma_f32_16x16x32_bf16 v[52:55], v[148:151], v[160:163], v[52:55]
  ds_read_b128 v[140:143], v188 offset:2560
  v_mfma_f32_16x16x32_bf16 v[108:111], v[148:151], v[164:167], v[108:111]
  s_waitcnt lgkmcnt(7)
  v_mfma_f32_16x16x32_bf16 v[56:59], v[152:155], v[160:163], v[56:59]
  ds_read_b128 v[144:147], v188 offset:4096
  v_mfma_f32_16x16x32_bf16 v[112:115], v[152:155], v[164:167], v[112:115]
  s_waitcnt lgkmcnt(7)
  v_mfma_f32_16x16x32_bf16 v[60:63], v[156:159], v[160:163], v[60:63]
  ds_read_b128 v[148:151], v188 offset:4608
  v_mfma_f32_16x16x32_bf16 v[116:119], v[156:159], v[164:167], v[116:119]
  s_waitcnt lgkmcnt(7)
  v_mfma_f32_16x16x32_bf16 v[64:67], v[128:131], v[160:163], v[64:67]
  ds_read_b128 v[152:155], v188 offset:6144
  v_mfma_f32_16x16x32_bf16 v[120:123], v[128:131], v[164:167], v[120:123]
  s_waitcnt lgkmcnt(7)
  v_mfma_f32_16x16x32_bf16 v[68:71], v[132:135], v[160:163], v[68:71]
  ds_read_b128 v[156:159], v188 offset:6656
  v_mfma_f32_16x16x32_bf16 v[124:127], v[132:135], v[164:167], v[124:127]
  s_waitcnt lgkmcnt(5)
  v_mfma_f32_16x16x32_bf16 v[16:19], v[136:139], v[168:171], v[16:19]
  ds_read_b128 v[128:131], v188 offset:8192
  v_mfma_f32_16x16x32_bf16 v[72:75], v[136:139], v[172:175], v[72:75]
  buffer_load_dwordx2 v[176:177], v3, s[24:27], 0 offen offset:0
  buffer_load_dwordx2 v[178:179], v3, s[24:27], 0 offen offset:128
  s_waitcnt lgkmcnt(5)
  v_mfma_f32_16x16x32_bf16 v[20:23], v[140:143], v[168:171], v[20:23]
  ds_read_b128 v[132:135], v188 offset:8704
  v_mfma_f32_16x16x32_bf16 v[76:79], v[140:143], v[172:175], v[76:79]
  buffer_load_dwordx2 v[180:181], v3, s[24:27], 0 offen offset:1024
  buffer_load_dwordx2 v[182:183], v3, s[24:27], 0 offen offset:1152
  s_waitcnt lgkmcnt(5)
  v_mfma_f32_16x16x32_bf16 v[24:27], v[144:147], v[168:171], v[24:27]
  ds_read_b128 v[136:139], v188 offset:10240
  v_mfma_f32_16x16x32_bf16 v[80:83], v[144:147], v[172:175], v[80:83]
  s_waitcnt lgkmcnt(5)
  v_mfma_f32_16x16x32_bf16 v[28:31], v[148:151], v[168:171], v[28:31]
  ds_read_b128 v[140:143], v188 offset:10752
  v_mfma_f32_16x16x32_bf16 v[84:87], v[148:151], v[172:175], v[84:87]
  s_waitcnt lgkmcnt(5)
  v_mfma_f32_16x16x32_bf16 v[32:35], v[152:155], v[168:171], v[32:35]
  ds_read_b128 v[144:147], v188 offset:12288
  v_mfma_f32_16x16x32_bf16 v[88:91], v[152:155], v[172:175], v[88:91]
  s_waitcnt lgkmcnt(5)
  v_mfma_f32_16x16x32_bf16 v[36:39], v[156:159], v[168:171], v[36:39]
  ds_read_b128 v[148:151], v188 offset:12800
  v_mfma_f32_16x16x32_bf16 v[92:95], v[156:159], v[172:175], v[92:95]
  s_waitcnt lgkmcnt(5)
  v_mfma_f32_16x16x32_bf16 v[40:43], v[128:131], v[168:171], v[40:43]
  ds_read_b128 v[152:155], v188 offset:14336
  v_mfma_f32_16x16x32_bf16 v[96:99], v[128:131], v[172:175], v[96:99]
  s_waitcnt lgkmcnt(5)
  v_mfma_f32_16x16x32_bf16 v[44:47], v[132:135], v[168:171], v[44:47]
  ds_read_b128 v[156:159], v188 offset:14848
  v_mfma_f32_16x16x32_bf16 v[100:103], v[132:135], v[172:175], v[100:103]
  s_barrier
  ds_read_b128 v[160:163], v190 offset:24576
  ds_read_b128 v[164:167], v190 offset:24832
  s_waitcnt lgkmcnt(7)
  v_mfma_f32_16x16x32_bf16 v[48:51], v[136:139], v[168:171], v[48:51]
  ds_read_b128 v[128:131], v188 offset:24576
  v_mfma_f32_16x16x32_bf16 v[104:107], v[136:139], v[172:175], v[104:107]
  s_waitcnt lgkmcnt(7)
  v_mfma_f32_16x16x32_bf16 v[52:55], v[140:143], v[168:171], v[52:55]
  ds_read_b128 v[132:135], v188 offset:25088
  v_mfma_f32_16x16x32_bf16 v[108:111], v[140:143], v[172:175], v[108:111]
  s_waitcnt lgkmcnt(7)
  v_mfma_f32_16x16x32_bf16 v[56:59], v[144:147], v[168:171], v[56:59]
  ds_read_b128 v[136:139], v188 offset:26624
  v_mfma_f32_16x16x32_bf16 v[112:115], v[144:147], v[172:175], v[112:115]
  s_waitcnt lgkmcnt(7)
  v_mfma_f32_16x16x32_bf16 v[60:63], v[148:151], v[168:171], v[60:63]
  ds_read_b128 v[140:143], v188 offset:27136
  v_mfma_f32_16x16x32_bf16 v[116:119], v[148:151], v[172:175], v[116:119]
  s_waitcnt lgkmcnt(7)
  v_mfma_f32_16x16x32_bf16 v[64:67], v[152:155], v[168:171], v[64:67]
  ds_read_b128 v[144:147], v188 offset:28672
  v_mfma_f32_16x16x32_bf16 v[120:123], v[152:155], v[172:175], v[120:123]
  s_waitcnt lgkmcnt(7)
  v_mfma_f32_16x16x32_bf16 v[68:71], v[156:159], v[168:171], v[68:71]
  ds_read_b128 v[148:151], v188 offset:29184
  v_mfma_f32_16x16x32_bf16 v[124:127], v[156:159], v[172:175], v[124:127]
  s_waitcnt lgkmcnt(5)
  v_mfma_f32_16x16x32_bf16 v[16:19], v[128:131], v[160:163], v[16:19]
  ds_read_b128 v[152:155], v188 offset:30720
  v_mfma_f32_16x16x32_bf16 v[72:75], v[128:131], v[164:167], v[72:75]
  s_waitcnt lgkmcnt(5)
  v_mfma_f32_16x16x32_bf16 v[20:23], v[132:135], v[160:163], v[20:23]
  ds_read_b128 v[156:159], v188 offset:31232
  v_mfma_f32_16x16x32_bf16 v[76:79], v[132:135], v[164:167], v[76:79]
  s_waitcnt lgkmcnt(5)
  v_mfma_f32_16x16x32_bf16 v[24:27], v[136:139], v[160:163], v[24:27]
  ds_read_b128 v[128:131], v188 offset:32768
  v_mfma_f32_16x16x32_bf16 v[80:83], v[136:139], v[164:167], v[80:83]
  s_waitcnt lgkmcnt(5)
  v_mfma_f32_16x16x32_bf16 v[28:31], v[140:143], v[160:163], v[28:31]
  ds_read_b128 v[132:135], v188 offset:33280
  v_mfma_f32_16x16x32_bf16 v[84:87], v[140:143], v[164:167], v[84:87]
  s_waitcnt lgkmcnt(5)
  v_mfma_f32_16x16x32_bf16 v[32:35], v[144:147], v[160:163], v[32:35]
  ds_read_b128 v[136:139], v188 offset:34816
  v_mfma_f32_16x16x32_bf16 v[88:91], v[144:147], v[164:167], v[88:91]
  s_waitcnt lgkmcnt(5)
  v_mfma_f32_16x16x32_bf16 v[36:39], v[148:151], v[160:163], v[36:39]
  ds_read_b128 v[140:143], v188 offset:35328
  v_mfma_f32_16x16x32_bf16 v[92:95], v[148:151], v[164:167], v[92:95]
  s_waitcnt lgkmcnt(5)
  v_mfma_f32_16x16x32_bf16 v[40:43], v[152:155], v[160:163], v[40:43]
  ds_read_b128 v[144:147], v188 offset:36864
  v_mfma_f32_16x16x32_bf16 v[96:99], v[152:155], v[164:167], v[96:99]
  s_waitcnt lgkmcnt(5)
  v_mfma_f32_16x16x32_bf16 v[44:47], v[156:159], v[160:163], v[44:47]
  ds_read_b128 v[148:151], v188 offset:37376
  v_mfma_f32_16x16x32_bf16 v[100:103], v[156:159], v[164:167], v[100:103]
  s_barrier
  ds_read_b128 v[168:171], v190 offset:47104
  ds_read_b128 v[172:175], v190 offset:47360
  s_waitcnt lgkmcnt(7)
  v_mfma_f32_16x16x32_bf16 v[48:51], v[128:131], v[160:163], v[48:51]
  ds_read_b128 v[152:155], v188 offset:47104
  v_mfma_f32_16x16x32_bf16 v[104:107], v[128:131], v[164:167], v[104:107]
  s_waitcnt lgkmcnt(7)
  v_mfma_f32_16x16x32_bf16 v[52:55], v[132:135], v[160:163], v[52:55]
  ds_read_b128 v[156:159], v188 offset:47616
  v_mfma_f32_16x16x32_bf16 v[108:111], v[132:135], v[164:167], v[108:111]
  s_waitcnt lgkmcnt(7)
  v_mfma_f32_16x16x32_bf16 v[56:59], v[136:139], v[160:163], v[56:59]
  ds_read_b128 v[128:131], v188 offset:49152
  v_mfma_f32_16x16x32_bf16 v[112:115], v[136:139], v[164:167], v[112:115]
  s_waitcnt lgkmcnt(7)
  v_mfma_f32_16x16x32_bf16 v[60:63], v[140:143], v[160:163], v[60:63]
  ds_read_b128 v[132:135], v188 offset:49664
  v_mfma_f32_16x16x32_bf16 v[116:119], v[140:143], v[164:167], v[116:119]
  s_waitcnt lgkmcnt(7)
  v_mfma_f32_16x16x32_bf16 v[64:67], v[144:147], v[160:163], v[64:67]
  ds_read_b128 v[136:139], v188 offset:51200
  v_mfma_f32_16x16x32_bf16 v[120:123], v[144:147], v[164:167], v[120:123]
  s_waitcnt lgkmcnt(7)
  v_mfma_f32_16x16x32_bf16 v[68:71], v[148:151], v[160:163], v[68:71]
  ds_read_b128 v[140:143], v188 offset:51712
  v_mfma_f32_16x16x32_bf16 v[124:127], v[148:151], v[164:167], v[124:127]
  s_waitcnt lgkmcnt(5)
  v_mfma_f32_16x16x32_bf16 v[16:19], v[152:155], v[168:171], v[16:19]
  ds_read_b128 v[144:147], v188 offset:53248
  v_mfma_f32_16x16x32_bf16 v[72:75], v[152:155], v[172:175], v[72:75]
  s_waitcnt lgkmcnt(5)
  v_mfma_f32_16x16x32_bf16 v[20:23], v[156:159], v[168:171], v[20:23]
  ds_read_b128 v[148:151], v188 offset:53760
  v_mfma_f32_16x16x32_bf16 v[76:79], v[156:159], v[172:175], v[76:79]
  s_waitcnt lgkmcnt(5)
  v_mfma_f32_16x16x32_bf16 v[24:27], v[128:131], v[168:171], v[24:27]
  ds_read_b128 v[152:155], v188 offset:55296
  v_mfma_f32_16x16x32_bf16 v[80:83], v[128:131], v[172:175], v[80:83]
  s_waitcnt lgkmcnt(5)
  v_mfma_f32_16x16x32_bf16 v[28:31], v[132:135], v[168:171], v[28:31]
  ds_read_b128 v[156:159], v188 offset:55808
  v_mfma_f32_16x16x32_bf16 v[84:87], v[132:135], v[172:175], v[84:87]
  s_waitcnt lgkmcnt(5)
  v_mfma_f32_16x16x32_bf16 v[32:35], v[136:139], v[168:171], v[32:35]
  ds_read_b128 v[128:131], v188 offset:57344
  v_mfma_f32_16x16x32_bf16 v[88:91], v[136:139], v[172:175], v[88:91]
  s_waitcnt lgkmcnt(5)
  v_mfma_f32_16x16x32_bf16 v[36:39], v[140:143], v[168:171], v[36:39]
  ds_read_b128 v[132:135], v188 offset:57856
  v_mfma_f32_16x16x32_bf16 v[92:95], v[140:143], v[172:175], v[92:95]
  s_waitcnt lgkmcnt(5)
  v_mfma_f32_16x16x32_bf16 v[40:43], v[144:147], v[168:171], v[40:43]
  ds_read_b128 v[136:139], v188 offset:59392
  v_mfma_f32_16x16x32_bf16 v[96:99], v[144:147], v[172:175], v[96:99]
  s_waitcnt lgkmcnt(5)
  v_mfma_f32_16x16x32_bf16 v[44:47], v[148:151], v[168:171], v[44:47]
  ds_read_b128 v[140:143], v188 offset:59904
  v_mfma_f32_16x16x32_bf16 v[100:103], v[148:151], v[172:175], v[100:103]
  s_barrier
  ds_read_b128 v[160:163], v191 offset:4096
  ds_read_b128 v[164:167], v191 offset:4352
  s_waitcnt lgkmcnt(7)
  v_mfma_f32_16x16x32_bf16 v[48:51], v[152:155], v[168:171], v[48:51]
  ds_read_b128 v[144:147], v189 offset:4096
  v_mfma_f32_16x16x32_bf16 v[104:107], v[152:155], v[172:175], v[104:107]
  s_waitcnt lgkmcnt(7)
  v_mfma_f32_16x16x32_bf16 v[52:55], v[156:159], v[168:171], v[52:55]
  ds_read_b128 v[148:151], v189 offset:4608
  v_mfma_f32_16x16x32_bf16 v[108:111], v[156:159], v[172:175], v[108:111]
  s_waitcnt lgkmcnt(7)
  v_mfma_f32_16x16x32_bf16 v[56:59], v[128:131], v[168:171], v[56:59]
  ds_read_b128 v[152:155], v189 offset:6144
  v_mfma_f32_16x16x32_bf16 v[112:115], v[128:131], v[172:175], v[112:115]
  s_waitcnt lgkmcnt(7)
  v_mfma_f32_16x16x32_bf16 v[60:63], v[132:135], v[168:171], v[60:63]
  ds_read_b128 v[156:159], v189 offset:6656
  v_mfma_f32_16x16x32_bf16 v[116:119], v[132:135], v[172:175], v[116:119]
  s_waitcnt lgkmcnt(7)
  v_mfma_f32_16x16x32_bf16 v[64:67], v[136:139], v[168:171], v[64:67]
  ds_read_b128 v[128:131], v189 offset:8192
  v_mfma_f32_16x16x32_bf16 v[120:123], v[136:139], v[172:175], v[120:123]
  s_waitcnt lgkmcnt(7)
  v_mfma_f32_16x16x32_bf16 v[68:71], v[140:143], v[168:171], v[68:71]
  ds_read_b128 v[132:135], v189 offset:8704
  v_mfma_f32_16x16x32_bf16 v[124:127], v[140:143], v[172:175], v[124:127]
  s_waitcnt lgkmcnt(5)
  v_mfma_f32_16x16x32_bf16 v[16:19], v[144:147], v[160:163], v[16:19]
  ds_read_b128 v[136:139], v189 offset:10240
  v_mfma_f32_16x16x32_bf16 v[72:75], v[144:147], v[164:167], v[72:75]
  s_waitcnt lgkmcnt(5)
  v_mfma_f32_16x16x32_bf16 v[20:23], v[148:151], v[160:163], v[20:23]
  ds_read_b128 v[140:143], v189 offset:10752
  v_mfma_f32_16x16x32_bf16 v[76:79], v[148:151], v[164:167], v[76:79]
  s_waitcnt lgkmcnt(5)
  v_mfma_f32_16x16x32_bf16 v[24:27], v[152:155], v[160:163], v[24:27]
  ds_read_b128 v[144:147], v189 offset:12288
  v_mfma_f32_16x16x32_bf16 v[80:83], v[152:155], v[164:167], v[80:83]
  s_waitcnt lgkmcnt(5)
  v_mfma_f32_16x16x32_bf16 v[28:31], v[156:159], v[160:163], v[28:31]
  ds_read_b128 v[148:151], v189 offset:12800
  v_mfma_f32_16x16x32_bf16 v[84:87], v[156:159], v[164:167], v[84:87]
  s_waitcnt lgkmcnt(5)
  v_mfma_f32_16x16x32_bf16 v[32:35], v[128:131], v[160:163], v[32:35]
  ds_read_b128 v[152:155], v189 offset:14336
  v_mfma_f32_16x16x32_bf16 v[88:91], v[128:131], v[164:167], v[88:91]
  s_waitcnt lgkmcnt(5)
  v_mfma_f32_16x16x32_bf16 v[36:39], v[132:135], v[160:163], v[36:39]
  ds_read_b128 v[156:159], v189 offset:14848
  v_mfma_f32_16x16x32_bf16 v[92:95], v[132:135], v[164:167], v[92:95]
  s_waitcnt lgkmcnt(5)
  v_mfma_f32_16x16x32_bf16 v[40:43], v[136:139], v[160:163], v[40:43]
  ds_read_b128 v[128:131], v189 offset:16384
  v_mfma_f32_16x16x32_bf16 v[96:99], v[136:139], v[164:167], v[96:99]
  s_waitcnt lgkmcnt(5)
  v_mfma_f32_16x16x32_bf16 v[44:47], v[140:143], v[160:163], v[44:47]
  ds_read_b128 v[132:135], v189 offset:16896
  v_mfma_f32_16x16x32_bf16 v[100:103], v[140:143], v[164:167], v[100:103]
  s_barrier
  ds_read_b128 v[168:171], v2
  ds_read_b128 v[172:175], v2 offset:256
  s_waitcnt lgkmcnt(7)
  v_mfma_f32_16x16x32_bf16 v[48:51], v[144:147], v[160:163], v[48:51]
  ds_read_b128 v[136:139], v1
  v_mfma_f32_16x16x32_bf16 v[104:107], v[144:147], v[164:167], v[104:107]
  s_waitcnt lgkmcnt(7)
  v_mfma_f32_16x16x32_bf16 v[52:55], v[148:151], v[160:163], v[52:55]
  ds_read_b128 v[140:143], v1 offset:512
  v_mfma_f32_16x16x32_bf16 v[108:111], v[148:151], v[164:167], v[108:111]
  s_waitcnt lgkmcnt(7)
  v_mfma_f32_16x16x32_bf16 v[56:59], v[152:155], v[160:163], v[56:59]
  ds_read_b128 v[144:147], v1 offset:2048
  v_mfma_f32_16x16x32_bf16 v[112:115], v[152:155], v[164:167], v[112:115]
  s_waitcnt lgkmcnt(7)
  v_mfma_f32_16x16x32_bf16 v[60:63], v[156:159], v[160:163], v[60:63]
  ds_read_b128 v[148:151], v1 offset:2560
  v_mfma_f32_16x16x32_bf16 v[116:119], v[156:159], v[164:167], v[116:119]
  s_waitcnt lgkmcnt(7)
  v_mfma_f32_16x16x32_bf16 v[64:67], v[128:131], v[160:163], v[64:67]
  ds_read_b128 v[152:155], v1 offset:4096
  v_mfma_f32_16x16x32_bf16 v[120:123], v[128:131], v[164:167], v[120:123]
  s_waitcnt lgkmcnt(7)
  v_mfma_f32_16x16x32_bf16 v[68:71], v[132:135], v[160:163], v[68:71]
  ds_read_b128 v[156:159], v1 offset:4608
  v_mfma_f32_16x16x32_bf16 v[124:127], v[132:135], v[164:167], v[124:127]
  s_waitcnt lgkmcnt(5)
  v_mfma_f32_16x16x32_bf16 v[16:19], v[136:139], v[168:171], v[16:19]
  ds_read_b128 v[128:131], v1 offset:6144
  v_mfma_f32_16x16x32_bf16 v[72:75], v[136:139], v[172:175], v[72:75]
  s_waitcnt lgkmcnt(5)
  v_mfma_f32_16x16x32_bf16 v[20:23], v[140:143], v[168:171], v[20:23]
  ds_read_b128 v[132:135], v1 offset:6656
  v_mfma_f32_16x16x32_bf16 v[76:79], v[140:143], v[172:175], v[76:79]
  s_waitcnt lgkmcnt(5)
  v_mfma_f32_16x16x32_bf16 v[24:27], v[144:147], v[168:171], v[24:27]
  ds_read_b128 v[136:139], v1 offset:8192
  v_mfma_f32_16x16x32_bf16 v[80:83], v[144:147], v[172:175], v[80:83]
  s_waitcnt lgkmcnt(5)
  v_mfma_f32_16x16x32_bf16 v[28:31], v[148:151], v[168:171], v[28:31]
  ds_read_b128 v[140:143], v1 offset:8704
  v_mfma_f32_16x16x32_bf16 v[84:87], v[148:151], v[172:175], v[84:87]
  s_waitcnt lgkmcnt(5)
  v_mfma_f32_16x16x32_bf16 v[32:35], v[152:155], v[168:171], v[32:35]
  ds_read_b128 v[144:147], v1 offset:10240
  v_mfma_f32_16x16x32_bf16 v[88:91], v[152:155], v[172:175], v[88:91]
  s_waitcnt lgkmcnt(5)
  v_mfma_f32_16x16x32_bf16 v[36:39], v[156:159], v[168:171], v[36:39]
  ds_read_b128 v[148:151], v1 offset:10752
  v_mfma_f32_16x16x32_bf16 v[92:95], v[156:159], v[172:175], v[92:95]
  s_waitcnt lgkmcnt(5)
  v_mfma_f32_16x16x32_bf16 v[40:43], v[128:131], v[168:171], v[40:43]
  ds_read_b128 v[152:155], v1 offset:12288
  v_mfma_f32_16x16x32_bf16 v[96:99], v[128:131], v[172:175], v[96:99]
  s_waitcnt lgkmcnt(5)
  v_mfma_f32_16x16x32_bf16 v[44:47], v[132:135], v[168:171], v[44:47]
  ds_read_b128 v[156:159], v1 offset:12800
  v_mfma_f32_16x16x32_bf16 v[100:103], v[132:135], v[172:175], v[100:103]
  s_barrier
  ds_read_b128 v[160:163], v2 offset:22528
  ds_read_b128 v[164:167], v2 offset:22784
  s_waitcnt lgkmcnt(7)
  v_mfma_f32_16x16x32_bf16 v[48:51], v[136:139], v[168:171], v[48:51]
  ds_read_b128 v[128:131], v1 offset:22528
  v_mfma_f32_16x16x32_bf16 v[104:107], v[136:139], v[172:175], v[104:107]
  s_waitcnt lgkmcnt(7)
  v_mfma_f32_16x16x32_bf16 v[52:55], v[140:143], v[168:171], v[52:55]
  ds_read_b128 v[132:135], v1 offset:23040
  v_mfma_f32_16x16x32_bf16 v[108:111], v[140:143], v[172:175], v[108:111]
  s_waitcnt lgkmcnt(7)
  v_mfma_f32_16x16x32_bf16 v[56:59], v[144:147], v[168:171], v[56:59]
  ds_read_b128 v[136:139], v1 offset:24576
  v_mfma_f32_16x16x32_bf16 v[112:115], v[144:147], v[172:175], v[112:115]
  s_waitcnt lgkmcnt(7)
  v_mfma_f32_16x16x32_bf16 v[60:63], v[148:151], v[168:171], v[60:63]
  ds_read_b128 v[140:143], v1 offset:25088
  v_mfma_f32_16x16x32_bf16 v[116:119], v[148:151], v[172:175], v[116:119]
  s_waitcnt lgkmcnt(7)
  v_mfma_f32_16x16x32_bf16 v[64:67], v[152:155], v[168:171], v[64:67]
  ds_read_b128 v[144:147], v1 offset:26624
  v_mfma_f32_16x16x32_bf16 v[120:123], v[152:155], v[172:175], v[120:123]
  s_waitcnt lgkmcnt(7)
  v_mfma_f32_16x16x32_bf16 v[68:71], v[156:159], v[168:171], v[68:71]
  ds_read_b128 v[148:151], v1 offset:27136
  v_mfma_f32_16x16x32_bf16 v[124:127], v[156:159], v[172:175], v[124:127]
  s_waitcnt lgkmcnt(5)
  v_mfma_f32_16x16x32_bf16 v[16:19], v[128:131], v[160:163], v[16:19]
  ds_read_b128 v[152:155], v1 offset:28672
  v_mfma_f32_16x16x32_bf16 v[72:75], v[128:131], v[164:167], v[72:75]
  s_waitcnt lgkmcnt(5)
  v_mfma_f32_16x16x32_bf16 v[20:23], v[132:135], v[160:163], v[20:23]
  ds_read_b128 v[156:159], v1 offset:29184
  v_mfma_f32_16x16x32_bf16 v[76:79], v[132:135], v[164:167], v[76:79]
  s_waitcnt lgkmcnt(5)
  v_mfma_f32_16x16x32_bf16 v[24:27], v[136:139], v[160:163], v[24:27]
  ds_read_b128 v[128:131], v1 offset:30720
  v_mfma_f32_16x16x32_bf16 v[80:83], v[136:139], v[164:167], v[80:83]
  s_waitcnt lgkmcnt(5)
  v_mfma_f32_16x16x32_bf16 v[28:31], v[140:143], v[160:163], v[28:31]
  ds_read_b128 v[132:135], v1 offset:31232
  v_mfma_f32_16x16x32_bf16 v[84:87], v[140:143], v[164:167], v[84:87]
  s_waitcnt lgkmcnt(5)
  v_mfma_f32_16x16x32_bf16 v[32:35], v[144:147], v[160:163], v[32:35]
  ds_read_b128 v[136:139], v1 offset:32768
  v_mfma_f32_16x16x32_bf16 v[88:91], v[144:147], v[164:167], v[88:91]
  s_waitcnt lgkmcnt(5)
  v_mfma_f32_16x16x32_bf16 v[36:39], v[148:151], v[160:163], v[36:39]
  ds_read_b128 v[140:143], v1 offset:33280
  v_mfma_f32_16x16x32_bf16 v[92:95], v[148:151], v[164:167], v[92:95]
  s_waitcnt lgkmcnt(5)
  v_mfma_f32_16x16x32_bf16 v[40:43], v[152:155], v[160:163], v[40:43]
  ds_read_b128 v[144:147], v1 offset:34816
  v_mfma_f32_16x16x32_bf16 v[96:99], v[152:155], v[164:167], v[96:99]
  s_waitcnt lgkmcnt(5)
  v_mfma_f32_16x16x32_bf16 v[44:47], v[156:159], v[160:163], v[44:47]
  ds_read_b128 v[148:151], v1 offset:35328
  v_mfma_f32_16x16x32_bf16 v[100:103], v[156:159], v[164:167], v[100:103]
  s_barrier
  ds_read_b128 v[168:171], v2 offset:45056
  ds_read_b128 v[172:175], v2 offset:45312
  s_waitcnt lgkmcnt(7)
  v_mfma_f32_16x16x32_bf16 v[48:51], v[128:131], v[160:163], v[48:51]
  ds_read_b128 v[152:155], v1 offset:45056
  v_mfma_f32_16x16x32_bf16 v[104:107], v[128:131], v[164:167], v[104:107]
  s_waitcnt lgkmcnt(7)
  v_mfma_f32_16x16x32_bf16 v[52:55], v[132:135], v[160:163], v[52:55]
  ds_read_b128 v[156:159], v1 offset:45568
  v_mfma_f32_16x16x32_bf16 v[108:111], v[132:135], v[164:167], v[108:111]
  s_waitcnt lgkmcnt(7)
  v_mfma_f32_16x16x32_bf16 v[56:59], v[136:139], v[160:163], v[56:59]
  ds_read_b128 v[128:131], v1 offset:47104
  v_mfma_f32_16x16x32_bf16 v[112:115], v[136:139], v[164:167], v[112:115]
  s_waitcnt lgkmcnt(7)
  v_mfma_f32_16x16x32_bf16 v[60:63], v[140:143], v[160:163], v[60:63]
  ds_read_b128 v[132:135], v1 offset:47616
  v_mfma_f32_16x16x32_bf16 v[116:119], v[140:143], v[164:167], v[116:119]
  s_waitcnt lgkmcnt(7)
  v_mfma_f32_16x16x32_bf16 v[64:67], v[144:147], v[160:163], v[64:67]
  ds_read_b128 v[136:139], v1 offset:49152
  v_mfma_f32_16x16x32_bf16 v[120:123], v[144:147], v[164:167], v[120:123]
  s_waitcnt lgkmcnt(7)
  v_mfma_f32_16x16x32_bf16 v[68:71], v[148:151], v[160:163], v[68:71]
  ds_read_b128 v[140:143], v1 offset:49664
  v_mfma_f32_16x16x32_bf16 v[124:127], v[148:151], v[164:167], v[124:127]
  s_waitcnt lgkmcnt(5)
  v_mfma_f32_16x16x32_bf16 v[16:19], v[152:155], v[168:171], v[16:19]
  ds_read_b128 v[144:147], v1 offset:51200
  v_mfma_f32_16x16x32_bf16 v[72:75], v[152:155], v[172:175], v[72:75]
  s_waitcnt lgkmcnt(5)
  v_mfma_f32_16x16x32_bf16 v[20:23], v[156:159], v[168:171], v[20:23]
  ds_read_b128 v[148:151], v1 offset:51712
  v_mfma_f32_16x16x32_bf16 v[76:79], v[156:159], v[172:175], v[76:79]
  s_waitcnt lgkmcnt(5)
  v_mfma_f32_16x16x32_bf16 v[24:27], v[128:131], v[168:171], v[24:27]
  ds_read_b128 v[152:155], v1 offset:53248
  v_mfma_f32_16x16x32_bf16 v[80:83], v[128:131], v[172:175], v[80:83]
  s_waitcnt lgkmcnt(5)
  v_mfma_f32_16x16x32_bf16 v[28:31], v[132:135], v[168:171], v[28:31]
  ds_read_b128 v[156:159], v1 offset:53760
  v_mfma_f32_16x16x32_bf16 v[84:87], v[132:135], v[172:175], v[84:87]
  s_waitcnt lgkmcnt(5)
  v_mfma_f32_16x16x32_bf16 v[32:35], v[136:139], v[168:171], v[32:35]
  ds_read_b128 v[128:131], v1 offset:55296
  v_mfma_f32_16x16x32_bf16 v[88:91], v[136:139], v[172:175], v[88:91]
  s_waitcnt lgkmcnt(5)
  v_mfma_f32_16x16x32_bf16 v[36:39], v[140:143], v[168:171], v[36:39]
  ds_read_b128 v[132:135], v1 offset:55808
  v_mfma_f32_16x16x32_bf16 v[92:95], v[140:143], v[172:175], v[92:95]
  s_waitcnt lgkmcnt(5)
  v_mfma_f32_16x16x32_bf16 v[40:43], v[144:147], v[168:171], v[40:43]
  ds_read_b128 v[136:139], v1 offset:57344
  v_mfma_f32_16x16x32_bf16 v[96:99], v[144:147], v[172:175], v[96:99]
  s_waitcnt lgkmcnt(5)
  v_mfma_f32_16x16x32_bf16 v[44:47], v[148:151], v[168:171], v[44:47]
  ds_read_b128 v[140:143], v1 offset:57856
  v_mfma_f32_16x16x32_bf16 v[100:103], v[148:151], v[172:175], v[100:103]
  s_barrier
  ds_read_b128 v[160:163], v190 offset:2048
  ds_read_b128 v[164:167], v190 offset:2304
  s_waitcnt lgkmcnt(7)
  v_mfma_f32_16x16x32_bf16 v[48:51], v[152:155], v[168:171], v[48:51]
  ds_read_b128 v[144:147], v188 offset:2048
  v_mfma_f32_16x16x32_bf16 v[104:107], v[152:155], v[172:175], v[104:107]
  s_waitcnt lgkmcnt(7)
  v_mfma_f32_16x16x32_bf16 v[52:55], v[156:159], v[168:171], v[52:55]
  ds_read_b128 v[148:151], v188 offset:2560
  v_mfma_f32_16x16x32_bf16 v[108:111], v[156:159], v[172:175], v[108:111]
  s_waitcnt lgkmcnt(7)
  v_mfma_f32_16x16x32_bf16 v[56:59], v[128:131], v[168:171], v[56:59]
  ds_read_b128 v[152:155], v188 offset:4096
  v_mfma_f32_16x16x32_bf16 v[112:115], v[128:131], v[172:175], v[112:115]
  s_waitcnt lgkmcnt(7)
  v_mfma_f32_16x16x32_bf16 v[60:63], v[132:135], v[168:171], v[60:63]
  ds_read_b128 v[156:159], v188 offset:4608
  v_mfma_f32_16x16x32_bf16 v[116:119], v[132:135], v[172:175], v[116:119]
  s_waitcnt lgkmcnt(7)
  v_mfma_f32_16x16x32_bf16 v[64:67], v[136:139], v[168:171], v[64:67]
  ds_read_b128 v[128:131], v188 offset:6144
  v_mfma_f32_16x16x32_bf16 v[120:123], v[136:139], v[172:175], v[120:123]
  s_waitcnt lgkmcnt(7)
  v_mfma_f32_16x16x32_bf16 v[68:71], v[140:143], v[168:171], v[68:71]
  ds_read_b128 v[132:135], v188 offset:6656
  v_mfma_f32_16x16x32_bf16 v[124:127], v[140:143], v[172:175], v[124:127]
  s_waitcnt lgkmcnt(5)
  v_mfma_f32_16x16x32_bf16 v[16:19], v[144:147], v[160:163], v[16:19]
  ds_read_b128 v[136:139], v188 offset:8192
  v_mfma_f32_16x16x32_bf16 v[72:75], v[144:147], v[164:167], v[72:75]
  s_waitcnt lgkmcnt(5)
  v_mfma_f32_16x16x32_bf16 v[20:23], v[148:151], v[160:163], v[20:23]
  ds_read_b128 v[140:143], v188 offset:8704
  v_mfma_f32_16x16x32_bf16 v[76:79], v[148:151], v[164:167], v[76:79]
  s_waitcnt vmcnt(2)
  v_add_f32 v176, v176, v178
  s_waitcnt lgkmcnt(5)
  v_mfma_f32_16x16x32_bf16 v[24:27], v[152:155], v[160:163], v[24:27]
  ds_read_b128 v[144:147], v188 offset:10240
  v_mfma_f32_16x16x32_bf16 v[80:83], v[152:155], v[164:167], v[80:83]
  s_waitcnt lgkmcnt(5)
  v_mfma_f32_16x16x32_bf16 v[28:31], v[156:159], v[160:163], v[28:31]
  ds_read_b128 v[148:151], v188 offset:10752
  v_mfma_f32_16x16x32_bf16 v[84:87], v[156:159], v[164:167], v[84:87]
  v_add_f32 v177, v177, v179
  s_waitcnt lgkmcnt(5)
  v_mfma_f32_16x16x32_bf16 v[32:35], v[128:131], v[160:163], v[32:35]
  ds_read_b128 v[152:155], v188 offset:12288
  v_mfma_f32_16x16x32_bf16 v[88:91], v[128:131], v[164:167], v[88:91]
  s_waitcnt lgkmcnt(5)
  v_mfma_f32_16x16x32_bf16 v[36:39], v[132:135], v[160:163], v[36:39]
  ds_read_b128 v[156:159], v188 offset:12800
  v_mfma_f32_16x16x32_bf16 v[92:95], v[132:135], v[164:167], v[92:95]
  s_waitcnt vmcnt(0)
  v_add_f32 v180, v180, v182
  s_waitcnt lgkmcnt(5)
  v_mfma_f32_16x16x32_bf16 v[40:43], v[136:139], v[160:163], v[40:43]
  ds_read_b128 v[128:131], v188 offset:14336
  v_mfma_f32_16x16x32_bf16 v[96:99], v[136:139], v[164:167], v[96:99]
  s_waitcnt lgkmcnt(5)
  v_mfma_f32_16x16x32_bf16 v[44:47], v[140:143], v[160:163], v[44:47]
  ds_read_b128 v[132:135], v188 offset:14848
  v_mfma_f32_16x16x32_bf16 v[100:103], v[140:143], v[164:167], v[100:103]
  v_add_f32 v181, v181, v183
  s_barrier
  ds_read_b128 v[168:171], v190 offset:24576
  ds_read_b128 v[172:175], v190 offset:24832
  s_waitcnt lgkmcnt(7)
  v_mfma_f32_16x16x32_bf16 v[48:51], v[144:147], v[160:163], v[48:51]
  ds_read_b128 v[136:139], v188 offset:24576
  v_mfma_f32_16x16x32_bf16 v[104:107], v[144:147], v[164:167], v[104:107]
  s_waitcnt lgkmcnt(7)
  v_mfma_f32_16x16x32_bf16 v[52:55], v[148:151], v[160:163], v[52:55]
  ds_read_b128 v[140:143], v188 offset:25088
  v_mfma_f32_16x16x32_bf16 v[108:111], v[148:151], v[164:167], v[108:111]
  v_mov_b32 v178, v176
  s_waitcnt lgkmcnt(7)
  v_mfma_f32_16x16x32_bf16 v[56:59], v[152:155], v[160:163], v[56:59]
  ds_read_b128 v[144:147], v188 offset:26624
  v_mfma_f32_16x16x32_bf16 v[112:115], v[152:155], v[164:167], v[112:115]
  s_waitcnt lgkmcnt(7)
  v_mfma_f32_16x16x32_bf16 v[60:63], v[156:159], v[160:163], v[60:63]
  ds_read_b128 v[148:151], v188 offset:27136
  v_mfma_f32_16x16x32_bf16 v[116:119], v[156:159], v[164:167], v[116:119]
  v_mov_b32 v179, v177
  s_waitcnt lgkmcnt(7)
  v_mfma_f32_16x16x32_bf16 v[64:67], v[128:131], v[160:163], v[64:67]
  ds_read_b128 v[152:155], v188 offset:28672
  v_mfma_f32_16x16x32_bf16 v[120:123], v[128:131], v[164:167], v[120:123]
  s_waitcnt lgkmcnt(7)
  v_mfma_f32_16x16x32_bf16 v[68:71], v[132:135], v[160:163], v[68:71]
  ds_read_b128 v[156:159], v188 offset:29184
  v_mfma_f32_16x16x32_bf16 v[124:127], v[132:135], v[164:167], v[124:127]
  v_mov_b32 v182, v180
  s_waitcnt lgkmcnt(5)
  v_mfma_f32_16x16x32_bf16 v[16:19], v[136:139], v[168:171], v[16:19]
  ds_read_b128 v[128:131], v188 offset:30720
  v_mfma_f32_16x16x32_bf16 v[72:75], v[136:139], v[172:175], v[72:75]
  s_waitcnt lgkmcnt(5)
  v_mfma_f32_16x16x32_bf16 v[20:23], v[140:143], v[168:171], v[20:23]
  ds_read_b128 v[132:135], v188 offset:31232
  v_mfma_f32_16x16x32_bf16 v[76:79], v[140:143], v[172:175], v[76:79]
  v_mov_b32 v183, v181
  s_waitcnt lgkmcnt(5)
  v_mfma_f32_16x16x32_bf16 v[24:27], v[144:147], v[168:171], v[24:27]
  ds_read_b128 v[136:139], v188 offset:32768
  v_mfma_f32_16x16x32_bf16 v[80:83], v[144:147], v[172:175], v[80:83]
  s_waitcnt lgkmcnt(5)
  v_mfma_f32_16x16x32_bf16 v[28:31], v[148:151], v[168:171], v[28:31]
  ds_read_b128 v[140:143], v188 offset:33280
  v_mfma_f32_16x16x32_bf16 v[84:87], v[148:151], v[172:175], v[84:87]
  v_permlane16_swap_b32 v176, v178
  s_waitcnt lgkmcnt(5)
  v_mfma_f32_16x16x32_bf16 v[32:35], v[152:155], v[168:171], v[32:35]
  ds_read_b128 v[144:147], v188 offset:34816
  v_mfma_f32_16x16x32_bf16 v[88:91], v[152:155], v[172:175], v[88:91]
  s_waitcnt lgkmcnt(5)
  v_mfma_f32_16x16x32_bf16 v[36:39], v[156:159], v[168:171], v[36:39]
  ds_read_b128 v[148:151], v188 offset:35328
  v_mfma_f32_16x16x32_bf16 v[92:95], v[156:159], v[172:175], v[92:95]
  v_permlane16_swap_b32 v177, v179
  s_waitcnt lgkmcnt(5)
  v_mfma_f32_16x16x32_bf16 v[40:43], v[128:131], v[168:171], v[40:43]
  ds_read_b128 v[152:155], v188 offset:36864
  v_mfma_f32_16x16x32_bf16 v[96:99], v[128:131], v[172:175], v[96:99]
  s_waitcnt lgkmcnt(5)
  v_mfma_f32_16x16x32_bf16 v[44:47], v[132:135], v[168:171], v[44:47]
  ds_read_b128 v[156:159], v188 offset:37376
  v_mfma_f32_16x16x32_bf16 v[100:103], v[132:135], v[172:175], v[100:103]
  v_permlane16_swap_b32 v180, v182
  s_barrier
  ds_read_b128 v[160:163], v190 offset:47104
  ds_read_b128 v[164:167], v190 offset:47360
  s_waitcnt lgkmcnt(7)
  v_mfma_f32_16x16x32_bf16 v[48:51], v[136:139], v[168:171], v[48:51]
  ds_read_b128 v[128:131], v188 offset:47104
  v_mfma_f32_16x16x32_bf16 v[104:107], v[136:139], v[172:175], v[104:107]
  s_waitcnt lgkmcnt(7)
  v_mfma_f32_16x16x32_bf16 v[52:55], v[140:143], v[168:171], v[52:55]
  ds_read_b128 v[132:135], v188 offset:47616
  v_mfma_f32_16x16x32_bf16 v[108:111], v[140:143], v[172:175], v[108:111]
  v_permlane16_swap_b32 v181, v183
  s_waitcnt lgkmcnt(7)
  v_mfma_f32_16x16x32_bf16 v[56:59], v[144:147], v[168:171], v[56:59]
  ds_read_b128 v[136:139], v188 offset:49152
  v_mfma_f32_16x16x32_bf16 v[112:115], v[144:147], v[172:175], v[112:115]
  s_waitcnt lgkmcnt(7)
  v_mfma_f32_16x16x32_bf16 v[60:63], v[148:151], v[168:171], v[60:63]
  ds_read_b128 v[140:143], v188 offset:49664
  v_mfma_f32_16x16x32_bf16 v[116:119], v[148:151], v[172:175], v[116:119]
  v_add_f32 v176, v176, v178
  s_waitcnt lgkmcnt(7)
  v_mfma_f32_16x16x32_bf16 v[64:67], v[152:155], v[168:171], v[64:67]
  ds_read_b128 v[144:147], v188 offset:51200
  v_mfma_f32_16x16x32_bf16 v[120:123], v[152:155], v[172:175], v[120:123]
  s_waitcnt lgkmcnt(7)
  v_mfma_f32_16x16x32_bf16 v[68:71], v[156:159], v[168:171], v[68:71]
  ds_read_b128 v[148:151], v188 offset:51712
  v_mfma_f32_16x16x32_bf16 v[124:127], v[156:159], v[172:175], v[124:127]
  v_add_f32 v177, v177, v179
  s_waitcnt lgkmcnt(5)
  v_mfma_f32_16x16x32_bf16 v[16:19], v[128:131], v[160:163], v[16:19]
  ds_read_b128 v[152:155], v188 offset:53248
  v_mfma_f32_16x16x32_bf16 v[72:75], v[128:131], v[164:167], v[72:75]
  s_waitcnt lgkmcnt(5)
  v_mfma_f32_16x16x32_bf16 v[20:23], v[132:135], v[160:163], v[20:23]
  ds_read_b128 v[156:159], v188 offset:53760
  v_mfma_f32_16x16x32_bf16 v[76:79], v[132:135], v[164:167], v[76:79]
  v_add_f32 v180, v180, v182
  s_waitcnt lgkmcnt(5)
  v_mfma_f32_16x16x32_bf16 v[24:27], v[136:139], v[160:163], v[24:27]
  ds_read_b128 v[128:131], v188 offset:55296
  v_mfma_f32_16x16x32_bf16 v[80:83], v[136:139], v[164:167], v[80:83]
  s_waitcnt lgkmcnt(5)
  v_mfma_f32_16x16x32_bf16 v[28:31], v[140:143], v[160:163], v[28:31]
  ds_read_b128 v[132:135], v188 offset:55808
  v_mfma_f32_16x16x32_bf16 v[84:87], v[140:143], v[164:167], v[84:87]
  v_add_f32 v181, v181, v183
  s_waitcnt lgkmcnt(5)
  v_mfma_f32_16x16x32_bf16 v[32:35], v[144:147], v[160:163], v[32:35]
  ds_read_b128 v[136:139], v188 offset:57344
  v_mfma_f32_16x16x32_bf16 v[88:91], v[144:147], v[164:167], v[88:91]
  s_waitcnt lgkmcnt(5)
  v_mfma_f32_16x16x32_bf16 v[36:39], v[148:151], v[160:163], v[36:39]
  ds_read_b128 v[140:143], v188 offset:57856
  v_mfma_f32_16x16x32_bf16 v[92:95], v[148:151], v[164:167], v[92:95]
  v_mov_b32 v178, v176
  s_waitcnt lgkmcnt(5)
  v_mfma_f32_16x16x32_bf16 v[40:43], v[152:155], v[160:163], v[40:43]
  ds_read_b128 v[144:147], v188 offset:59392
  v_mfma_f32_16x16x32_bf16 v[96:99], v[152:155], v[164:167], v[96:99]
  s_waitcnt lgkmcnt(5)
  v_mfma_f32_16x16x32_bf16 v[44:47], v[156:159], v[160:163], v[44:47]
  ds_read_b128 v[148:151], v188 offset:59904
  v_mfma_f32_16x16x32_bf16 v[100:103], v[156:159], v[164:167], v[100:103]
  v_mov_b32 v179, v177
  s_barrier
  ds_read_b128 v[168:171], v191 offset:4096
  ds_read_b128 v[172:175], v191 offset:4352
  s_waitcnt lgkmcnt(7)
  v_mfma_f32_16x16x32_bf16 v[48:51], v[128:131], v[160:163], v[48:51]
  ds_read_b128 v[152:155], v189 offset:4096
  v_mfma_f32_16x16x32_bf16 v[104:107], v[128:131], v[164:167], v[104:107]
  s_waitcnt lgkmcnt(7)
  v_mfma_f32_16x16x32_bf16 v[52:55], v[132:135], v[160:163], v[52:55]
  ds_read_b128 v[156:159], v189 offset:4608
  v_mfma_f32_16x16x32_bf16 v[108:111], v[132:135], v[164:167], v[108:111]
  v_mov_b32 v182, v180
  s_waitcnt lgkmcnt(7)
  v_mfma_f32_16x16x32_bf16 v[56:59], v[136:139], v[160:163], v[56:59]
  ds_read_b128 v[128:131], v189 offset:6144
  v_mfma_f32_16x16x32_bf16 v[112:115], v[136:139], v[164:167], v[112:115]
  s_waitcnt lgkmcnt(7)
  v_mfma_f32_16x16x32_bf16 v[60:63], v[140:143], v[160:163], v[60:63]
  ds_read_b128 v[132:135], v189 offset:6656
  v_mfma_f32_16x16x32_bf16 v[116:119], v[140:143], v[164:167], v[116:119]
  v_mov_b32 v183, v181
  s_waitcnt lgkmcnt(7)
  v_mfma_f32_16x16x32_bf16 v[64:67], v[144:147], v[160:163], v[64:67]
  ds_read_b128 v[136:139], v189 offset:8192
  v_mfma_f32_16x16x32_bf16 v[120:123], v[144:147], v[164:167], v[120:123]
  s_waitcnt lgkmcnt(7)
  v_mfma_f32_16x16x32_bf16 v[68:71], v[148:151], v[160:163], v[68:71]
  ds_read_b128 v[140:143], v189 offset:8704
  v_mfma_f32_16x16x32_bf16 v[124:127], v[148:151], v[164:167], v[124:127]
  v_permlane32_swap_b32 v176, v178
  s_waitcnt lgkmcnt(5)
  v_mfma_f32_16x16x32_bf16 v[16:19], v[152:155], v[168:171], v[16:19]
  ds_read_b128 v[144:147], v189 offset:10240
  v_mfma_f32_16x16x32_bf16 v[72:75], v[152:155], v[172:175], v[72:75]
  s_waitcnt lgkmcnt(5)
  v_mfma_f32_16x16x32_bf16 v[20:23], v[156:159], v[168:171], v[20:23]
  ds_read_b128 v[148:151], v189 offset:10752
  v_mfma_f32_16x16x32_bf16 v[76:79], v[156:159], v[172:175], v[76:79]
  v_permlane32_swap_b32 v177, v179
  s_waitcnt lgkmcnt(5)
  v_mfma_f32_16x16x32_bf16 v[24:27], v[128:131], v[168:171], v[24:27]
  ds_read_b128 v[152:155], v189 offset:12288
  v_mfma_f32_16x16x32_bf16 v[80:83], v[128:131], v[172:175], v[80:83]
  s_waitcnt lgkmcnt(5)
  v_mfma_f32_16x16x32_bf16 v[28:31], v[132:135], v[168:171], v[28:31]
  ds_read_b128 v[156:159], v189 offset:12800
  v_mfma_f32_16x16x32_bf16 v[84:87], v[132:135], v[172:175], v[84:87]
  v_permlane32_swap_b32 v180, v182
  s_waitcnt lgkmcnt(5)
  v_mfma_f32_16x16x32_bf16 v[32:35], v[136:139], v[168:171], v[32:35]
  ds_read_b128 v[128:131], v189 offset:14336
  v_mfma_f32_16x16x32_bf16 v[88:91], v[136:139], v[172:175], v[88:91]
  s_waitcnt lgkmcnt(5)
  v_mfma_f32_16x16x32_bf16 v[36:39], v[140:143], v[168:171], v[36:39]
  ds_read_b128 v[132:135], v189 offset:14848
  v_mfma_f32_16x16x32_bf16 v[92:95], v[140:143], v[172:175], v[92:95]
  v_permlane32_swap_b32 v181, v183
  s_waitcnt lgkmcnt(5)
  v_mfma_f32_16x16x32_bf16 v[40:43], v[144:147], v[168:171], v[40:43]
  ds_read_b128 v[136:139], v189 offset:16384
  v_mfma_f32_16x16x32_bf16 v[96:99], v[144:147], v[172:175], v[96:99]
  s_waitcnt lgkmcnt(5)
  v_mfma_f32_16x16x32_bf16 v[44:47], v[148:151], v[168:171], v[44:47]
  ds_read_b128 v[140:143], v189 offset:16896
  v_mfma_f32_16x16x32_bf16 v[100:103], v[148:151], v[172:175], v[100:103]
  v_add_f32 v176, v176, v178
  s_barrier
  ds_read_b128 v[160:163], v2
  ds_read_b128 v[164:167], v2 offset:256
  s_waitcnt lgkmcnt(7)
  v_mfma_f32_16x16x32_bf16 v[48:51], v[152:155], v[168:171], v[48:51]
  ds_read_b128 v[144:147], v1
  v_mfma_f32_16x16x32_bf16 v[104:107], v[152:155], v[172:175], v[104:107]
  s_waitcnt lgkmcnt(7)
  v_mfma_f32_16x16x32_bf16 v[52:55], v[156:159], v[168:171], v[52:55]
  ds_read_b128 v[148:151], v1 offset:512
  v_mfma_f32_16x16x32_bf16 v[108:111], v[156:159], v[172:175], v[108:111]
  v_add_f32 v177, v177, v179
  s_waitcnt lgkmcnt(7)
  v_mfma_f32_16x16x32_bf16 v[56:59], v[128:131], v[168:171], v[56:59]
  ds_read_b128 v[152:155], v1 offset:2048
  v_mfma_f32_16x16x32_bf16 v[112:115], v[128:131], v[172:175], v[112:115]
  s_waitcnt lgkmcnt(7)
  v_mfma_f32_16x16x32_bf16 v[60:63], v[132:135], v[168:171], v[60:63]
  ds_read_b128 v[156:159], v1 offset:2560
  v_mfma_f32_16x16x32_bf16 v[116:119], v[132:135], v[172:175], v[116:119]
  v_add_f32 v180, v180, v182
  s_waitcnt lgkmcnt(7)
  v_mfma_f32_16x16x32_bf16 v[64:67], v[136:139], v[168:171], v[64:67]
  ds_read_b128 v[128:131], v1 offset:4096
  v_mfma_f32_16x16x32_bf16 v[120:123], v[136:139], v[172:175], v[120:123]
  s_waitcnt lgkmcnt(7)
  v_mfma_f32_16x16x32_bf16 v[68:71], v[140:143], v[168:171], v[68:71]
  ds_read_b128 v[132:135], v1 offset:4608
  v_mfma_f32_16x16x32_bf16 v[124:127], v[140:143], v[172:175], v[124:127]
  v_add_f32 v181, v181, v183
  s_waitcnt lgkmcnt(5)
  v_mfma_f32_16x16x32_bf16 v[16:19], v[144:147], v[160:163], v[16:19]
  ds_read_b128 v[136:139], v1 offset:6144
  v_mfma_f32_16x16x32_bf16 v[72:75], v[144:147], v[164:167], v[72:75]
  s_waitcnt lgkmcnt(5)
  v_mfma_f32_16x16x32_bf16 v[20:23], v[148:151], v[160:163], v[20:23]
  ds_read_b128 v[140:143], v1 offset:6656
  v_mfma_f32_16x16x32_bf16 v[76:79], v[148:151], v[164:167], v[76:79]
  v_mul_f32 v184, s36, v176
  s_waitcnt lgkmcnt(5)
  v_mfma_f32_16x16x32_bf16 v[24:27], v[152:155], v[160:163], v[24:27]
  ds_read_b128 v[144:147], v1 offset:8192
  v_mfma_f32_16x16x32_bf16 v[80:83], v[152:155], v[164:167], v[80:83]
  s_waitcnt lgkmcnt(5)
  v_mfma_f32_16x16x32_bf16 v[28:31], v[156:159], v[160:163], v[28:31]
  ds_read_b128 v[148:151], v1 offset:8704
  v_mfma_f32_16x16x32_bf16 v[84:87], v[156:159], v[164:167], v[84:87]
  v_mul_f32 v185, s36, v177
  s_waitcnt lgkmcnt(5)
  v_mfma_f32_16x16x32_bf16 v[32:35], v[128:131], v[160:163], v[32:35]
  ds_read_b128 v[152:155], v1 offset:10240
  v_mfma_f32_16x16x32_bf16 v[88:91], v[128:131], v[164:167], v[88:91]
  s_waitcnt lgkmcnt(5)
  v_mfma_f32_16x16x32_bf16 v[36:39], v[132:135], v[160:163], v[36:39]
  ds_read_b128 v[156:159], v1 offset:10752
  v_mfma_f32_16x16x32_bf16 v[92:95], v[132:135], v[164:167], v[92:95]
  v_mul_f32 v186, s36, v180
  s_waitcnt lgkmcnt(5)
  v_mfma_f32_16x16x32_bf16 v[40:43], v[136:139], v[160:163], v[40:43]
  ds_read_b128 v[128:131], v1 offset:12288
  v_mfma_f32_16x16x32_bf16 v[96:99], v[136:139], v[164:167], v[96:99]
  s_waitcnt lgkmcnt(5)
  v_mfma_f32_16x16x32_bf16 v[44:47], v[140:143], v[160:163], v[44:47]
  ds_read_b128 v[132:135], v1 offset:12800
  v_mfma_f32_16x16x32_bf16 v[100:103], v[140:143], v[164:167], v[100:103]
  v_mul_f32 v187, s36, v181
  s_barrier
  ds_read_b128 v[168:171], v2 offset:22528
  ds_read_b128 v[172:175], v2 offset:22784
  s_waitcnt lgkmcnt(7)
  v_mfma_f32_16x16x32_bf16 v[48:51], v[144:147], v[160:163], v[48:51]
  ds_read_b128 v[136:139], v1 offset:22528
  v_mfma_f32_16x16x32_bf16 v[104:107], v[144:147], v[164:167], v[104:107]
  s_waitcnt lgkmcnt(7)
  v_mfma_f32_16x16x32_bf16 v[52:55], v[148:151], v[160:163], v[52:55]
  ds_read_b128 v[140:143], v1 offset:23040
  v_mfma_f32_16x16x32_bf16 v[108:111], v[148:151], v[164:167], v[108:111]
  v_fma_f32 v185, -v184, v184, v185
  s_waitcnt lgkmcnt(7)
  v_mfma_f32_16x16x32_bf16 v[56:59], v[152:155], v[160:163], v[56:59]
  ds_read_b128 v[144:147], v1 offset:24576
  v_mfma_f32_16x16x32_bf16 v[112:115], v[152:155], v[164:167], v[112:115]
  s_waitcnt lgkmcnt(7)
  v_mfma_f32_16x16x32_bf16 v[60:63], v[156:159], v[160:163], v[60:63]
  ds_read_b128 v[148:151], v1 offset:25088
  v_mfma_f32_16x16x32_bf16 v[116:119], v[156:159], v[164:167], v[116:119]
  v_fma_f32 v187, -v186, v186, v187
  s_waitcnt lgkmcnt(7)
  v_mfma_f32_16x16x32_bf16 v[64:67], v[128:131], v[160:163], v[64:67]
  ds_read_b128 v[152:155], v1 offset:26624
  v_mfma_f32_16x16x32_bf16 v[120:123], v[128:131], v[164:167], v[120:123]
  s_waitcnt lgkmcnt(7)
  v_mfma_f32_16x16x32_bf16 v[68:71], v[132:135], v[160:163], v[68:71]
  ds_read_b128 v[156:159], v1 offset:27136
  v_mfma_f32_16x16x32_bf16 v[124:127], v[132:135], v[164:167], v[124:127]
  v_max_f32 v185, 0, v185
  s_waitcnt lgkmcnt(5)
  v_mfma_f32_16x16x32_bf16 v[16:19], v[136:139], v[168:171], v[16:19]
  ds_read_b128 v[128:131], v1 offset:28672
  v_mfma_f32_16x16x32_bf16 v[72:75], v[136:139], v[172:175], v[72:75]
  s_waitcnt lgkmcnt(5)
  v_mfma_f32_16x16x32_bf16 v[20:23], v[140:143], v[168:171], v[20:23]
  ds_read_b128 v[132:135], v1 offset:29184
  v_mfma_f32_16x16x32_bf16 v[76:79], v[140:143], v[172:175], v[76:79]
  v_max_f32 v187, 0, v187
  s_waitcnt lgkmcnt(5)
  v_mfma_f32_16x16x32_bf16 v[24:27], v[144:147], v[168:171], v[24:27]
  ds_read_b128 v[136:139], v1 offset:30720
  v_mfma_f32_16x16x32_bf16 v[80:83], v[144:147], v[172:175], v[80:83]
  s_waitcnt lgkmcnt(5)
  v_mfma_f32_16x16x32_bf16 v[28:31], v[148:151], v[168:171], v[28:31]
  ds_read_b128 v[140:143], v1 offset:31232
  v_mfma_f32_16x16x32_bf16 v[84:87], v[148:151], v[172:175], v[84:87]
  v_cvt_pk_bf16_f32 v185, v185, v185
  s_waitcnt lgkmcnt(5)
  v_mfma_f32_16x16x32_bf16 v[32:35], v[152:155], v[168:171], v[32:35]
  ds_read_b128 v[144:147], v1 offset:32768
  v_mfma_f32_16x16x32_bf16 v[88:91], v[152:155], v[172:175], v[88:91]
  s_waitcnt lgkmcnt(5)
  v_mfma_f32_16x16x32_bf16 v[36:39], v[156:159], v[168:171], v[36:39]
  ds_read_b128 v[148:151], v1 offset:33280
  v_mfma_f32_16x16x32_bf16 v[92:95], v[156:159], v[172:175], v[92:95]
  v_cvt_pk_bf16_f32 v187, v187, v187
  s_waitcnt lgkmcnt(5)
  v_mfma_f32_16x16x32_bf16 v[40:43], v[128:131], v[168:171], v[40:43]
  ds_read_b128 v[152:155], v1 offset:34816
  v_mfma_f32_16x16x32_bf16 v[96:99], v[128:131], v[172:175], v[96:99]
  s_waitcnt lgkmcnt(5)
  v_mfma_f32_16x16x32_bf16 v[44:47], v[132:135], v[168:171], v[44:47]
  ds_read_b128 v[156:159], v1 offset:35328
  v_mfma_f32_16x16x32_bf16 v[100:103], v[132:135], v[172:175], v[100:103]
  v_lshlrev_b32 v185, 16, v185
  s_barrier
  ds_read_b128 v[160:163], v2 offset:45056
  ds_read_b128 v[164:167], v2 offset:45312
  s_waitcnt lgkmcnt(7)
  v_mfma_f32_16x16x32_bf16 v[48:51], v[136:139], v[168:171], v[48:51]
  ds_read_b128 v[128:131], v1 offset:45056
  v_mfma_f32_16x16x32_bf16 v[104:107], v[136:139], v[172:175], v[104:107]
  s_waitcnt lgkmcnt(7)
  v_mfma_f32_16x16x32_bf16 v[52:55], v[140:143], v[168:171], v[52:55]
  ds_read_b128 v[132:135], v1 offset:45568
  v_mfma_f32_16x16x32_bf16 v[108:111], v[140:143], v[172:175], v[108:111]
  v_lshlrev_b32 v187, 16, v187
  s_waitcnt lgkmcnt(7)
  v_mfma_f32_16x16x32_bf16 v[56:59], v[144:147], v[168:171], v[56:59]
  ds_read_b128 v[136:139], v1 offset:47104
  v_mfma_f32_16x16x32_bf16 v[112:115], v[144:147], v[172:175], v[112:115]
  s_waitcnt lgkmcnt(7)
  v_mfma_f32_16x16x32_bf16 v[60:63], v[148:151], v[168:171], v[60:63]
  ds_read_b128 v[140:143], v1 offset:47616
  v_mfma_f32_16x16x32_bf16 v[116:119], v[148:151], v[172:175], v[116:119]
  v_add_f32 v185, s37, v185
  s_waitcnt lgkmcnt(7)
  v_mfma_f32_16x16x32_bf16 v[64:67], v[152:155], v[168:171], v[64:67]
  ds_read_b128 v[144:147], v1 offset:49152
  v_mfma_f32_16x16x32_bf16 v[120:123], v[152:155], v[172:175], v[120:123]
  s_waitcnt lgkmcnt(7)
  v_mfma_f32_16x16x32_bf16 v[68:71], v[156:159], v[168:171], v[68:71]
  ds_read_b128 v[148:151], v1 offset:49664
  v_mfma_f32_16x16x32_bf16 v[124:127], v[156:159], v[172:175], v[124:127]
  v_add_f32 v187, s37, v187
  s_waitcnt lgkmcnt(5)
  v_mfma_f32_16x16x32_bf16 v[16:19], v[128:131], v[160:163], v[16:19]
  ds_read_b128 v[152:155], v1 offset:51200
  v_mfma_f32_16x16x32_bf16 v[72:75], v[128:131], v[164:167], v[72:75]
  s_waitcnt lgkmcnt(5)
  v_mfma_f32_16x16x32_bf16 v[20:23], v[132:135], v[160:163], v[20:23]
  ds_read_b128 v[156:159], v1 offset:51712
  v_mfma_f32_16x16x32_bf16 v[76:79], v[132:135], v[164:167], v[76:79]
  v_cvt_pk_bf16_f32 v185, v185, v185
  s_waitcnt lgkmcnt(5)
  v_mfma_f32_16x16x32_bf16 v[24:27], v[136:139], v[160:163], v[24:27]
  ds_read_b128 v[128:131], v1 offset:53248
  v_mfma_f32_16x16x32_bf16 v[80:83], v[136:139], v[164:167], v[80:83]
  s_waitcnt lgkmcnt(5)
  v_mfma_f32_16x16x32_bf16 v[28:31], v[140:143], v[160:163], v[28:31]
  ds_read_b128 v[132:135], v1 offset:53760
  v_mfma_f32_16x16x32_bf16 v[84:87], v[140:143], v[164:167], v[84:87]
  v_cvt_pk_bf16_f32 v187, v187, v187
  s_waitcnt lgkmcnt(5)
  v_mfma_f32_16x16x32_bf16 v[32:35], v[144:147], v[160:163], v[32:35]
  ds_read_b128 v[136:139], v1 offset:55296
  v_mfma_f32_16x16x32_bf16 v[88:91], v[144:147], v[164:167], v[88:91]
  s_waitcnt lgkmcnt(5)
  v_mfma_f32_16x16x32_bf16 v[36:39], v[148:151], v[160:163], v[36:39]
  ds_read_b128 v[140:143], v1 offset:55808
  v_mfma_f32_16x16x32_bf16 v[92:95], v[148:151], v[164:167], v[92:95]
  v_lshlrev_b32 v185, 16, v185
  s_waitcnt lgkmcnt(5)
  v_mfma_f32_16x16x32_bf16 v[40:43], v[152:155], v[160:163], v[40:43]
  ds_read_b128 v[144:147], v1 offset:57344
  v_mfma_f32_16x16x32_bf16 v[96:99], v[152:155], v[164:167], v[96:99]
  s_waitcnt lgkmcnt(5)
  v_mfma_f32_16x16x32_bf16 v[44:47], v[156:159], v[160:163], v[44:47]
  ds_read_b128 v[148:151], v1 offset:57856
  v_mfma_f32_16x16x32_bf16 v[100:103], v[156:159], v[164:167], v[100:103]
  v_lshlrev_b32 v187, 16, v187
  s_barrier
  ds_read_b128 v[168:171], v190 offset:2048
  ds_read_b128 v[172:175], v190 offset:2304
  s_waitcnt lgkmcnt(7)
  v_mfma_f32_16x16x32_bf16 v[48:51], v[128:131], v[160:163], v[48:51]
  ds_read_b128 v[152:155], v188 offset:2048
  v_mfma_f32_16x16x32_bf16 v[104:107], v[128:131], v[164:167], v[104:107]
  s_waitcnt lgkmcnt(7)
  v_mfma_f32_16x16x32_bf16 v[52:55], v[132:135], v[160:163], v[52:55]
  ds_read_b128 v[156:159], v188 offset:2560
  v_mfma_f32_16x16x32_bf16 v[108:111], v[132:135], v[164:167], v[108:111]
  v_sqrt_f32 v185, v185
  s_waitcnt lgkmcnt(7)
  v_mfma_f32_16x16x32_bf16 v[56:59], v[136:139], v[160:163], v[56:59]
  ds_read_b128 v[128:131], v188 offset:4096
  v_mfma_f32_16x16x32_bf16 v[112:115], v[136:139], v[164:167], v[112:115]
  s_waitcnt lgkmcnt(7)
  v_mfma_f32_16x16x32_bf16 v[60:63], v[140:143], v[160:163], v[60:63]
  ds_read_b128 v[132:135], v188 offset:4608
  v_mfma_f32_16x16x32_bf16 v[116:119], v[140:143], v[164:167], v[116:119]
  v_sqrt_f32 v187, v187
  s_waitcnt lgkmcnt(7)
  v_mfma_f32_16x16x32_bf16 v[64:67], v[144:147], v[160:163], v[64:67]
  ds_read_b128 v[136:139], v188 offset:6144
  v_mfma_f32_16x16x32_bf16 v[120:123], v[144:147], v[164:167], v[120:123]
  s_waitcnt lgkmcnt(7)
  v_mfma_f32_16x16x32_bf16 v[68:71], v[148:151], v[160:163], v[68:71]
  ds_read_b128 v[140:143], v188 offset:6656
  v_mfma_f32_16x16x32_bf16 v[124:127], v[148:151], v[164:167], v[124:127]
  v_cvt_pk_bf16_f32 v184, v184, v184
  s_waitcnt lgkmcnt(5)
  v_mfma_f32_16x16x32_bf16 v[16:19], v[152:155], v[168:171], v[16:19]
  ds_read_b128 v[144:147], v188 offset:8192
  v_mfma_f32_16x16x32_bf16 v[72:75], v[152:155], v[172:175], v[72:75]
  s_waitcnt lgkmcnt(5)
  v_mfma_f32_16x16x32_bf16 v[20:23], v[156:159], v[168:171], v[20:23]
  ds_read_b128 v[148:151], v188 offset:8704
  v_mfma_f32_16x16x32_bf16 v[76:79], v[156:159], v[172:175], v[76:79]
  v_cvt_pk_bf16_f32 v186, v186, v186
  s_waitcnt lgkmcnt(5)
  v_mfma_f32_16x16x32_bf16 v[24:27], v[128:131], v[168:171], v[24:27]
  ds_read_b128 v[152:155], v188 offset:10240
  v_mfma_f32_16x16x32_bf16 v[80:83], v[128:131], v[172:175], v[80:83]
  s_waitcnt lgkmcnt(5)
  v_mfma_f32_16x16x32_bf16 v[28:31], v[132:135], v[168:171], v[28:31]
  ds_read_b128 v[156:159], v188 offset:10752
  v_mfma_f32_16x16x32_bf16 v[84:87], v[132:135], v[172:175], v[84:87]
  v_lshlrev_b32 v184, 16, v184
  s_waitcnt lgkmcnt(5)
  v_mfma_f32_16x16x32_bf16 v[32:35], v[136:139], v[168:171], v[32:35]
  ds_read_b128 v[128:131], v188 offset:12288
  v_mfma_f32_16x16x32_bf16 v[88:91], v[136:139], v[172:175], v[88:91]
  s_waitcnt lgkmcnt(5)
  v_mfma_f32_16x16x32_bf16 v[36:39], v[140:143], v[168:171], v[36:39]
  ds_read_b128 v[132:135], v188 offset:12800
  v_mfma_f32_16x16x32_bf16 v[92:95], v[140:143], v[172:175], v[92:95]
  v_lshlrev_b32 v186, 16, v186
  s_waitcnt lgkmcnt(5)
  v_mfma_f32_16x16x32_bf16 v[40:43], v[144:147], v[168:171], v[40:43]
  ds_read_b128 v[136:139], v188 offset:14336
  v_mfma_f32_16x16x32_bf16 v[96:99], v[144:147], v[172:175], v[96:99]
  s_waitcnt lgkmcnt(5)
  v_mfma_f32_16x16x32_bf16 v[44:47], v[148:151], v[168:171], v[44:47]
  ds_read_b128 v[140:143], v188 offset:14848
  v_mfma_f32_16x16x32_bf16 v[100:103], v[148:151], v[172:175], v[100:103]
  v_cvt_pk_bf16_f32 v185, v185, v185
  s_barrier
  ds_read_b128 v[160:163], v190 offset:24576
  ds_read_b128 v[164:167], v190 offset:24832
  s_waitcnt lgkmcnt(7)
  v_mfma_f32_16x16x32_bf16 v[48:51], v[152:155], v[168:171], v[48:51]
  ds_read_b128 v[144:147], v188 offset:24576
  v_mfma_f32_16x16x32_bf16 v[104:107], v[152:155], v[172:175], v[104:107]
  s_waitcnt lgkmcnt(7)
  v_mfma_f32_16x16x32_bf16 v[52:55], v[156:159], v[168:171], v[52:55]
  ds_read_b128 v[148:151], v188 offset:25088
  v_mfma_f32_16x16x32_bf16 v[108:111], v[156:159], v[172:175], v[108:111]
  v_cvt_pk_bf16_f32 v187, v187, v187
  s_waitcnt lgkmcnt(7)
  v_mfma_f32_16x16x32_bf16 v[56:59], v[128:131], v[168:171], v[56:59]
  ds_read_b128 v[152:155], v188 offset:26624
  v_mfma_f32_16x16x32_bf16 v[112:115], v[128:131], v[172:175], v[112:115]
  s_waitcnt lgkmcnt(7)
  v_mfma_f32_16x16x32_bf16 v[60:63], v[132:135], v[168:171], v[60:63]
  ds_read_b128 v[156:159], v188 offset:27136
  v_mfma_f32_16x16x32_bf16 v[116:119], v[132:135], v[172:175], v[116:119]
  v_lshlrev_b32 v185, 16, v185
  s_waitcnt lgkmcnt(7)
  v_mfma_f32_16x16x32_bf16 v[64:67], v[136:139], v[168:171], v[64:67]
  ds_read_b128 v[128:131], v188 offset:28672
  v_mfma_f32_16x16x32_bf16 v[120:123], v[136:139], v[172:175], v[120:123]
  s_waitcnt lgkmcnt(7)
  v_mfma_f32_16x16x32_bf16 v[68:71], v[140:143], v[168:171], v[68:71]
  ds_read_b128 v[132:135], v188 offset:29184
  v_mfma_f32_16x16x32_bf16 v[124:127], v[140:143], v[172:175], v[124:127]
  v_lshlrev_b32 v187, 16, v187
  s_waitcnt lgkmcnt(5)
  v_mfma_f32_16x16x32_bf16 v[16:19], v[144:147], v[160:163], v[16:19]
  ds_read_b128 v[136:139], v188 offset:30720
  v_mfma_f32_16x16x32_bf16 v[72:75], v[144:147], v[164:167], v[72:75]
  s_waitcnt lgkmcnt(5)
  v_mfma_f32_16x16x32_bf16 v[20:23], v[148:151], v[160:163], v[20:23]
  ds_read_b128 v[140:143], v188 offset:31232
  v_mfma_f32_16x16x32_bf16 v[76:79], v[148:151], v[164:167], v[76:79]
  v_rcp_f32 v185, v185
  s_waitcnt lgkmcnt(5)
  v_mfma_f32_16x16x32_bf16 v[24:27], v[152:155], v[160:163], v[24:27]
  ds_read_b128 v[144:147], v188 offset:32768
  v_mfma_f32_16x16x32_bf16 v[80:83], v[152:155], v[164:167], v[80:83]
  s_waitcnt lgkmcnt(5)
  v_mfma_f32_16x16x32_bf16 v[28:31], v[156:159], v[160:163], v[28:31]
  ds_read_b128 v[148:151], v188 offset:33280
  v_mfma_f32_16x16x32_bf16 v[84:87], v[156:159], v[164:167], v[84:87]
  v_rcp_f32 v187, v187
  s_waitcnt lgkmcnt(5)
  v_mfma_f32_16x16x32_bf16 v[32:35], v[128:131], v[160:163], v[32:35]
  ds_read_b128 v[152:155], v188 offset:34816
  v_mfma_f32_16x16x32_bf16 v[88:91], v[128:131], v[164:167], v[88:91]
  s_waitcnt lgkmcnt(5)
  v_mfma_f32_16x16x32_bf16 v[36:39], v[132:135], v[160:163], v[36:39]
  ds_read_b128 v[156:159], v188 offset:35328
  v_mfma_f32_16x16x32_bf16 v[92:95], v[132:135], v[164:167], v[92:95]
  v_mul_f32 v185, v185, v185
  s_waitcnt lgkmcnt(5)
  v_mfma_f32_16x16x32_bf16 v[40:43], v[136:139], v[160:163], v[40:43]
  ds_read_b128 v[128:131], v188 offset:36864
  v_mfma_f32_16x16x32_bf16 v[96:99], v[136:139], v[164:167], v[96:99]
  s_waitcnt lgkmcnt(5)
  v_mfma_f32_16x16x32_bf16 v[44:47], v[140:143], v[160:163], v[44:47]
  ds_read_b128 v[132:135], v188 offset:37376
  v_mfma_f32_16x16x32_bf16 v[100:103], v[140:143], v[164:167], v[100:103]
  v_mul_f32 v187, v187, v187
  s_barrier
  ds_read_b128 v[168:171], v190 offset:47104
  ds_read_b128 v[172:175], v190 offset:47360
  s_waitcnt lgkmcnt(7)
  v_mfma_f32_16x16x32_bf16 v[48:51], v[144:147], v[160:163], v[48:51]
  ds_read_b128 v[136:139], v188 offset:47104
  v_mfma_f32_16x16x32_bf16 v[104:107], v[144:147], v[164:167], v[104:107]
  s_waitcnt lgkmcnt(7)
  v_mfma_f32_16x16x32_bf16 v[52:55], v[148:151], v[160:163], v[52:55]
  ds_read_b128 v[140:143], v188 offset:47616
  v_mfma_f32_16x16x32_bf16 v[108:111], v[148:151], v[164:167], v[108:111]
  s_waitcnt lgkmcnt(7)
  v_mfma_f32_16x16x32_bf16 v[56:59], v[152:155], v[160:163], v[56:59]
  ds_read_b128 v[144:147], v188 offset:49152
  v_mfma_f32_16x16x32_bf16 v[112:115], v[152:155], v[164:167], v[112:115]
  s_waitcnt lgkmcnt(7)
  v_mfma_f32_16x16x32_bf16 v[60:63], v[156:159], v[160:163], v[60:63]
  ds_read_b128 v[148:151], v188 offset:49664
  v_mfma_f32_16x16x32_bf16 v[116:119], v[156:159], v[164:167], v[116:119]
  s_waitcnt lgkmcnt(7)
  v_mfma_f32_16x16x32_bf16 v[64:67], v[128:131], v[160:163], v[64:67]
  ds_read_b128 v[152:155], v188 offset:51200
  v_mfma_f32_16x16x32_bf16 v[120:123], v[128:131], v[164:167], v[120:123]
  s_waitcnt lgkmcnt(7)
  v_mfma_f32_16x16x32_bf16 v[68:71], v[132:135], v[160:163], v[68:71]
  ds_read_b128 v[156:159], v188 offset:51712
  v_mfma_f32_16x16x32_bf16 v[124:127], v[132:135], v[164:167], v[124:127]
  s_waitcnt lgkmcnt(5)
  v_mfma_f32_16x16x32_bf16 v[16:19], v[136:139], v[168:171], v[16:19]
  ds_read_b128 v[128:131], v188 offset:53248
  v_mfma_f32_16x16x32_bf16 v[72:75], v[136:139], v[172:175], v[72:75]
  s_waitcnt lgkmcnt(5)
  v_mfma_f32_16x16x32_bf16 v[20:23], v[140:143], v[168:171], v[20:23]
  ds_read_b128 v[132:135], v188 offset:53760
  v_mfma_f32_16x16x32_bf16 v[76:79], v[140:143], v[172:175], v[76:79]
  s_waitcnt lgkmcnt(5)
  v_mfma_f32_16x16x32_bf16 v[24:27], v[144:147], v[168:171], v[24:27]
  ds_read_b128 v[136:139], v188 offset:55296
  v_mfma_f32_16x16x32_bf16 v[80:83], v[144:147], v[172:175], v[80:83]
  s_waitcnt lgkmcnt(5)
  v_mfma_f32_16x16x32_bf16 v[28:31], v[148:151], v[168:171], v[28:31]
  ds_read_b128 v[140:143], v188 offset:55808
  v_mfma_f32_16x16x32_bf16 v[84:87], v[148:151], v[172:175], v[84:87]
  s_waitcnt lgkmcnt(5)
  v_mfma_f32_16x16x32_bf16 v[32:35], v[152:155], v[168:171], v[32:35]
  ds_read_b128 v[144:147], v188 offset:57344
  v_mfma_f32_16x16x32_bf16 v[88:91], v[152:155], v[172:175], v[88:91]
  s_waitcnt lgkmcnt(5)
  v_mfma_f32_16x16x32_bf16 v[36:39], v[156:159], v[168:171], v[36:39]
  ds_read_b128 v[148:151], v188 offset:57856
  v_mfma_f32_16x16x32_bf16 v[92:95], v[156:159], v[172:175], v[92:95]
  s_waitcnt lgkmcnt(5)
  v_mfma_f32_16x16x32_bf16 v[40:43], v[128:131], v[168:171], v[40:43]
  ds_read_b128 v[152:155], v188 offset:59392
  v_mfma_f32_16x16x32_bf16 v[96:99], v[128:131], v[172:175], v[96:99]
  s_waitcnt lgkmcnt(5)
  v_mfma_f32_16x16x32_bf16 v[44:47], v[132:135], v[168:171], v[44:47]
  ds_read_b128 v[156:159], v188 offset:59904
  v_mfma_f32_16x16x32_bf16 v[100:103], v[132:135], v[172:175], v[100:103]
  s_waitcnt lgkmcnt(5)
  v_mfma_f32_16x16x32_bf16 v[48:51], v[136:139], v[168:171], v[48:51]
  v_mfma_f32_16x16x32_bf16 v[104:107], v[136:139], v[172:175], v[104:107]
  s_waitcnt lgkmcnt(4)
  v_mfma_f32_16x16x32_bf16 v[52:55], v[140:143], v[168:171], v[52:55]
  v_mfma_f32_16x16x32_bf16 v[108:111], v[140:143], v[172:175], v[108:111]
  s_waitcnt lgkmcnt(3)
  v_mfma_f32_16x16x32_bf16 v[56:59], v[144:147], v[168:171], v[56:59]
  v_mfma_f32_16x16x32_bf16 v[112:115], v[144:147], v[172:175], v[112:115]
  s_waitcnt lgkmcnt(2)
  v_mfma_f32_16x16x32_bf16 v[60:63], v[148:151], v[168:171], v[60:63]
  v_mfma_f32_16x16x32_bf16 v[116:119], v[148:151], v[172:175], v[116:119]
  s_waitcnt lgkmcnt(1)
  v_mfma_f32_16x16x32_bf16 v[64:67], v[152:155], v[168:171], v[64:67]
  v_mfma_f32_16x16x32_bf16 v[120:123], v[152:155], v[172:175], v[120:123]
  s_waitcnt lgkmcnt(0)
  v_mfma_f32_16x16x32_bf16 v[68:71], v[156:159], v[168:171], v[68:71]
  v_mfma_f32_16x16x32_bf16 v[124:127], v[156:159], v[172:175], v[124:127]
  ds_read_b128 v[128:131], v5 offset:0
  ds_read_b128 v[132:135], v5 offset:64
  ds_read_b128 v[136:139], v5 offset:128
  ds_read_b128 v[140:143], v5 offset:192
  s_waitcnt lgkmcnt(3)
  v_pk_fma_f32 v[16:17], v[128:129], v[184:185], v[16:17] op_sel:[0,0,0] op_sel_hi:[1,0,1] neg_lo:[0,1,0] neg_hi:[0,1,0]
  v_pk_fma_f32 v[18:19], v[130:131], v[184:185], v[18:19] op_sel:[0,0,0] op_sel_hi:[1,0,1] neg_lo:[0,1,0] neg_hi:[0,1,0]
  s_waitcnt lgkmcnt(2)
  v_pk_fma_f32 v[20:21], v[132:133], v[184:185], v[20:21] op_sel:[0,0,0] op_sel_hi:[1,0,1] neg_lo:[0,1,0] neg_hi:[0,1,0]
  v_pk_fma_f32 v[22:23], v[134:135], v[184:185], v[22:23] op_sel:[0,0,0] op_sel_hi:[1,0,1] neg_lo:[0,1,0] neg_hi:[0,1,0]
  v_pk_fma_f32 v[72:73], v[128:129], v[186:187], v[72:73] op_sel:[0,0,0] op_sel_hi:[1,0,1] neg_lo:[0,1,0] neg_hi:[0,1,0]
  v_pk_fma_f32 v[74:75], v[130:131], v[186:187], v[74:75] op_sel:[0,0,0] op_sel_hi:[1,0,1] neg_lo:[0,1,0] neg_hi:[0,1,0]
  v_pk_fma_f32 v[76:77], v[132:133], v[186:187], v[76:77] op_sel:[0,0,0] op_sel_hi:[1,0,1] neg_lo:[0,1,0] neg_hi:[0,1,0]
  v_pk_fma_f32 v[78:79], v[134:135], v[186:187], v[78:79] op_sel:[0,0,0] op_sel_hi:[1,0,1] neg_lo:[0,1,0] neg_hi:[0,1,0]
  v_pk_mul_f32 v[16:17], v[16:17], v[20:21]
  v_pk_mul_f32 v[18:19], v[18:19], v[22:23]
  v_pk_mul_f32 v[72:73], v[72:73], v[76:77]
  v_pk_mul_f32 v[74:75], v[74:75], v[78:79]
  v_pk_mul_f32 v[16:17], v[16:17], v[184:185] op_sel:[0,1] op_sel_hi:[1,1]
  v_pk_mul_f32 v[18:19], v[18:19], v[184:185] op_sel:[0,1] op_sel_hi:[1,1]
  v_pk_mul_f32 v[72:73], v[72:73], v[186:187] op_sel:[0,1] op_sel_hi:[1,1]
  v_pk_mul_f32 v[74:75], v[74:75], v[186:187] op_sel:[0,1] op_sel_hi:[1,1]
  v_cvt_pk_bf16_f32 v160, v16, v17
  v_cvt_pk_bf16_f32 v161, v18, v19
  v_cvt_pk_bf16_f32 v162, v72, v73
  v_cvt_pk_bf16_f32 v163, v74, v75
  s_nop 0
  v_permlane16_swap_b32 v160, v162
  v_permlane16_swap_b32 v161, v163
  s_add_u32 s16, s12, 0
  s_lshr_b32 s17, s16, 1
  s_lshl_b32 s17, s17, 10
  s_and_b32 s16, s16, 1
  s_lshl_b32 s16, s16, 9
  s_add_u32 s16, s16, s17
  buffer_store_dwordx4 v[160:163], v4, s[28:31], s16 offen sc1
  ds_read_b128 v[128:131], v5 offset:256
  ds_read_b128 v[132:135], v5 offset:320
  s_waitcnt lgkmcnt(3)
  v_pk_fma_f32 v[24:25], v[136:137], v[184:185], v[24:25] op_sel:[0,0,0] op_sel_hi:[1,0,1] neg_lo:[0,1,0] neg_hi:[0,1,0]
  v_pk_fma_f32 v[26:27], v[138:139], v[184:185], v[26:27] op_sel:[0,0,0] op_sel_hi:[1,0,1] neg_lo:[0,1,0] neg_hi:[0,1,0]
  s_waitcnt lgkmcnt(2)
  v_pk_fma_f32 v[28:29], v[140:141], v[184:185], v[28:29] op_sel:[0,0,0] op_sel_hi:[1,0,1] neg_lo:[0,1,0] neg_hi:[0,1,0]
  v_pk_fma_f32 v[30:31], v[142:143], v[184:185], v[30:31] op_sel:[0,0,0] op_sel_hi:[1,0,1] neg_lo:[0,1,0] neg_hi:[0,1,0]
  v_pk_fma_f32 v[80:81], v[136:137], v[186:187], v[80:81] op_sel:[0,0,0] op_sel_hi:[1,0,1] neg_lo:[0,1,0] neg_hi:[0,1,0]
  v_pk_fma_f32 v[82:83], v[138:139], v[186:187], v[82:83] op_sel:[0,0,0] op_sel_hi:[1,0,1] neg_lo:[0,1,0] neg_hi:[0,1,0]
  v_pk_fma_f32 v[84:85], v[140:141], v[186:187], v[84:85] op_sel:[0,0,0] op_sel_hi:[1,0,1] neg_lo:[0,1,0] neg_hi:[0,1,0]
  v_pk_fma_f32 v[86:87], v[142:143], v[186:187], v[86:87] op_sel:[0,0,0] op_sel_hi:[1,0,1] neg_lo:[0,1,0] neg_hi:[0,1,0]
  v_pk_mul_f32 v[24:25], v[24:25], v[28:29]
  v_pk_mul_f32 v[26:27], v[26:27], v[30:31]
  v_pk_mul_f32 v[80:81], v[80:81], v[84:85]
  v_pk_mul_f32 v[82:83], v[82:83], v[86:87]
  v_pk_mul_f32 v[24:25], v[24:25], v[184:185] op_sel:[0,1] op_sel_hi:[1,1]
  v_pk_mul_f32 v[26:27], v[26:27], v[184:185] op_sel:[0,1] op_sel_hi:[1,1]
  v_pk_mul_f32 v[80:81], v[80:81], v[186:187] op_sel:[0,1] op_sel_hi:[1,1]
  v_pk_mul_f32 v[82:83], v[82:83], v[186:187] op_sel:[0,1] op_sel_hi:[1,1]
  v_cvt_pk_bf16_f32 v164, v24, v25
  v_cvt_pk_bf16_f32 v165, v26, v27
  v_cvt_pk_bf16_f32 v166, v80, v81
  v_cvt_pk_bf16_f32 v167, v82, v83
  s_nop 0
  v_permlane16_swap_b32 v164, v166
  v_permlane16_swap_b32 v165, v167
  s_add_u32 s16, s12, 1
  s_lshr_b32 s17, s16, 1
  s_lshl_b32 s17, s17, 10
  s_and_b32 s16, s16, 1
  s_lshl_b32 s16, s16, 9
  s_add_u32 s16, s16, s17
  buffer_store_dwordx4 v[164:167], v4, s[28:31], s16 offen sc1
  ds_read_b128 v[136:139], v5 offset:384
  ds_read_b128 v[140:143], v5 offset:448
  s_waitcnt lgkmcnt(3)
  v_pk_fma_f32 v[32:33], v[128:129], v[184:185], v[32:33] op_sel:[0,0,0] op_sel_hi:[1,0,1] neg_lo:[0,1,0] neg_hi:[0,1,0]
  v_pk_fma_f32 v[34:35], v[130:131], v[184:185], v[34:35] op_sel:[0,0,0] op_sel_hi:[1,0,1] neg_lo:[0,1,0] neg_hi:[0,1,0]
  s_waitcnt lgkmcnt(2)
  v_pk_fma_f32 v[36:37], v[132:133], v[184:185], v[36:37] op_sel:[0,0,0] op_sel_hi:[1,0,1] neg_lo:[0,1,0] neg_hi:[0,1,0]
  v_pk_fma_f32 v[38:39], v[134:135], v[184:185], v[38:39] op_sel:[0,0,0] op_sel_hi:[1,0,1] neg_lo:[0,1,0] neg_hi:[0,1,0]
  v_pk_fma_f32 v[88:89], v[128:129], v[186:187], v[88:89] op_sel:[0,0,0] op_sel_hi:[1,0,1] neg_lo:[0,1,0] neg_hi:[0,1,0]
  v_pk_fma_f32 v[90:91], v[130:131], v[186:187], v[90:91] op_sel:[0,0,0] op_sel_hi:[1,0,1] neg_lo:[0,1,0] neg_hi:[0,1,0]
  v_pk_fma_f32 v[92:93], v[132:133], v[186:187], v[92:93] op_sel:[0,0,0] op_sel_hi:[1,0,1] neg_lo:[0,1,0] neg_hi:[0,1,0]
  v_pk_fma_f32 v[94:95], v[134:135], v[186:187], v[94:95] op_sel:[0,0,0] op_sel_hi:[1,0,1] neg_lo:[0,1,0] neg_hi:[0,1,0]
  v_pk_mul_f32 v[32:33], v[32:33], v[36:37]
  v_pk_mul_f32 v[34:35], v[34:35], v[38:39]
  v_pk_mul_f32 v[88:89], v[88:89], v[92:93]
  v_pk_mul_f32 v[90:91], v[90:91], v[94:95]
  v_pk_mul_f32 v[32:33], v[32:33], v[184:185] op_sel:[0,1] op_sel_hi:[1,1]
  v_pk_mul_f32 v[34:35], v[34:35], v[184:185] op_sel:[0,1] op_sel_hi:[1,1]
  v_pk_mul_f32 v[88:89], v[88:89], v[186:187] op_sel:[0,1] op_sel_hi:[1,1]
  v_pk_mul_f32 v[90:91], v[90:91], v[186:187] op_sel:[0,1] op_sel_hi:[1,1]
  v_cvt_pk_bf16_f32 v168, v32, v33
  v_cvt_pk_bf16_f32 v169, v34, v35
  v_cvt_pk_bf16_f32 v170, v88, v89
  v_cvt_pk_bf16_f32 v171, v90, v91
  s_nop 0
  v_permlane16_swap_b32 v168, v170
  v_permlane16_swap_b32 v169, v171
  s_add_u32 s16, s12, 2
  s_lshr_b32 s17, s16, 1
  s_lshl_b32 s17, s17, 10
  s_and_b32 s16, s16, 1
  s_lshl_b32 s16, s16, 9
  s_add_u32 s16, s16, s17
  buffer_store_dwordx4 v[168:171], v4, s[28:31], s16 offen sc1
  ds_read_b128 v[128:131], v5 offset:512
  ds_read_b128 v[132:135], v5 offset:576
  s_waitcnt lgkmcnt(3)
  v_pk_fma_f32 v[40:41], v[136:137], v[184:185], v[40:41] op_sel:[0,0,0] op_sel_hi:[1,0,1] neg_lo:[0,1,0] neg_hi:[0,1,0]
  v_pk_fma_f32 v[42:43], v[138:139], v[184:185], v[42:43] op_sel:[0,0,0] op_sel_hi:[1,0,1] neg_lo:[0,1,0] neg_hi:[0,1,0]
  s_waitcnt lgkmcnt(2)
  v_pk_fma_f32 v[44:45], v[140:141], v[184:185], v[44:45] op_sel:[0,0,0] op_sel_hi:[1,0,1] neg_lo:[0,1,0] neg_hi:[0,1,0]
  v_pk_fma_f32 v[46:47], v[142:143], v[184:185], v[46:47] op_sel:[0,0,0] op_sel_hi:[1,0,1] neg_lo:[0,1,0] neg_hi:[0,1,0]
  v_pk_fma_f32 v[96:97], v[136:137], v[186:187], v[96:97] op_sel:[0,0,0] op_sel_hi:[1,0,1] neg_lo:[0,1,0] neg_hi:[0,1,0]
  v_pk_fma_f32 v[98:99], v[138:139], v[186:187], v[98:99] op_sel:[0,0,0] op_sel_hi:[1,0,1] neg_lo:[0,1,0] neg_hi:[0,1,0]
  v_pk_fma_f32 v[100:101], v[140:141], v[186:187], v[100:101] op_sel:[0,0,0] op_sel_hi:[1,0,1] neg_lo:[0,1,0] neg_hi:[0,1,0]
  v_pk_fma_f32 v[102:103], v[142:143], v[186:187], v[102:103] op_sel:[0,0,0] op_sel_hi:[1,0,1] neg_lo:[0,1,0] neg_hi:[0,1,0]
  v_pk_mul_f32 v[40:41], v[40:41], v[44:45]
  v_pk_mul_f32 v[42:43], v[42:43], v[46:47]
  v_pk_mul_f32 v[96:97], v[96:97], v[100:101]
  v_pk_mul_f32 v[98:99], v[98:99], v[102:103]
  v_pk_mul_f32 v[40:41], v[40:41], v[184:185] op_sel:[0,1] op_sel_hi:[1,1]
  v_pk_mul_f32 v[42:43], v[42:43], v[184:185] op_sel:[0,1] op_sel_hi:[1,1]
  v_pk_mul_f32 v[96:97], v[96:97], v[186:187] op_sel:[0,1] op_sel_hi:[1,1]
  v_pk_mul_f32 v[98:99], v[98:99], v[186:187] op_sel:[0,1] op_sel_hi:[1,1]
  v_cvt_pk_bf16_f32 v172, v40, v41
  v_cvt_pk_bf16_f32 v173, v42, v43
  v_cvt_pk_bf16_f32 v174, v96, v97
  v_cvt_pk_bf16_f32 v175, v98, v99
  s_nop 0
  v_permlane16_swap_b32 v172, v174
  v_permlane16_swap_b32 v173, v175
  s_add_u32 s16, s12, 3
  s_lshr_b32 s17, s16, 1
  s_lshl_b32 s17, s17, 10
  s_and_b32 s16, s16, 1
  s_lshl_b32 s16, s16, 9
  s_add_u32 s16, s16, s17
  buffer_store_dwordx4 v[172:175], v4, s[28:31], s16 offen sc1
  ds_read_b128 v[136:139], v5 offset:640
  ds_read_b128 v[140:143], v5 offset:704
  s_waitcnt lgkmcnt(3)
  v_pk_fma_f32 v[48:49], v[128:129], v[184:185], v[48:49] op_sel:[0,0,0] op_sel_hi:[1,0,1] neg_lo:[0,1,0] neg_hi:[0,1,0]
  v_pk_fma_f32 v[50:51], v[130:131], v[184:185], v[50:51] op_sel:[0,0,0] op_sel_hi:[1,0,1] neg_lo:[0,1,0] neg_hi:[0,1,0]
  s_waitcnt lgkmcnt(2)
  v_pk_fma_f32 v[52:53], v[132:133], v[184:185], v[52:53] op_sel:[0,0,0] op_sel_hi:[1,0,1] neg_lo:[0,1,0] neg_hi:[0,1,0]
  v_pk_fma_f32 v[54:55], v[134:135], v[184:185], v[54:55] op_sel:[0,0,0] op_sel_hi:[1,0,1] neg_lo:[0,1,0] neg_hi:[0,1,0]
  v_pk_fma_f32 v[104:105], v[128:129], v[186:187], v[104:105] op_sel:[0,0,0] op_sel_hi:[1,0,1] neg_lo:[0,1,0] neg_hi:[0,1,0]
  v_pk_fma_f32 v[106:107], v[130:131], v[186:187], v[106:107] op_sel:[0,0,0] op_sel_hi:[1,0,1] neg_lo:[0,1,0] neg_hi:[0,1,0]
  v_pk_fma_f32 v[108:109], v[132:133], v[186:187], v[108:109] op_sel:[0,0,0] op_sel_hi:[1,0,1] neg_lo:[0,1,0] neg_hi:[0,1,0]
  v_pk_fma_f32 v[110:111], v[134:135], v[186:187], v[110:111] op_sel:[0,0,0] op_sel_hi:[1,0,1] neg_lo:[0,1,0] neg_hi:[0,1,0]
  v_pk_mul_f32 v[48:49], v[48:49], v[52:53]
  v_pk_mul_f32 v[50:51], v[50:51], v[54:55]
  v_pk_mul_f32 v[104:105], v[104:105], v[108:109]
  v_pk_mul_f32 v[106:107], v[106:107], v[110:111]
  v_pk_mul_f32 v[48:49], v[48:49], v[184:185] op_sel:[0,1] op_sel_hi:[1,1]
  v_pk_mul_f32 v[50:51], v[50:51], v[184:185] op_sel:[0,1] op_sel_hi:[1,1]
  v_pk_mul_f32 v[104:105], v[104:105], v[186:187] op_sel:[0,1] op_sel_hi:[1,1]
  v_pk_mul_f32 v[106:107], v[106:107], v[186:187] op_sel:[0,1] op_sel_hi:[1,1]
  v_cvt_pk_bf16_f32 v160, v48, v49
  v_cvt_pk_bf16_f32 v161, v50, v51
  v_cvt_pk_bf16_f32 v162, v104, v105
  v_cvt_pk_bf16_f32 v163, v106, v107
  s_nop 0
  v_permlane16_swap_b32 v160, v162
  v_permlane16_swap_b32 v161, v163
  s_add_u32 s16, s12, 4
  s_lshr_b32 s17, s16, 1
  s_lshl_b32 s17, s17, 10
  s_and_b32 s16, s16, 1
  s_lshl_b32 s16, s16, 9
  s_add_u32 s16, s16, s17
  buffer_store_dwordx4 v[160:163], v4, s[28:31], s16 offen sc1
  ds_read_b128 v[128:131], v5 offset:768
  ds_read_b128 v[132:135], v5 offset:832
  s_waitcnt lgkmcnt(3)
  v_pk_fma_f32 v[56:57], v[136:137], v[184:185], v[56:57] op_sel:[0,0,0] op_sel_hi:[1,0,1] neg_lo:[0,1,0] neg_hi:[0,1,0]
  v_pk_fma_f32 v[58:59], v[138:139], v[184:185], v[58:59] op_sel:[0,0,0] op_sel_hi:[1,0,1] neg_lo:[0,1,0] neg_hi:[0,1,0]
  s_waitcnt lgkmcnt(2)
  v_pk_fma_f32 v[60:61], v[140:141], v[184:185], v[60:61] op_sel:[0,0,0] op_sel_hi:[1,0,1] neg_lo:[0,1,0] neg_hi:[0,1,0]
  v_pk_fma_f32 v[62:63], v[142:143], v[184:185], v[62:63] op_sel:[0,0,0] op_sel_hi:[1,0,1] neg_lo:[0,1,0] neg_hi:[0,1,0]
  v_pk_fma_f32 v[112:113], v[136:137], v[186:187], v[112:113] op_sel:[0,0,0] op_sel_hi:[1,0,1] neg_lo:[0,1,0] neg_hi:[0,1,0]
  v_pk_fma_f32 v[114:115], v[138:139], v[186:187], v[114:115] op_sel:[0,0,0] op_sel_hi:[1,0,1] neg_lo:[0,1,0] neg_hi:[0,1,0]
  v_pk_fma_f32 v[116:117], v[140:141], v[186:187], v[116:117] op_sel:[0,0,0] op_sel_hi:[1,0,1] neg_lo:[0,1,0] neg_hi:[0,1,0]
  v_pk_fma_f32 v[118:119], v[142:143], v[186:187], v[118:119] op_sel:[0,0,0] op_sel_hi:[1,0,1] neg_lo:[0,1,0] neg_hi:[0,1,0]
  v_pk_mul_f32 v[56:57], v[56:57], v[60:61]
  v_pk_mul_f32 v[58:59], v[58:59], v[62:63]
  v_pk_mul_f32 v[112:113], v[112:113], v[116:117]
  v_pk_mul_f32 v[114:115], v[114:115], v[118:119]
  v_pk_mul_f32 v[56:57], v[56:57], v[184:185] op_sel:[0,1] op_sel_hi:[1,1]
  v_pk_mul_f32 v[58:59], v[58:59], v[184:185] op_sel:[0,1] op_sel_hi:[1,1]
  v_pk_mul_f32 v[112:113], v[112:113], v[186:187] op_sel:[0,1] op_sel_hi:[1,1]
  v_pk_mul_f32 v[114:115], v[114:115], v[186:187] op_sel:[0,1] op_sel_hi:[1,1]
  v_cvt_pk_bf16_f32 v164, v56, v57
  v_cvt_pk_bf16_f32 v165, v58, v59
  v_cvt_pk_bf16_f32 v166, v112, v113
  v_cvt_pk_bf16_f32 v167, v114, v115
  s_nop 0
  v_permlane16_swap_b32 v164, v166
  v_permlane16_swap_b32 v165, v167
  s_add_u32 s16, s12, 5
  s_lshr_b32 s17, s16, 1
  s_lshl_b32 s17, s17, 10
  s_and_b32 s16, s16, 1
  s_lshl_b32 s16, s16, 9
  s_add_u32 s16, s16, s17
  buffer_store_dwordx4 v[164:167], v4, s[28:31], s16 offen sc1
  s_waitcnt lgkmcnt(1)
  v_pk_fma_f32 v[64:65], v[128:129], v[184:185], v[64:65] op_sel:[0,0,0] op_sel_hi:[1,0,1] neg_lo:[0,1,0] neg_hi:[0,1,0]
  v_pk_fma_f32 v[66:67], v[130:131], v[184:185], v[66:67] op_sel:[0,0,0] op_sel_hi:[1,0,1] neg_lo:[0,1,0] neg_hi:[0,1,0]
  s_waitcnt lgkmcnt(0)
  v_pk_fma_f32 v[68:69], v[132:133], v[184:185], v[68:69] op_sel:[0,0,0] op_sel_hi:[1,0,1] neg_lo:[0,1,0] neg_hi:[0,1,0]
  v_pk_fma_f32 v[70:71], v[134:135], v[184:185], v[70:71] op_sel:[0,0,0] op_sel_hi:[1,0,1] neg_lo:[0,1,0] neg_hi:[0,1,0]
  v_pk_fma_f32 v[120:121], v[128:129], v[186:187], v[120:121] op_sel:[0,0,0] op_sel_hi:[1,0,1] neg_lo:[0,1,0] neg_hi:[0,1,0]
  v_pk_fma_f32 v[122:123], v[130:131], v[186:187], v[122:123] op_sel:[0,0,0] op_sel_hi:[1,0,1] neg_lo:[0,1,0] neg_hi:[0,1,0]
  v_pk_fma_f32 v[124:125], v[132:133], v[186:187], v[124:125] op_sel:[0,0,0] op_sel_hi:[1,0,1] neg_lo:[0,1,0] neg_hi:[0,1,0]
  v_pk_fma_f32 v[126:127], v[134:135], v[186:187], v[126:127] op_sel:[0,0,0] op_sel_hi:[1,0,1] neg_lo:[0,1,0] neg_hi:[0,1,0]
  v_pk_mul_f32 v[64:65], v[64:65], v[68:69]
  v_pk_mul_f32 v[66:67], v[66:67], v[70:71]
  v_pk_mul_f32 v[120:121], v[120:121], v[124:125]
  v_pk_mul_f32 v[122:123], v[122:123], v[126:127]
  v_pk_mul_f32 v[64:65], v[64:65], v[184:185] op_sel:[0,1] op_sel_hi:[1,1]
  v_pk_mul_f32 v[66:67], v[66:67], v[184:185] op_sel:[0,1] op_sel_hi:[1,1]
  v_pk_mul_f32 v[120:121], v[120:121], v[186:187] op_sel:[0,1] op_sel_hi:[1,1]
  v_pk_mul_f32 v[122:123], v[122:123], v[186:187] op_sel:[0,1] op_sel_hi:[1,1]
  v_cvt_pk_bf16_f32 v168, v64, v65
  v_cvt_pk_bf16_f32 v169, v66, v67
  v_cvt_pk_bf16_f32 v170, v120, v121
  v_cvt_pk_bf16_f32 v171, v122, v123
  s_nop 0
  v_permlane16_swap_b32 v168, v170
  v_permlane16_swap_b32 v169, v171
  s_add_u32 s16, s12, 6
  s_lshr_b32 s17, s16, 1
  s_lshl_b32 s17, s17, 10
  s_and_b32 s16, s16, 1
  s_lshl_b32 s16, s16, 9
  s_add_u32 s16, s16, s17
  buffer_store_dwordx4 v[168:171], v4, s[28:31], s16 offen sc1
  s_add_u32 s56, s8, 34603008
  s_addc_u32 s57, s9, 0
  s_and_b32 s57, s57, 0xffff
  s_mov_b32 s58, 1769472
  s_mov_b32 s59, 0x00020000
  s_mul_i32 s52, s11, 2048
  s_mul_i32 s53, s33, 128
  s_add_u32 s52, s52, s53
  s_lshl_b32 s53, s10, 2
  s_add_u32 s52, s52, s53
  s_add_u32 s52, s52, 196608
  v_mov_b32 v210, s52
  s_and_b32 s11, s13, 3
  s_lshl_b32 s11, s11, 3
  s_and_b32 s15, s14, 7
  s_add_u32 s11, s11, s15
  s_lshr_b32 s12, s13, 2
  s_lshl_b32 s12, s12, 2
  s_lshr_b32 s15, s14, 3
  s_add_u32 s12, s12, s15
  s_mov_b32 s44, 0
  v_lshlrev_b32 v1, 4, v0
  s_lshl_b32 s16, s11, 2
  s_add_u32 s16, s16, s10
  s_mul_i32 s16, s16, 55296
  v_add_u32 v2, s16, v1
  s_mul_i32 s17, s44, 3072
  s_waitcnt lgkmcnt(0)
  s_add_u32 s24, s8, 16777216
  s_addc_u32 s25, s9, 0
  s_and_b32 s25, s25, 0xffff
  s_mov_b32 s26, 7077888
  s_mov_b32 s27, 0x00020000
  s_waitcnt vmcnt(3)
  s_barrier
  s_waitcnt vmcnt(0)
  v_mov_b32 v211, 1
  s_mov_b64 exec, 1
  buffer_store_dword v211, v210, s[56:59], 0 offen sc1
  s_mov_b64 exec, -1
  s_barrier
  s_mov_b32 s17, 0
  buffer_load_dwordx4 v[88:91], v2, s[24:27], s17 offen
  s_mov_b32 s17, 1024
  buffer_load_dwordx4 v[92:95], v2, s[24:27], s17 offen
  s_mov_b32 s17, 3072
  buffer_load_dwordx4 v[96:99], v2, s[24:27], s17 offen
  s_mov_b32 s17, 4096
  buffer_load_dwordx4 v[100:103], v2, s[24:27], s17 offen
  s_mov_b32 s17, 7168
  buffer_load_dwordx4 v[104:107], v2, s[24:27], s17 offen
  s_mov_b32 s17, 10240
  buffer_load_dwordx4 v[108:111], v2, s[24:27], s17 offen
  v_and_b32 v7, 15, v0
  v_lshrrev_b32 v8, 4, v0
  s_lshl_b32 s16, s11, 6
  s_lshl_b32 s18, s10, 4
  s_add_u32 s16, s16, s18
  v_add_u32 v9, s16, v7
  v_mul_u32_u24 v3, 1280, v9
  s_mul_i32 s18, s12, 160
  v_lshl_add_u32 v3, v8, 3, v3
  v_add_u32 v3, s18, v3
  v_lshrrev_b32 v10, 5, v9
  v_mul_u32_u24 v10, 40960, v10
  v_and_b32 v11, 31, v9
  v_lshl_add_u32 v10, v11, 4, v10
  v_lshrrev_b32 v11, 1, v8
  v_lshl_add_u32 v10, v11, 9, v10
  v_and_b32 v11, 1, v8
  v_lshl_add_u32 v10, v11, 3, v10
  s_mul_i32 s18, s12, 5120
  v_add_u32 v4, s18, v10
  s_mov_b32 s32, s6
  s_and_b32 s33, s7, 0xffff
  s_mov_b32 s34, 2621440
  s_mov_b32 s35, 0x00020000
  v_add_u32 v15, 65536, v1
  v_add_u32 v14, 131072, v1
  s_barrier
  ds_read_b128 v[48:51], v1 offset:0
  ds_read_b128 v[52:55], v1 offset:1024
  ds_read_b128 v[56:59], v1 offset:2048
  ds_read_b128 v[60:63], v1 offset:3072
  ds_read_b128 v[64:67], v1 offset:4096
  s_waitcnt vmcnt(5) lgkmcnt(4)
  v_mfma_f32_16x16x32_bf16 v[28:31], v[48:51], v[88:91], 0
  ds_read_b128 v[68:71], v1 offset:5120
  s_waitcnt lgkmcnt(4)
  v_mfma_f32_16x16x32_bf16 v[32:35], v[52:55], v[88:91], 0
  ds_read_b128 v[72:75], v1 offset:6144
  s_waitcnt lgkmcnt(4)
  v_mfma_f32_16x16x32_bf16 v[36:39], v[56:59], v[88:91], 0
  ds_read_b128 v[76:79], v1 offset:7168
  s_waitcnt lgkmcnt(4)
  v_mfma_f32_16x16x32_bf16 v[40:43], v[60:63], v[88:91], 0
  ds_read_b128 v[80:83], v1 offset:8192
  s_waitcnt lgkmcnt(4)
  v_mfma_f32_16x16x32_bf16 v[44:47], v[64:67], v[88:91], 0
  ds_read_b128 v[84:87], v1 offset:9216
  s_mov_b32 s17, 11264
  buffer_load_dwordx4 v[88:91], v2, s[24:27], s17 offen
  s_waitcnt vmcnt(5) lgkmcnt(4)
  v_mfma_f32_16x16x32_bf16 v[28:31], v[68:71], v[92:95], v[28:31]
  ds_read_b128 v[48:51], v1 offset:10240
  s_waitcnt lgkmcnt(4)
  v_mfma_f32_16x16x32_bf16 v[32:35], v[72:75], v[92:95], v[32:35]
  ds_read_b128 v[52:55], v1 offset:11264
  s_waitcnt lgkmcnt(4)
  v_mfma_f32_16x16x32_bf16 v[36:39], v[76:79], v[92:95], v[36:39]
  ds_read_b128 v[56:59], v1 offset:12288
  s_waitcnt lgkmcnt(4)
  v_mfma_f32_16x16x32_bf16 v[40:43], v[80:83], v[92:95], v[40:43]
  ds_read_b128 v[60:63], v1 offset:13312
  s_waitcnt lgkmcnt(4)
  v_mfma_f32_16x16x32_bf16 v[44:47], v[84:87], v[92:95], v[44:47]
  ds_read_b128 v[64:67], v1 offset:14336
  s_mov_b32 s17, 14336
  buffer_load_dwordx4 v[92:95], v2, s[24:27], s17 offen
  s_waitcnt lgkmcnt(0)
  s_barrier
  s_waitcnt vmcnt(5)
  v_mfma_f32_16x16x32_bf16 v[28:31], v[48:51], v[96:99], v[28:31]
  ds_read_b128 v[68:71], v1 offset:15360
  v_mfma_f32_16x16x32_bf16 v[32:35], v[52:55], v[96:99], v[32:35]
  ds_read_b128 v[72:75], v1 offset:16384
  v_mfma_f32_16x16x32_bf16 v[36:39], v[56:59], v[96:99], v[36:39]
  ds_read_b128 v[76:79], v1 offset:17408
  v_mfma_f32_16x16x32_bf16 v[40:43], v[60:63], v[96:99], v[40:43]
  ds_read_b128 v[80:83], v1 offset:18432
  v_mfma_f32_16x16x32_bf16 v[44:47], v[64:67], v[96:99], v[44:47]
  ds_read_b128 v[84:87], v1 offset:19456
  s_mov_b32 s17, 17408
  buffer_load_dwordx4 v[96:99], v2, s[24:27], s17 offen
  s_waitcnt vmcnt(5) lgkmcnt(4)
  v_mfma_f32_16x16x32_bf16 v[28:31], v[68:71], v[100:103], v[28:31]
  ds_read_b128 v[48:51], v1 offset:20480
  s_waitcnt lgkmcnt(4)
  v_mfma_f32_16x16x32_bf16 v[32:35], v[72:75], v[100:103], v[32:35]
  ds_read_b128 v[52:55], v1 offset:21504
  s_waitcnt lgkmcnt(4)
  v_mfma_f32_16x16x32_bf16 v[36:39], v[76:79], v[100:103], v[36:39]
  ds_read_b128 v[56:59], v1 offset:22528
  s_waitcnt lgkmcnt(4)
  v_mfma_f32_16x16x32_bf16 v[40:43], v[80:83], v[100:103], v[40:43]
  ds_read_b128 v[60:63], v1 offset:23552
  s_waitcnt lgkmcnt(4)
  v_mfma_f32_16x16x32_bf16 v[44:47], v[84:87], v[100:103], v[44:47]
  ds_read_b128 v[64:67], v1 offset:24576
  s_mov_b32 s17, 20480
  buffer_load_dwordx4 v[100:103], v2, s[24:27], s17 offen
  s_waitcnt vmcnt(5) lgkmcnt(4)
  v_mfma_f32_16x16x32_bf16 v[28:31], v[48:51], v[104:107], v[28:31]
  ds_read_b128 v[68:71], v1 offset:25600
  s_waitcnt lgkmcnt(4)
  v_mfma_f32_16x16x32_bf16 v[32:35], v[52:55], v[104:107], v[32:35]
  ds_read_b128 v[72:75], v1 offset:26624
  s_waitcnt lgkmcnt(4)
  v_mfma_f32_16x16x32_bf16 v[36:39], v[56:59], v[104:107], v[36:39]
  ds_read_b128 v[76:79], v1 offset:27648
  s_waitcnt lgkmcnt(4)
  v_mfma_f32_16x16x32_bf16 v[40:43], v[60:63], v[104:107], v[40:43]
  ds_read_b128 v[80:83], v1 offset:28672
  s_waitcnt lgkmcnt(4)
  v_mfma_f32_16x16x32_bf16 v[44:47], v[64:67], v[104:107], v[44:47]
  ds_read_b128 v[84:87], v1 offset:29696
  s_mov_b32 s17, 21504
  buffer_load_dwordx4 v[104:107], v2, s[24:27], s17 offen
  s_waitcnt lgkmcnt(0)
  s_barrier
  s_waitcnt vmcnt(5)
  v_mfma_f32_16x16x32_bf16 v[28:31], v[68:71], v[108:111], v[28:31]
  ds_read_b128 v[48:51], v1 offset:30720
  v_mfma_f32_16x16x32_bf16 v[32:35], v[72:75], v[108:111], v[32:35]
  ds_read_b128 v[52:55], v1 offset:31744
  v_mfma_f32_16x16x32_bf16 v[36:39], v[76:79], v[108:111], v[36:39]
  ds_read_b128 v[56:59], v1 offset:32768
  v_mfma_f32_16x16x32_bf16 v[40:43], v[80:83], v[108:111], v[40:43]
  ds_read_b128 v[60:63], v1 offset:33792
  v_mfma_f32_16x16x32_bf16 v[44:47], v[84:87], v[108:111], v[44:47]
  ds_read_b128 v[64:67], v1 offset:34816
  s_mov_b32 s17, 24576
  buffer_load_dwordx4 v[108:111], v2, s[24:27], s17 offen
  s_waitcnt vmcnt(5) lgkmcnt(4)
  v_mfma_f32_16x16x32_bf16 v[28:31], v[48:51], v[88:91], v[28:31]
  ds_read_b128 v[68:71], v1 offset:35840
  s_waitcnt lgkmcnt(4)
  v_mfma_f32_16x16x32_bf16 v[32:35], v[52:55], v[88:91], v[32:35]
  ds_read_b128 v[72:75], v1 offset:36864
  s_waitcnt lgkmcnt(4)
  v_mfma_f32_16x16x32_bf16 v[36:39], v[56:59], v[88:91], v[36:39]
  ds_read_b128 v[76:79], v1 offset:37888
  s_waitcnt lgkmcnt(4)
  v_mfma_f32_16x16x32_bf16 v[40:43], v[60:63], v[88:91], v[40:43]
  ds_read_b128 v[80:83], v1 offset:38912
  s_waitcnt lgkmcnt(4)
  v_mfma_f32_16x16x32_bf16 v[44:47], v[64:67], v[88:91], v[44:47]
  ds_read_b128 v[84:87], v1 offset:39936
  s_mov_b32 s17, 27648
  buffer_load_dwordx4 v[88:91], v2, s[24:27], s17 offen
  s_waitcnt vmcnt(5) lgkmcnt(4)
  v_mfma_f32_16x16x32_bf16 v[28:31], v[68:71], v[92:95], v[28:31]
  ds_read_b128 v[48:51], v1 offset:40960
  s_waitcnt lgkmcnt(4)
  v_mfma_f32_16x16x32_bf16 v[32:35], v[72:75], v[92:95], v[32:35]
  ds_read_b128 v[52:55], v1 offset:41984
  s_waitcnt lgkmcnt(4)
  v_mfma_f32_16x16x32_bf16 v[36:39], v[76:79], v[92:95], v[36:39]
  ds_read_b128 v[56:59], v1 offset:43008
  s_waitcnt lgkmcnt(4)
  v_mfma_f32_16x16x32_bf16 v[40:43], v[80:83], v[92:95], v[40:43]
  ds_read_b128 v[60:63], v1 offset:44032
  s_waitcnt lgkmcnt(4)
  v_mfma_f32_16x16x32_bf16 v[44:47], v[84:87], v[92:95], v[44:47]
  ds_read_b128 v[64:67], v1 offset:45056
  s_mov_b32 s17, 28672
  buffer_load_dwordx4 v[92:95], v2, s[24:27], s17 offen
  s_waitcnt lgkmcnt(0)
  s_barrier
  s_waitcnt vmcnt(5)
  v_mfma_f32_16x16x32_bf16 v[28:31], v[48:51], v[96:99], v[28:31]
  ds_read_b128 v[68:71], v1 offset:46080
  v_mfma_f32_16x16x32_bf16 v[32:35], v[52:55], v[96:99], v[32:35]
  ds_read_b128 v[72:75], v1 offset:47104
  v_mfma_f32_16x16x32_bf16 v[36:39], v[56:59], v[96:99], v[36:39]
  ds_read_b128 v[76:79], v1 offset:48128
  v_mfma_f32_16x16x32_bf16 v[40:43], v[60:63], v[96:99], v[40:43]
  ds_read_b128 v[80:83], v1 offset:49152
  v_mfma_f32_16x16x32_bf16 v[44:47], v[64:67], v[96:99], v[44:47]
  ds_read_b128 v[84:87], v1 offset:50176
  s_mov_b32 s17, 30720
  buffer_load_dwordx4 v[96:99], v2, s[24:27], s17 offen
  s_waitcnt vmcnt(5) lgkmcnt(4)
  v_mfma_f32_16x16x32_bf16 v[28:31], v[68:71], v[100:103], v[28:31]
  ds_read_b128 v[48:51], v1 offset:51200
  s_waitcnt lgkmcnt(4)
  v_mfma_f32_16x16x32_bf16 v[32:35], v[72:75], v[100:103], v[32:35]
  ds_read_b128 v[52:55], v1 offset:52224
  s_waitcnt lgkmcnt(4)
  v_mfma_f32_16x16x32_bf16 v[36:39], v[76:79], v[100:103], v[36:39]
  ds_read_b128 v[56:59], v1 offset:53248
  s_waitcnt lgkmcnt(4)
  v_mfma_f32_16x16x32_bf16 v[40:43], v[80:83], v[100:103], v[40:43]
  ds_read_b128 v[60:63], v1 offset:54272
  s_waitcnt lgkmcnt(4)
  v_mfma_f32_16x16x32_bf16 v[44:47], v[84:87], v[100:103], v[44:47]
  ds_read_b128 v[64:67], v1 offset:55296
  s_mov_b32 s17, 31744
  buffer_load_dwordx4 v[100:103], v2, s[24:27], s17 offen
  s_waitcnt vmcnt(5) lgkmcnt(4)
  v_mfma_f32_16x16x32_bf16 v[28:31], v[48:51], v[104:107], v[28:31]
  ds_read_b128 v[68:71], v1 offset:56320
  s_waitcnt lgkmcnt(4)
  v_mfma_f32_16x16x32_bf16 v[32:35], v[52:55], v[104:107], v[32:35]
  ds_read_b128 v[72:75], v1 offset:57344
  s_waitcnt lgkmcnt(4)
  v_mfma_f32_16x16x32_bf16 v[36:39], v[56:59], v[104:107], v[36:39]
  ds_read_b128 v[76:79], v1 offset:58368
  s_waitcnt lgkmcnt(4)
  v_mfma_f32_16x16x32_bf16 v[40:43], v[60:63], v[104:107], v[40:43]
  ds_read_b128 v[80:83], v1 offset:59392
  s_waitcnt lgkmcnt(4)
  v_mfma_f32_16x16x32_bf16 v[44:47], v[64:67], v[104:107], v[44:47]
  ds_read_b128 v[84:87], v1 offset:60416
  s_mov_b32 s17, 34816
  buffer_load_dwordx4 v[104:107], v2, s[24:27], s17 offen
  s_waitcnt lgkmcnt(0)
  s_barrier
  s_waitcnt vmcnt(5)
  v_mfma_f32_16x16x32_bf16 v[28:31], v[68:71], v[108:111], v[28:31]
  ds_read_b128 v[48:51], v1 offset:61440
  v_mfma_f32_16x16x32_bf16 v[32:35], v[72:75], v[108:111], v[32:35]
  ds_read_b128 v[52:55], v1 offset:62464
  v_mfma_f32_16x16x32_bf16 v[36:39], v[76:79], v[108:111], v[36:39]
  ds_read_b128 v[56:59], v1 offset:63488
  v_mfma_f32_16x16x32_bf16 v[40:43], v[80:83], v[108:111], v[40:43]
  ds_read_b128 v[60:63], v1 offset:64512
  v_mfma_f32_16x16x32_bf16 v[44:47], v[84:87], v[108:111], v[44:47]
  ds_read_b128 v[64:67], v15 offset:0
  s_mov_b32 s17, 37888
  buffer_load_dwordx4 v[108:111], v2, s[24:27], s17 offen
  s_waitcnt vmcnt(5) lgkmcnt(4)
  v_mfma_f32_16x16x32_bf16 v[28:31], v[48:51], v[88:91], v[28:31]
  ds_read_b128 v[68:71], v15 offset:1024
  s_waitcnt lgkmcnt(4)
  v_mfma_f32_16x16x32_bf16 v[32:35], v[52:55], v[88:91], v[32:35]
  ds_read_b128 v[72:75], v15 offset:2048
  s_waitcnt lgkmcnt(4)
  v_mfma_f32_16x16x32_bf16 v[36:39], v[56:59], v[88:91], v[36:39]
  ds_read_b128 v[76:79], v15 offset:3072
  s_waitcnt lgkmcnt(4)
  v_mfma_f32_16x16x32_bf16 v[40:43], v[60:63], v[88:91], v[40:43]
  ds_read_b128 v[80:83], v15 offset:4096
  s_waitcnt lgkmcnt(4)
  v_mfma_f32_16x16x32_bf16 v[44:47], v[64:67], v[88:91], v[44:47]
  ds_read_b128 v[84:87], v15 offset:5120
  s_mov_b32 s17, 38912
  buffer_load_dwordx4 v[88:91], v2, s[24:27], s17 offen
  s_waitcnt vmcnt(5) lgkmcnt(4)
  v_mfma_f32_16x16x32_bf16 v[28:31], v[68:71], v[92:95], v[28:31]
  ds_read_b128 v[48:51], v15 offset:6144
  s_waitcnt lgkmcnt(4)
  v_mfma_f32_16x16x32_bf16 v[32:35], v[72:75], v[92:95], v[32:35]
  ds_read_b128 v[52:55], v15 offset:7168
  s_waitcnt lgkmcnt(4)
  v_mfma_f32_16x16x32_bf16 v[36:39], v[76:79], v[92:95], v[36:39]
  ds_read_b128 v[56:59], v15 offset:8192
  s_waitcnt lgkmcnt(4)
  v_mfma_f32_16x16x32_bf16 v[40:43], v[80:83], v[92:95], v[40:43]
  ds_read_b128 v[60:63], v15 offset:9216
  s_waitcnt lgkmcnt(4)
  v_mfma_f32_16x16x32_bf16 v[44:47], v[84:87], v[92:95], v[44:47]
  ds_read_b128 v[64:67], v15 offset:10240
  s_mov_b32 s17, 41984
  buffer_load_dwordx4 v[92:95], v2, s[24:27], s17 offen
  s_waitcnt lgkmcnt(0)
  s_barrier
  s_waitcnt vmcnt(5)
  v_mfma_f32_16x16x32_bf16 v[28:31], v[48:51], v[96:99], v[28:31]
  ds_read_b128 v[68:71], v14 offset:7168
  v_mfma_f32_16x16x32_bf16 v[32:35], v[52:55], v[96:99], v[32:35]
  ds_read_b128 v[72:75], v14 offset:8192
  v_mfma_f32_16x16x32_bf16 v[36:39], v[56:59], v[96:99], v[36:39]
  ds_read_b128 v[76:79], v14 offset:9216
  v_mfma_f32_16x16x32_bf16 v[40:43], v[60:63], v[96:99], v[40:43]
  ds_read_b128 v[80:83], v14 offset:10240
  v_mfma_f32_16x16x32_bf16 v[44:47], v[64:67], v[96:99], v[44:47]
  ds_read_b128 v[84:87], v14 offset:11264
  s_mov_b32 s17, 45056
  buffer_load_dwordx4 v[96:99], v2, s[24:27], s17 offen
  s_waitcnt vmcnt(5) lgkmcnt(4)
  v_mfma_f32_16x16x32_bf16 v[28:31], v[68:71], v[100:103], v[28:31]
  ds_read_b128 v[48:51], v14 offset:12288
  s_waitcnt lgkmcnt(4)
  v_mfma_f32_16x16x32_bf16 v[32:35], v[72:75], v[100:103], v[32:35]
  ds_read_b128 v[52:55], v14 offset:13312
  s_waitcnt lgkmcnt(4)
  v_mfma_f32_16x16x32_bf16 v[36:39], v[76:79], v[100:103], v[36:39]
  ds_read_b128 v[56:59], v14 offset:14336
  s_waitcnt lgkmcnt(4)
  v_mfma_f32_16x16x32_bf16 v[40:43], v[80:83], v[100:103], v[40:43]
  ds_read_b128 v[60:63], v14 offset:15360
  s_waitcnt lgkmcnt(4)
  v_mfma_f32_16x16x32_bf16 v[44:47], v[84:87], v[100:103], v[44:47]
  ds_read_b128 v[64:67], v14 offset:16384
  s_mov_b32 s17, 48128
  buffer_load_dwordx4 v[100:103], v2, s[24:27], s17 offen
  s_waitcnt vmcnt(5) lgkmcnt(4)
  v_mfma_f32_16x16x32_bf16 v[28:31], v[48:51], v[104:107], v[28:31]
  ds_read_b128 v[68:71], v14 offset:17408
  s_waitcnt lgkmcnt(4)
  v_mfma_f32_16x16x32_bf16 v[32:35], v[52:55], v[104:107], v[32:35]
  ds_read_b128 v[72:75], v14 offset:18432
  s_waitcnt lgkmcnt(4)
  v_mfma_f32_16x16x32_bf16 v[36:39], v[56:59], v[104:107], v[36:39]
  ds_read_b128 v[76:79], v14 offset:19456
  s_waitcnt lgkmcnt(4)
  v_mfma_f32_16x16x32_bf16 v[40:43], v[60:63], v[104:107], v[40:43]
  ds_read_b128 v[80:83], v14 offset:20480
  s_waitcnt lgkmcnt(4)
  v_mfma_f32_16x16x32_bf16 v[44:47], v[64:67], v[104:107], v[44:47]
  ds_read_b128 v[84:87], v14 offset:21504
  s_mov_b32 s17, 49152
  buffer_load_dwordx4 v[104:107], v2, s[24:27], s17 offen
  s_waitcnt lgkmcnt(0)
  s_barrier
  s_waitcnt vmcnt(5)
  v_mfma_f32_16x16x32_bf16 v[28:31], v[68:71], v[108:111], v[28:31]
  ds_read_b128 v[48:51], v15 offset:11264
  v_mfma_f32_16x16x32_bf16 v[32:35], v[72:75], v[108:111], v[32:35]
  ds_read_b128 v[52:55], v15 offset:12288
  v_mfma_f32_16x16x32_bf16 v[36:39], v[76:79], v[108:111], v[36:39]
  ds_read_b128 v[56:59], v15 offset:13312
  v_mfma_f32_16x16x32_bf16 v[40:43], v[80:83], v[108:111], v[40:43]
  ds_read_b128 v[60:63], v15 offset:14336
  v_mfma_f32_16x16x32_bf16 v[44:47], v[84:87], v[108:111], v[44:47]
  ds_read_b128 v[64:67], v15 offset:15360
  s_mov_b32 s17, 52224
  buffer_load_dwordx4 v[108:111], v2, s[24:27], s17 offen
  s_waitcnt vmcnt(5) lgkmcnt(4)
  v_mfma_f32_16x16x32_bf16 v[28:31], v[48:51], v[88:91], v[28:31]
  ds_read_b128 v[68:71], v15 offset:16384
  s_waitcnt lgkmcnt(4)
  v_mfma_f32_16x16x32_bf16 v[32:35], v[52:55], v[88:91], v[32:35]
  ds_read_b128 v[72:75], v15 offset:17408
  s_waitcnt lgkmcnt(4)
  v_mfma_f32_16x16x32_bf16 v[36:39], v[56:59], v[88:91], v[36:39]
  ds_read_b128 v[76:79], v15 offset:18432
  s_waitcnt lgkmcnt(4)
  v_mfma_f32_16x16x32_bf16 v[40:43], v[60:63], v[88:91], v[40:43]
  ds_read_b128 v[80:83], v15 offset:19456
  s_waitcnt lgkmcnt(4)
  v_mfma_f32_16x16x32_bf16 v[44:47], v[64:67], v[88:91], v[44:47]
  ds_read_b128 v[84:87], v15 offset:20480
  s_mov_b32 s17, 2048
  buffer_load_dwordx4 v[88:91], v2, s[24:27], s17 offen
  s_waitcnt vmcnt(5) lgkmcnt(4)
  v_mfma_f32_16x16x32_bf16 v[28:31], v[68:71], v[92:95], v[28:31]
  ds_read_b128 v[48:51], v15 offset:21504
  s_waitcnt lgkmcnt(4)
  v_mfma_f32_16x16x32_bf16 v[32:35], v[72:75], v[92:95], v[32:35]
  ds_read_b128 v[52:55], v15 offset:22528
  s_waitcnt lgkmcnt(4)
  v_mfma_f32_16x16x32_bf16 v[36:39], v[76:79], v[92:95], v[36:39]
  ds_read_b128 v[56:59], v15 offset:23552
  s_waitcnt lgkmcnt(4)
  v_mfma_f32_16x16x32_bf16 v[40:43], v[80:83], v[92:95], v[40:43]
  ds_read_b128 v[60:63], v15 offset:24576
  s_waitcnt lgkmcnt(4)
  v_mfma_f32_16x16x32_bf16 v[44:47], v[84:87], v[92:95], v[44:47]
  ds_read_b128 v[64:67], v15 offset:25600
  s_mov_b32 s17, 5120
  buffer_load_dwordx4 v[92:95], v2, s[24:27], s17 offen
  s_waitcnt lgkmcnt(0)
  s_barrier
  s_waitcnt vmcnt(5)
  v_mfma_f32_16x16x32_bf16 v[28:31], v[48:51], v[96:99], v[28:31]
  ds_read_b128 v[68:71], v15 offset:26624
  v_mfma_f32_16x16x32_bf16 v[32:35], v[52:55], v[96:99], v[32:35]
  ds_read_b128 v[72:75], v15 offset:27648
  v_mfma_f32_16x16x32_bf16 v[36:39], v[56:59], v[96:99], v[36:39]
  ds_read_b128 v[76:79], v15 offset:28672
  v_mfma_f32_16x16x32_bf16 v[40:43], v[60:63], v[96:99], v[40:43]
  ds_read_b128 v[80:83], v15 offset:29696
  v_mfma_f32_16x16x32_bf16 v[44:47], v[64:67], v[96:99], v[44:47]
  ds_read_b128 v[84:87], v15 offset:30720
  s_mov_b32 s17, 6144
  buffer_load_dwordx4 v[96:99], v2, s[24:27], s17 offen
  s_waitcnt vmcnt(5) lgkmcnt(4)
  v_mfma_f32_16x16x32_bf16 v[28:31], v[68:71], v[100:103], v[28:31]
  ds_read_b128 v[48:51], v15 offset:31744
  s_waitcnt lgkmcnt(4)
  v_mfma_f32_16x16x32_bf16 v[32:35], v[72:75], v[100:103], v[32:35]
  ds_read_b128 v[52:55], v15 offset:32768
  s_waitcnt lgkmcnt(4)
  v_mfma_f32_16x16x32_bf16 v[36:39], v[76:79], v[100:103], v[36:39]
  ds_read_b128 v[56:59], v15 offset:33792
  s_waitcnt lgkmcnt(4)
  v_mfma_f32_16x16x32_bf16 v[40:43], v[80:83], v[100:103], v[40:43]
  ds_read_b128 v[60:63], v15 offset:34816
  s_waitcnt lgkmcnt(4)
  v_mfma_f32_16x16x32_bf16 v[44:47], v[84:87], v[100:103], v[44:47]
  ds_read_b128 v[64:67], v15 offset:35840
  s_mov_b32 s17, 8192
  buffer_load_dwordx4 v[100:103], v2, s[24:27], s17 offen
  s_waitcnt vmcnt(5) lgkmcnt(4)
  v_mfma_f32_16x16x32_bf16 v[28:31], v[48:51], v[104:107], v[28:31]
  ds_read_b128 v[68:71], v15 offset:36864
  s_waitcnt lgkmcnt(4)
  v_mfma_f32_16x16x32_bf16 v[32:35], v[52:55], v[104:107], v[32:35]
  ds_read_b128 v[72:75], v15 offset:37888
  s_waitcnt lgkmcnt(4)
  v_mfma_f32_16x16x32_bf16 v[36:39], v[56:59], v[104:107], v[36:39]
  ds_read_b128 v[76:79], v15 offset:38912
  s_waitcnt lgkmcnt(4)
  v_mfma_f32_16x16x32_bf16 v[40:43], v[60:63], v[104:107], v[40:43]
  ds_read_b128 v[80:83], v15 offset:39936
  s_waitcnt lgkmcnt(4)
  v_mfma_f32_16x16x32_bf16 v[44:47], v[64:67], v[104:107], v[44:47]
  ds_read_b128 v[84:87], v15 offset:40960
  s_mov_b32 s17, 9216
  buffer_load_dwordx4 v[104:107], v2, s[24:27], s17 offen
  s_waitcnt lgkmcnt(0)
  s_barrier
  s_waitcnt vmcnt(5)
  v_mfma_f32_16x16x32_bf16 v[28:31], v[68:71], v[108:111], v[28:31]
  ds_read_b128 v[48:51], v15 offset:41984
  v_mfma_f32_16x16x32_bf16 v[32:35], v[72:75], v[108:111], v[32:35]
  ds_read_b128 v[52:55], v15 offset:43008
  v_mfma_f32_16x16x32_bf16 v[36:39], v[76:79], v[108:111], v[36:39]
  ds_read_b128 v[56:59], v15 offset:44032
  v_mfma_f32_16x16x32_bf16 v[40:43], v[80:83], v[108:111], v[40:43]
  ds_read_b128 v[60:63], v15 offset:45056
  v_mfma_f32_16x16x32_bf16 v[44:47], v[84:87], v[108:111], v[44:47]
  ds_read_b128 v[64:67], v15 offset:46080
  s_mov_b32 s17, 12288
  buffer_load_dwordx4 v[108:111], v2, s[24:27], s17 offen
  s_waitcnt vmcnt(5) lgkmcnt(4)
  v_mfma_f32_16x16x32_bf16 v[28:31], v[48:51], v[88:91], v[28:31]
  ds_read_b128 v[68:71], v15 offset:47104
  s_waitcnt lgkmcnt(4)
  v_mfma_f32_16x16x32_bf16 v[32:35], v[52:55], v[88:91], v[32:35]
  ds_read_b128 v[72:75], v15 offset:48128
  s_waitcnt lgkmcnt(4)
  v_mfma_f32_16x16x32_bf16 v[36:39], v[56:59], v[88:91], v[36:39]
  ds_read_b128 v[76:79], v15 offset:49152
  s_waitcnt lgkmcnt(4)
  v_mfma_f32_16x16x32_bf16 v[40:43], v[60:63], v[88:91], v[40:43]
  ds_read_b128 v[80:83], v15 offset:50176
  s_waitcnt lgkmcnt(4)
  v_mfma_f32_16x16x32_bf16 v[44:47], v[64:67], v[88:91], v[44:47]
  ds_read_b128 v[84:87], v15 offset:51200
  s_mov_b32 s17, 13312
  buffer_load_dwordx4 v[88:91], v2, s[24:27], s17 offen
  s_waitcnt vmcnt(5) lgkmcnt(4)
  v_mfma_f32_16x16x32_bf16 v[28:31], v[68:71], v[92:95], v[28:31]
  ds_read_b128 v[48:51], v15 offset:52224
  s_waitcnt lgkmcnt(4)
  v_mfma_f32_16x16x32_bf16 v[32:35], v[72:75], v[92:95], v[32:35]
  ds_read_b128 v[52:55], v15 offset:53248
  s_waitcnt lgkmcnt(4)
  v_mfma_f32_16x16x32_bf16 v[36:39], v[76:79], v[92:95], v[36:39]
  ds_read_b128 v[56:59], v15 offset:54272
  s_waitcnt lgkmcnt(4)
  v_mfma_f32_16x16x32_bf16 v[40:43], v[80:83], v[92:95], v[40:43]
  ds_read_b128 v[60:63], v15 offset:55296
  s_waitcnt lgkmcnt(4)
  v_mfma_f32_16x16x32_bf16 v[44:47], v[84:87], v[92:95], v[44:47]
  ds_read_b128 v[64:67], v15 offset:56320
  s_mov_b32 s17, 15360
  buffer_load_dwordx4 v[92:95], v2, s[24:27], s17 offen
  s_waitcnt lgkmcnt(0)
  s_barrier
  s_waitcnt vmcnt(5)
  v_mfma_f32_16x16x32_bf16 v[28:31], v[48:51], v[96:99], v[28:31]
  ds_read_b128 v[68:71], v15 offset:57344
  v_mfma_f32_16x16x32_bf16 v[32:35], v[52:55], v[96:99], v[32:35]
  ds_read_b128 v[72:75], v15 offset:58368
  v_mfma_f32_16x16x32_bf16 v[36:39], v[56:59], v[96:99], v[36:39]
  ds_read_b128 v[76:79], v15 offset:59392
  v_mfma_f32_16x16x32_bf16 v[40:43], v[60:63], v[96:99], v[40:43]
  ds_read_b128 v[80:83], v15 offset:60416
  v_mfma_f32_16x16x32_bf16 v[44:47], v[64:67], v[96:99], v[44:47]
  ds_read_b128 v[84:87], v15 offset:61440
  s_mov_b32 s17, 16384
  buffer_load_dwordx4 v[96:99], v2, s[24:27], s17 offen
  s_waitcnt vmcnt(5) lgkmcnt(4)
  v_mfma_f32_16x16x32_bf16 v[28:31], v[68:71], v[100:103], v[28:31]
  ds_read_b128 v[48:51], v15 offset:62464
  s_waitcnt lgkmcnt(4)
  v_mfma_f32_16x16x32_bf16 v[32:35], v[72:75], v[100:103], v[32:35]
  ds_read_b128 v[52:55], v15 offset:63488
  s_waitcnt lgkmcnt(4)
  v_mfma_f32_16x16x32_bf16 v[36:39], v[76:79], v[100:103], v[36:39]
  ds_read_b128 v[56:59], v15 offset:64512
  s_waitcnt lgkmcnt(4)
  v_mfma_f32_16x16x32_bf16 v[40:43], v[80:83], v[100:103], v[40:43]
  ds_read_b128 v[60:63], v14 offset:0
  s_waitcnt lgkmcnt(4)
  v_mfma_f32_16x16x32_bf16 v[44:47], v[84:87], v[100:103], v[44:47]
  ds_read_b128 v[64:67], v14 offset:1024
  s_mov_b32 s17, 18432
  buffer_load_dwordx4 v[100:103], v2, s[24:27], s17 offen
  s_waitcnt vmcnt(5) lgkmcnt(4)
  v_mfma_f32_16x16x32_bf16 v[28:31], v[48:51], v[104:107], v[28:31]
  ds_read_b128 v[68:71], v14 offset:2048
  s_waitcnt lgkmcnt(4)
  v_mfma_f32_16x16x32_bf16 v[32:35], v[52:55], v[104:107], v[32:35]
  ds_read_b128 v[72:75], v14 offset:3072
  s_waitcnt lgkmcnt(4)
  v_mfma_f32_16x16x32_bf16 v[36:39], v[56:59], v[104:107], v[36:39]
  ds_read_b128 v[76:79], v14 offset:4096
  s_waitcnt lgkmcnt(4)
  v_mfma_f32_16x16x32_bf16 v[40:43], v[60:63], v[104:107], v[40:43]
  ds_read_b128 v[80:83], v14 offset:5120
  s_waitcnt lgkmcnt(4)
  v_mfma_f32_16x16x32_bf16 v[44:47], v[64:67], v[104:107], v[44:47]
  ds_read_b128 v[84:87], v14 offset:6144
  s_mov_b32 s17, 19456
  buffer_load_dwordx4 v[104:107], v2, s[24:27], s17 offen
  s_waitcnt lgkmcnt(0)
  s_barrier
  s_waitcnt vmcnt(5)
  v_mfma_f32_16x16x32_bf16 v[28:31], v[68:71], v[108:111], v[28:31]
  ds_read_b128 v[48:51], v1 offset:0
  v_mfma_f32_16x16x32_bf16 v[32:35], v[72:75], v[108:111], v[32:35]
  ds_read_b128 v[52:55], v1 offset:1024
  v_mfma_f32_16x16x32_bf16 v[36:39], v[76:79], v[108:111], v[36:39]
  ds_read_b128 v[56:59], v1 offset:2048
  v_mfma_f32_16x16x32_bf16 v[40:43], v[80:83], v[108:111], v[40:43]
  ds_read_b128 v[60:63], v1 offset:3072
  v_mfma_f32_16x16x32_bf16 v[44:47], v[84:87], v[108:111], v[44:47]
  ds_read_b128 v[64:67], v1 offset:4096
  s_mov_b32 s17, 22528
  buffer_load_dwordx4 v[108:111], v2, s[24:27], s17 offen
  s_waitcnt vmcnt(5) lgkmcnt(4)
  v_mfma_f32_16x16x32_bf16 v[28:31], v[48:51], v[88:91], v[28:31]
  ds_read_b128 v[68:71], v1 offset:5120
  s_waitcnt lgkmcnt(4)
  v_mfma_f32_16x16x32_bf16 v[32:35], v[52:55], v[88:91], v[32:35]
  ds_read_b128 v[72:75], v1 offset:6144
  s_waitcnt lgkmcnt(4)
  v_mfma_f32_16x16x32_bf16 v[36:39], v[56:59], v[88:91], v[36:39]
  ds_read_b128 v[76:79], v1 offset:7168
  s_waitcnt lgkmcnt(4)
  v_mfma_f32_16x16x32_bf16 v[40:43], v[60:63], v[88:91], v[40:43]
  ds_read_b128 v[80:83], v1 offset:8192
  s_waitcnt lgkmcnt(4)
  v_mfma_f32_16x16x32_bf16 v[44:47], v[64:67], v[88:91], v[44:47]
  ds_read_b128 v[84:87], v1 offset:9216
  s_mov_b32 s17, 23552
  buffer_load_dwordx4 v[88:91], v2, s[24:27], s17 offen
  s_waitcnt vmcnt(5) lgkmcnt(4)
  v_mfma_f32_16x16x32_bf16 v[28:31], v[68:71], v[92:95], v[28:31]
  ds_read_b128 v[48:51], v1 offset:10240
  s_waitcnt lgkmcnt(4)
  v_mfma_f32_16x16x32_bf16 v[32:35], v[72:75], v[92:95], v[32:35]
  ds_read_b128 v[52:55], v1 offset:11264
  s_waitcnt lgkmcnt(4)
  v_mfma_f32_16x16x32_bf16 v[36:39], v[76:79], v[92:95], v[36:39]
  ds_read_b128 v[56:59], v1 offset:12288
  s_waitcnt lgkmcnt(4)
  v_mfma_f32_16x16x32_bf16 v[40:43], v[80:83], v[92:95], v[40:43]
  ds_read_b128 v[60:63], v1 offset:13312
  s_waitcnt lgkmcnt(4)
  v_mfma_f32_16x16x32_bf16 v[44:47], v[84:87], v[92:95], v[44:47]
  ds_read_b128 v[64:67], v1 offset:14336
  s_mov_b32 s17, 25600
  buffer_load_dwordx4 v[92:95], v2, s[24:27], s17 offen
  s_waitcnt lgkmcnt(0)
  s_barrier
  s_waitcnt vmcnt(5)
  v_mfma_f32_16x16x32_bf16 v[28:31], v[48:51], v[96:99], v[28:31]
  ds_read_b128 v[68:71], v1 offset:15360
  v_mfma_f32_16x16x32_bf16 v[32:35], v[52:55], v[96:99], v[32:35]
  ds_read_b128 v[72:75], v1 offset:16384
  v_mfma_f32_16x16x32_bf16 v[36:39], v[56:59], v[96:99], v[36:39]
  ds_read_b128 v[76:79], v1 offset:17408
  v_mfma_f32_16x16x32_bf16 v[40:43], v[60:63], v[96:99], v[40:43]
  ds_read_b128 v[80:83], v1 offset:18432
  v_mfma_f32_16x16x32_bf16 v[44:47], v[64:67], v[96:99], v[44:47]
  ds_read_b128 v[84:87], v1 offset:19456
  s_mov_b32 s17, 26624
  buffer_load_dwordx4 v[96:99], v2, s[24:27], s17 offen
  s_waitcnt vmcnt(5) lgkmcnt(4)
  v_mfma_f32_16x16x32_bf16 v[28:31], v[68:71], v[100:103], v[28:31]
  ds_read_b128 v[48:51], v1 offset:20480
  s_waitcnt lgkmcnt(4)
  v_mfma_f32_16x16x32_bf16 v[32:35], v[72:75], v[100:103], v[32:35]
  ds_read_b128 v[52:55], v1 offset:21504
  s_waitcnt lgkmcnt(4)
  v_mfma_f32_16x16x32_bf16 v[36:39], v[76:79], v[100:103], v[36:39]
  ds_read_b128 v[56:59], v1 offset:22528
  s_waitcnt lgkmcnt(4)
  v_mfma_f32_16x16x32_bf16 v[40:43], v[80:83], v[100:103], v[40:43]
  ds_read_b128 v[60:63], v1 offset:23552
  s_waitcnt lgkmcnt(4)
  v_mfma_f32_16x16x32_bf16 v[44:47], v[84:87], v[100:103], v[44:47]
  ds_read_b128 v[64:67], v1 offset:24576
  s_mov_b32 s17, 29696
  buffer_load_dwordx4 v[100:103], v2, s[24:27], s17 offen
  s_waitcnt vmcnt(5) lgkmcnt(4)
  v_mfma_f32_16x16x32_bf16 v[28:31], v[48:51], v[104:107], v[28:31]
  ds_read_b128 v[68:71], v1 offset:25600
  s_waitcnt lgkmcnt(4)
  v_mfma_f32_16x16x32_bf16 v[32:35], v[52:55], v[104:107], v[32:35]
  ds_read_b128 v[72:75], v1 offset:26624
  s_waitcnt lgkmcnt(4)
  v_mfma_f32_16x16x32_bf16 v[36:39], v[56:59], v[104:107], v[36:39]
  ds_read_b128 v[76:79], v1 offset:27648
  s_waitcnt lgkmcnt(4)
  v_mfma_f32_16x16x32_bf16 v[40:43], v[60:63], v[104:107], v[40:43]
  ds_read_b128 v[80:83], v1 offset:28672
  s_waitcnt lgkmcnt(4)
  v_mfma_f32_16x16x32_bf16 v[44:47], v[64:67], v[104:107], v[44:47]
  ds_read_b128 v[84:87], v1 offset:29696
  s_mov_b32 s17, 32768
  buffer_load_dwordx4 v[104:107], v2, s[24:27], s17 offen
  s_waitcnt lgkmcnt(0)
  s_barrier
  s_waitcnt vmcnt(5)
  v_mfma_f32_16x16x32_bf16 v[28:31], v[68:71], v[108:111], v[28:31]
  ds_read_b128 v[48:51], v1 offset:30720
  v_mfma_f32_16x16x32_bf16 v[32:35], v[72:75], v[108:111], v[32:35]
  ds_read_b128 v[52:55], v1 offset:31744
  v_mfma_f32_16x16x32_bf16 v[36:39], v[76:79], v[108:111], v[36:39]
  ds_read_b128 v[56:59], v1 offset:32768
  v_mfma_f32_16x16x32_bf16 v[40:43], v[80:83], v[108:111], v[40:43]
  ds_read_b128 v[60:63], v1 offset:33792
  v_mfma_f32_16x16x32_bf16 v[44:47], v[84:87], v[108:111], v[44:47]
  ds_read_b128 v[64:67], v1 offset:34816
  s_mov_b32 s17, 33792
  buffer_load_dwordx4 v[108:111], v2, s[24:27], s17 offen
  s_waitcnt vmcnt(5) lgkmcnt(4)
  v_mfma_f32_16x16x32_bf16 v[28:31], v[48:51], v[88:91], v[28:31]
  ds_read_b128 v[68:71], v1 offset:35840
  s_waitcnt lgkmcnt(4)
  v_mfma_f32_16x16x32_bf16 v[32:35], v[52:55], v[88:91], v[32:35]
  ds_read_b128 v[72:75], v1 offset:36864
  s_waitcnt lgkmcnt(4)
  v_mfma_f32_16x16x32_bf16 v[36:39], v[56:59], v[88:91], v[36:39]
  ds_read_b128 v[76:79], v1 offset:37888
  s_waitcnt lgkmcnt(4)
  v_mfma_f32_16x16x32_bf16 v[40:43], v[60:63], v[88:91], v[40:43]
  ds_read_b128 v[80:83], v1 offset:38912
  s_waitcnt lgkmcnt(4)
  v_mfma_f32_16x16x32_bf16 v[44:47], v[64:67], v[88:91], v[44:47]
  ds_read_b128 v[84:87], v1 offset:39936
  s_mov_b32 s17, 35840
  buffer_load_dwordx4 v[88:91], v2, s[24:27], s17 offen
  s_waitcnt vmcnt(5) lgkmcnt(4)
  v_mfma_f32_16x16x32_bf16 v[28:31], v[68:71], v[92:95], v[28:31]
  ds_read_b128 v[48:51], v1 offset:40960
  s_waitcnt lgkmcnt(4)
  v_mfma_f32_16x16x32_bf16 v[32:35], v[72:75], v[92:95], v[32:35]
  ds_read_b128 v[52:55], v1 offset:41984
  s_waitcnt lgkmcnt(4)
  v_mfma_f32_16x16x32_bf16 v[36:39], v[76:79], v[92:95], v[36:39]
  ds_read_b128 v[56:59], v1 offset:43008
  s_waitcnt lgkmcnt(4)
  v_mfma_f32_16x16x32_bf16 v[40:43], v[80:83], v[92:95], v[40:43]
  ds_read_b128 v[60:63], v1 offset:44032
  s_waitcnt lgkmcnt(4)
  v_mfma_f32_16x16x32_bf16 v[44:47], v[84:87], v[92:95], v[44:47]
  ds_read_b128 v[64:67], v1 offset:45056
  s_mov_b32 s17, 36864
  buffer_load_dwordx4 v[92:95], v2, s[24:27], s17 offen
  s_waitcnt lgkmcnt(0)
  s_barrier
  s_waitcnt vmcnt(5)
  v_mfma_f32_16x16x32_bf16 v[28:31], v[48:51], v[96:99], v[28:31]
  ds_read_b128 v[68:71], v1 offset:46080
  v_mfma_f32_16x16x32_bf16 v[32:35], v[52:55], v[96:99], v[32:35]
  ds_read_b128 v[72:75], v1 offset:47104
  v_mfma_f32_16x16x32_bf16 v[36:39], v[56:59], v[96:99], v[36:39]
  ds_read_b128 v[76:79], v1 offset:48128
  v_mfma_f32_16x16x32_bf16 v[40:43], v[60:63], v[96:99], v[40:43]
  ds_read_b128 v[80:83], v1 offset:49152
  v_mfma_f32_16x16x32_bf16 v[44:47], v[64:67], v[96:99], v[44:47]
  ds_read_b128 v[84:87], v1 offset:50176
  s_mov_b32 s17, 39936
  buffer_load_dwordx4 v[96:99], v2, s[24:27], s17 offen
  s_waitcnt vmcnt(5) lgkmcnt(4)
  v_mfma_f32_16x16x32_bf16 v[28:31], v[68:71], v[100:103], v[28:31]
  ds_read_b128 v[48:51], v1 offset:51200
  s_waitcnt lgkmcnt(4)
  v_mfma_f32_16x16x32_bf16 v[32:35], v[72:75], v[100:103], v[32:35]
  ds_read_b128 v[52:55], v1 offset:52224
  s_waitcnt lgkmcnt(4)
  v_mfma_f32_16x16x32_bf16 v[36:39], v[76:79], v[100:103], v[36:39]
  ds_read_b128 v[56:59], v1 offset:53248
  s_waitcnt lgkmcnt(4)
  v_mfma_f32_16x16x32_bf16 v[40:43], v[80:83], v[100:103], v[40:43]
  ds_read_b128 v[60:63], v1 offset:54272
  s_waitcnt lgkmcnt(4)
  v_mfma_f32_16x16x32_bf16 v[44:47], v[84:87], v[100:103], v[44:47]
  ds_read_b128 v[64:67], v1 offset:55296
  s_mov_b32 s17, 40960
  buffer_load_dwordx4 v[100:103], v2, s[24:27], s17 offen
  s_waitcnt vmcnt(5) lgkmcnt(4)
  v_mfma_f32_16x16x32_bf16 v[28:31], v[48:51], v[104:107], v[28:31]
  ds_read_b128 v[68:71], v1 offset:56320
  s_waitcnt lgkmcnt(4)
  v_mfma_f32_16x16x32_bf16 v[32:35], v[52:55], v[104:107], v[32:35]
  ds_read_b128 v[72:75], v1 offset:57344
  s_waitcnt lgkmcnt(4)
  v_mfma_f32_16x16x32_bf16 v[36:39], v[56:59], v[104:107], v[36:39]
  ds_read_b128 v[76:79], v1 offset:58368
  s_waitcnt lgkmcnt(4)
  v_mfma_f32_16x16x32_bf16 v[40:43], v[60:63], v[104:107], v[40:43]
  ds_read_b128 v[80:83], v1 offset:59392
  s_waitcnt lgkmcnt(4)
  v_mfma_f32_16x16x32_bf16 v[44:47], v[64:67], v[104:107], v[44:47]
  ds_read_b128 v[84:87], v1 offset:60416
  s_mov_b32 s17, 43008
  buffer_load_dwordx4 v[104:107], v2, s[24:27], s17 offen
  s_waitcnt lgkmcnt(0)
  s_barrier
  s_waitcnt vmcnt(5)
  v_mfma_f32_16x16x32_bf16 v[28:31], v[68:71], v[108:111], v[28:31]
  ds_read_b128 v[48:51], v1 offset:61440
  v_mfma_f32_16x16x32_bf16 v[32:35], v[72:75], v[108:111], v[32:35]
  ds_read_b128 v[52:55], v1 offset:62464
  v_mfma_f32_16x16x32_bf16 v[36:39], v[76:79], v[108:111], v[36:39]
  ds_read_b128 v[56:59], v1 offset:63488
  v_mfma_f32_16x16x32_bf16 v[40:43], v[80:83], v[108:111], v[40:43]
  ds_read_b128 v[60:63], v1 offset:64512
  v_mfma_f32_16x16x32_bf16 v[44:47], v[84:87], v[108:111], v[44:47]
  ds_read_b128 v[64:67], v15 offset:0
  s_mov_b32 s17, 44032
  buffer_load_dwordx4 v[108:111], v2, s[24:27], s17 offen
  s_waitcnt vmcnt(5) lgkmcnt(4)
  v_mfma_f32_16x16x32_bf16 v[28:31], v[48:51], v[88:91], v[28:31]
  ds_read_b128 v[68:71], v15 offset:1024
  s_waitcnt lgkmcnt(4)
  v_mfma_f32_16x16x32_bf16 v[32:35], v[52:55], v[88:91], v[32:35]
  ds_read_b128 v[72:75], v15 offset:2048
  s_waitcnt lgkmcnt(4)
  v_mfma_f32_16x16x32_bf16 v[36:39], v[56:59], v[88:91], v[36:39]
  ds_read_b128 v[76:79], v15 offset:3072
  s_waitcnt lgkmcnt(4)
  v_mfma_f32_16x16x32_bf16 v[40:43], v[60:63], v[88:91], v[40:43]
  ds_read_b128 v[80:83], v15 offset:4096
  s_waitcnt lgkmcnt(4)
  v_mfma_f32_16x16x32_bf16 v[44:47], v[64:67], v[88:91], v[44:47]
  ds_read_b128 v[84:87], v15 offset:5120
  s_mov_b32 s17, 46080
  buffer_load_dwordx4 v[88:91], v2, s[24:27], s17 offen
  s_waitcnt vmcnt(5) lgkmcnt(4)
  v_mfma_f32_16x16x32_bf16 v[28:31], v[68:71], v[92:95], v[28:31]
  ds_read_b128 v[48:51], v15 offset:6144
  s_waitcnt lgkmcnt(4)
  v_mfma_f32_16x16x32_bf16 v[32:35], v[72:75], v[92:95], v[32:35]
  ds_read_b128 v[52:55], v15 offset:7168
  s_waitcnt lgkmcnt(4)
  v_mfma_f32_16x16x32_bf16 v[36:39], v[76:79], v[92:95], v[36:39]
  ds_read_b128 v[56:59], v15 offset:8192
  s_waitcnt lgkmcnt(4)
  v_mfma_f32_16x16x32_bf16 v[40:43], v[80:83], v[92:95], v[40:43]
  ds_read_b128 v[60:63], v15 offset:9216
  s_waitcnt lgkmcnt(4)
  v_mfma_f32_16x16x32_bf16 v[44:47], v[84:87], v[92:95], v[44:47]
  ds_read_b128 v[64:67], v15 offset:10240
  s_mov_b32 s17, 47104
  buffer_load_dwordx4 v[92:95], v2, s[24:27], s17 offen
  s_waitcnt lgkmcnt(0)
  s_barrier
  s_waitcnt vmcnt(5)
  v_mfma_f32_16x16x32_bf16 v[28:31], v[48:51], v[96:99], v[28:31]
  ds_read_b128 v[68:71], v14 offset:7168
  v_mfma_f32_16x16x32_bf16 v[32:35], v[52:55], v[96:99], v[32:35]
  ds_read_b128 v[72:75], v14 offset:8192
  v_mfma_f32_16x16x32_bf16 v[36:39], v[56:59], v[96:99], v[36:39]
  ds_read_b128 v[76:79], v14 offset:9216
  v_mfma_f32_16x16x32_bf16 v[40:43], v[60:63], v[96:99], v[40:43]
  ds_read_b128 v[80:83], v14 offset:10240
  v_mfma_f32_16x16x32_bf16 v[44:47], v[64:67], v[96:99], v[44:47]
  ds_read_b128 v[84:87], v14 offset:11264
  s_mov_b32 s17, 50176
  buffer_load_dwordx4 v[96:99], v2, s[24:27], s17 offen
  s_waitcnt vmcnt(5) lgkmcnt(4)
  v_mfma_f32_16x16x32_bf16 v[28:31], v[68:71], v[100:103], v[28:31]
  ds_read_b128 v[48:51], v14 offset:12288
  s_waitcnt lgkmcnt(4)
  v_mfma_f32_16x16x32_bf16 v[32:35], v[72:75], v[100:103], v[32:35]
  ds_read_b128 v[52:55], v14 offset:13312
  s_waitcnt lgkmcnt(4)
  v_mfma_f32_16x16x32_bf16 v[36:39], v[76:79], v[100:103], v[36:39]
  ds_read_b128 v[56:59], v14 offset:14336
  s_waitcnt lgkmcnt(4)
  v_mfma_f32_16x16x32_bf16 v[40:43], v[80:83], v[100:103], v[40:43]
  ds_read_b128 v[60:63], v14 offset:15360
  s_waitcnt lgkmcnt(4)
  v_mfma_f32_16x16x32_bf16 v[44:47], v[84:87], v[100:103], v[44:47]
  ds_read_b128 v[64:67], v14 offset:16384
  s_mov_b32 s17, 51200
  buffer_load_dwordx4 v[100:103], v2, s[24:27], s17 offen
  s_waitcnt vmcnt(5) lgkmcnt(4)
  v_mfma_f32_16x16x32_bf16 v[28:31], v[48:51], v[104:107], v[28:31]
  ds_read_b128 v[68:71], v14 offset:17408
  s_waitcnt lgkmcnt(4)
  v_mfma_f32_16x16x32_bf16 v[32:35], v[52:55], v[104:107], v[32:35]
  ds_read_b128 v[72:75], v14 offset:18432
  s_waitcnt lgkmcnt(4)
  v_mfma_f32_16x16x32_bf16 v[36:39], v[56:59], v[104:107], v[36:39]
  ds_read_b128 v[76:79], v14 offset:19456
  s_waitcnt lgkmcnt(4)
  v_mfma_f32_16x16x32_bf16 v[40:43], v[60:63], v[104:107], v[40:43]
  ds_read_b128 v[80:83], v14 offset:20480
  s_waitcnt lgkmcnt(4)
  v_mfma_f32_16x16x32_bf16 v[44:47], v[64:67], v[104:107], v[44:47]
  ds_read_b128 v[84:87], v14 offset:21504
  s_mov_b32 s17, 53248
  buffer_load_dwordx4 v[104:107], v2, s[24:27], s17 offen
  s_waitcnt lgkmcnt(0)
  s_barrier
  s_waitcnt vmcnt(5)
  v_mfma_f32_16x16x32_bf16 v[28:31], v[68:71], v[108:111], v[28:31]
  ds_read_b128 v[48:51], v15 offset:11264
  v_mfma_f32_16x16x32_bf16 v[32:35], v[72:75], v[108:111], v[32:35]
  ds_read_b128 v[52:55], v15 offset:12288
  v_mfma_f32_16x16x32_bf16 v[36:39], v[76:79], v[108:111], v[36:39]
  ds_read_b128 v[56:59], v15 offset:13312
  v_mfma_f32_16x16x32_bf16 v[40:43], v[80:83], v[108:111], v[40:43]
  ds_read_b128 v[60:63], v15 offset:14336
  v_mfma_f32_16x16x32_bf16 v[44:47], v[84:87], v[108:111], v[44:47]
  ds_read_b128 v[64:67], v15 offset:15360
  s_mov_b32 s17, 54272
  buffer_load_dwordx4 v[108:111], v2, s[24:27], s17 offen
  s_waitcnt vmcnt(5) lgkmcnt(4)
  v_mfma_f32_16x16x32_bf16 v[28:31], v[48:51], v[88:91], v[28:31]
  ds_read_b128 v[68:71], v15 offset:16384
  s_waitcnt lgkmcnt(4)
  v_mfma_f32_16x16x32_bf16 v[32:35], v[52:55], v[88:91], v[32:35]
  ds_read_b128 v[72:75], v15 offset:17408
  s_waitcnt lgkmcnt(4)
  v_mfma_f32_16x16x32_bf16 v[36:39], v[56:59], v[88:91], v[36:39]
  ds_read_b128 v[76:79], v15 offset:18432
  s_waitcnt lgkmcnt(4)
  v_mfma_f32_16x16x32_bf16 v[40:43], v[60:63], v[88:91], v[40:43]
  ds_read_b128 v[80:83], v15 offset:19456
  s_waitcnt lgkmcnt(4)
  v_mfma_f32_16x16x32_bf16 v[44:47], v[64:67], v[88:91], v[44:47]
  ds_read_b128 v[84:87], v15 offset:20480
  s_waitcnt vmcnt(4) lgkmcnt(4)
  v_mfma_f32_16x16x32_bf16 v[28:31], v[68:71], v[92:95], v[28:31]
  ds_read_b128 v[48:51], v15 offset:21504
  s_waitcnt lgkmcnt(4)
  v_mfma_f32_16x16x32_bf16 v[32:35], v[72:75], v[92:95], v[32:35]
  ds_read_b128 v[52:55], v15 offset:22528
  s_waitcnt lgkmcnt(4)
  v_mfma_f32_16x16x32_bf16 v[36:39], v[76:79], v[92:95], v[36:39]
  ds_read_b128 v[56:59], v15 offset:23552
  s_waitcnt lgkmcnt(4)
  v_mfma_f32_16x16x32_bf16 v[40:43], v[80:83], v[92:95], v[40:43]
  ds_read_b128 v[60:63], v15 offset:24576
  s_waitcnt lgkmcnt(4)
  v_mfma_f32_16x16x32_bf16 v[44:47], v[84:87], v[92:95], v[44:47]
  ds_read_b128 v[64:67], v15 offset:25600
  s_waitcnt lgkmcnt(0)
  s_barrier
  s_waitcnt vmcnt(3)
  v_mfma_f32_16x16x32_bf16 v[28:31], v[48:51], v[96:99], v[28:31]
  ds_read_b128 v[68:71], v15 offset:26624
  v_mfma_f32_16x16x32_bf16 v[32:35], v[52:55], v[96:99], v[32:35]
  ds_read_b128 v[72:75], v15 offset:27648
  v_mfma_f32_16x16x32_bf16 v[36:39], v[56:59], v[96:99], v[36:39]
  ds_read_b128 v[76:79], v15 offset:28672
  v_mfma_f32_16x16x32_bf16 v[40:43], v[60:63], v[96:99], v[40:43]
  ds_read_b128 v[80:83], v15 offset:29696
  v_mfma_f32_16x16x32_bf16 v[44:47], v[64:67], v[96:99], v[44:47]
  ds_read_b128 v[84:87], v15 offset:30720
  s_waitcnt vmcnt(2) lgkmcnt(4)
  v_mfma_f32_16x16x32_bf16 v[28:31], v[68:71], v[100:103], v[28:31]
  ds_read_b128 v[48:51], v15 offset:31744
  s_waitcnt lgkmcnt(4)
  v_mfma_f32_16x16x32_bf16 v[32:35], v[72:75], v[100:103], v[32:35]
  ds_read_b128 v[52:55], v15 offset:32768
  s_waitcnt lgkmcnt(4)
  v_mfma_f32_16x16x32_bf16 v[36:39], v[76:79], v[100:103], v[36:39]
  ds_read_b128 v[56:59], v15 offset:33792
  s_waitcnt lgkmcnt(4)
  v_mfma_f32_16x16x32_bf16 v[40:43], v[80:83], v[100:103], v[40:43]
  ds_read_b128 v[60:63], v15 offset:34816
  s_waitcnt lgkmcnt(4)
  v_mfma_f32_16x16x32_bf16 v[44:47], v[84:87], v[100:103], v[44:47]
  ds_read_b128 v[64:67], v15 offset:35840
  s_waitcnt vmcnt(1) lgkmcnt(4)
  v_mfma_f32_16x16x32_bf16 v[28:31], v[48:51], v[104:107], v[28:31]
  ds_read_b128 v[68:71], v15 offset:36864
  s_waitcnt lgkmcnt(4)
  v_mfma_f32_16x16x32_bf16 v[32:35], v[52:55], v[104:107], v[32:35]
  ds_read_b128 v[72:75], v15 offset:37888
  s_waitcnt lgkmcnt(4)
  v_mfma_f32_16x16x32_bf16 v[36:39], v[56:59], v[104:107], v[36:39]
  ds_read_b128 v[76:79], v15 offset:38912
  s_waitcnt lgkmcnt(4)
  v_mfma_f32_16x16x32_bf16 v[40:43], v[60:63], v[104:107], v[40:43]
  ds_read_b128 v[80:83], v15 offset:39936
  s_waitcnt lgkmcnt(4)
  v_mfma_f32_16x16x32_bf16 v[44:47], v[64:67], v[104:107], v[44:47]
  ds_read_b128 v[84:87], v15 offset:40960
  s_waitcnt lgkmcnt(0)
  s_barrier
  s_waitcnt vmcnt(0)
  v_mfma_f32_16x16x32_bf16 v[28:31], v[68:71], v[108:111], v[28:31]
  v_mfma_f32_16x16x32_bf16 v[32:35], v[72:75], v[108:111], v[32:35]
  v_mfma_f32_16x16x32_bf16 v[36:39], v[76:79], v[108:111], v[36:39]
  v_mfma_f32_16x16x32_bf16 v[40:43], v[80:83], v[108:111], v[40:43]
  v_mfma_f32_16x16x32_bf16 v[44:47], v[84:87], v[108:111], v[44:47]
  s_nop 3
  v_cvt_pk_bf16_f32 v48, v28, v29
  v_cvt_pk_bf16_f32 v49, v30, v31
  v_lshlrev_b32 v28, 16, v48
  v_and_b32 v29, 0xffff0000, v48
  v_lshlrev_b32 v50, 16, v200
  v_and_b32 v51, 0xffff0000, v200
  v_lshlrev_b32 v30, 16, v49
  v_and_b32 v31, 0xffff0000, v49
  v_lshlrev_b32 v52, 16, v201
  v_and_b32 v53, 0xffff0000, v201
  v_pk_add_f32 v[28:29], v[28:29], v[50:51]
  v_pk_add_f32 v[30:31], v[30:31], v[52:53]
  v_cvt_pk_bf16_f32 v60, v28, v29
  v_cvt_pk_bf16_f32 v61, v30, v31
  buffer_store_dwordx2 v[60:61], v3, s[32:35], 0 offen offset:0
  v_cvt_pk_bf16_f32 v48, v32, v33
  v_cvt_pk_bf16_f32 v49, v34, v35
  v_lshlrev_b32 v32, 16, v48
  v_and_b32 v33, 0xffff0000, v48
  v_lshlrev_b32 v50, 16, v202
  v_and_b32 v51, 0xffff0000, v202
  v_lshlrev_b32 v34, 16, v49
  v_and_b32 v35, 0xffff0000, v49
  v_lshlrev_b32 v52, 16, v203
  v_and_b32 v53, 0xffff0000, v203
  v_pk_add_f32 v[32:33], v[32:33], v[50:51]
  v_pk_add_f32 v[34:35], v[34:35], v[52:53]
  v_cvt_pk_bf16_f32 v62, v32, v33
  v_cvt_pk_bf16_f32 v63, v34, v35
  buffer_store_dwordx2 v[62:63], v3, s[32:35], 0 offen offset:32
  v_cvt_pk_bf16_f32 v48, v36, v37
  v_cvt_pk_bf16_f32 v49, v38, v39
  v_lshlrev_b32 v36, 16, v48
  v_and_b32 v37, 0xffff0000, v48
  v_lshlrev_b32 v50, 16, v204
  v_and_b32 v51, 0xffff0000, v204
  v_lshlrev_b32 v38, 16, v49
  v_and_b32 v39, 0xffff0000, v49
  v_lshlrev_b32 v52, 16, v205
  v_and_b32 v53, 0xffff0000, v205
  v_pk_add_f32 v[36:37], v[36:37], v[50:51]
  v_pk_add_f32 v[38:39], v[38:39], v[52:53]
  v_cvt_pk_bf16_f32 v64, v36, v37
  v_cvt_pk_bf16_f32 v65, v38, v39
  buffer_store_dwordx2 v[64:65], v3, s[32:35], 0 offen offset:64
  v_cvt_pk_bf16_f32 v48, v40, v41
  v_cvt_pk_bf16_f32 v49, v42, v43
  v_lshlrev_b32 v40, 16, v48
  v_and_b32 v41, 0xffff0000, v48
  v_lshlrev_b32 v50, 16, v206
  v_and_b32 v51, 0xffff0000, v206
  v_lshlrev_b32 v42, 16, v49
  v_and_b32 v43, 0xffff0000, v49
  v_lshlrev_b32 v52, 16, v207
  v_and_b32 v53, 0xffff0000, v207
  v_pk_add_f32 v[40:41], v[40:41], v[50:51]
  v_pk_add_f32 v[42:43], v[42:43], v[52:53]
  v_cvt_pk_bf16_f32 v66, v40, v41
  v_cvt_pk_bf16_f32 v67, v42, v43
  buffer_store_dwordx2 v[66:67], v3, s[32:35], 0 offen offset:96
  v_cvt_pk_bf16_f32 v48, v44, v45
  v_cvt_pk_bf16_f32 v49, v46, v47
  v_lshlrev_b32 v44, 16, v48
  v_and_b32 v45, 0xffff0000, v48
  v_lshlrev_b32 v50, 16, v208
  v_and_b32 v51, 0xffff0000, v208
  v_lshlrev_b32 v46, 16, v49
  v_and_b32 v47, 0xffff0000, v49
  v_lshlrev_b32 v52, 16, v209
  v_and_b32 v53, 0xffff0000, v209
  v_pk_add_f32 v[44:45], v[44:45], v[50:51]
  v_pk_add_f32 v[46:47], v[46:47], v[52:53]
  v_cvt_pk_bf16_f32 v68, v44, v45
  v_cvt_pk_bf16_f32 v69, v46, v47
  buffer_store_dwordx2 v[68:69], v3, s[32:35], 0 offen offset:128
  s_endpgm
L_prod_phF_kernel:
  s_sub_u32 s19, s10, 4
  v_lshrrev_b32 v20, 3, v0
  v_mul_u32_u24 v20, 1280, v20
  v_lshrrev_b32 v21, 4, v0
  v_and_b32 v22, 7, v0
  v_xor_b32 v22, v22, v21
  s_mul_i32 s16, s11, 163840
  v_add_u32 v20, s16, v20
  v_lshl_add_u32 v2, v22, 4, v20
  v_xor_b32 v3, 64, v2
  s_lshl_b32 s17, s12, 8
  v_mul_u32_u24 v20, 3840, v21
  v_add_u32 v20, s17, v20
  v_and_b32 v22, 15, v0
  v_lshlrev_b32 v21, 1, v21
  v_xor_b32 v22, v22, v21
  v_lshl_add_u32 v4, v22, 4, v20
  s_waitcnt lgkmcnt(0)
  s_mov_b32 s20, s4
  s_and_b32 s21, s5, 0xffff
  s_mov_b32 s22, 2621440
  s_mov_b32 s23, 0x00020000
  s_mov_b32 s24, s6
  s_and_b32 s25, s7, 0xffff
  s_mov_b32 s26, 2457600
  s_mov_b32 s27, 0x00020000
  s_cmp_eq_u32 s19, 3
  s_cbranch_scc1 L_earlyA_phF_kernel
  s_add_u32 s16, s29, s19
  s_add_u32 s16, s16, 1
  s_and_b32 s16, s16, 3
  s_lshl_b32 s30, s16, 12
  s_mul_i32 s31, s16, 40960
  s_lshl_b32 s16, s15, 1
  s_mul_i32 s17, s19, 5
  s_add_u32 s16, s16, s17
  s_add_u32 s16, s16, 2
  s_add_u32 s17, s16, 0
  s_and_b32 s17, s17, 15
  s_lshl_b32 s32, s17, 10
  s_mul_i32 s38, s17, 15360
  s_lshl_b32 s17, s17, 6
  s_and_b32 s17, s17, 128
  v_xor_b32 v5, s17, v4
  s_add_u32 s17, s16, 1
  s_and_b32 s17, s17, 15
  s_lshl_b32 s33, s17, 10
  s_mul_i32 s39, s17, 15360
  s_lshl_b32 s17, s17, 6
  s_and_b32 s17, s17, 128
  v_xor_b32 v6, s17, v4
  s_add_u32 s17, s16, 2
  s_and_b32 s17, s17, 15
  s_lshl_b32 s34, s17, 10
  s_mul_i32 s40, s17, 15360
  s_lshl_b32 s17, s17, 6
  s_and_b32 s17, s17, 128
  v_xor_b32 v7, s17, v4
  s_add_u32 s17, s16, 3
  s_and_b32 s17, s17, 15
  s_lshl_b32 s35, s17, 10
  s_mul_i32 s41, s17, 15360
  s_lshl_b32 s17, s17, 6
  s_and_b32 s17, s17, 128
  v_xor_b32 v8, s17, v4
  s_add_u32 s17, s16, 4
  s_and_b32 s17, s17, 15
  s_lshl_b32 s36, s17, 10
  s_mul_i32 s42, s17, 15360
  s_lshl_b32 s17, s17, 6
  s_and_b32 s17, s17, 128
  v_xor_b32 v9, s17, v4
  s_add_u32 m0, s30, 0
  s_add_u32 s18, s31, 0
  buffer_load_dwordx4 v2, s[20:23], s18 offen lds
  s_add_u32 m0, s32, 65536
  s_add_u32 s18, s38, 0
  buffer_load_dwordx4 v5, s[24:27], s18 offen lds
  s_add_u32 m0, s30, 1024
  s_add_u32 s18, s31, 10240
  buffer_load_dwordx4 v3, s[20:23], s18 offen lds
  s_add_u32 m0, s33, 65536
  s_add_u32 s18, s39, 0
  buffer_load_dwordx4 v6, s[24:27], s18 offen lds
  s_add_u32 m0, s30, 2048
  s_add_u32 s18, s31, 20480
  buffer_load_dwordx4 v2, s[20:23], s18 offen lds
  s_add_u32 m0, s34, 65536
  s_add_u32 s18, s40, 0
  buffer_load_dwordx4 v7, s[24:27], s18 offen lds
  s_add_u32 m0, s30, 3072
  s_add_u32 s18, s31, 30720
  buffer_load_dwordx4 v3, s[20:23], s18 offen lds
  s_add_u32 m0, s35, 65536
  s_add_u32 s18, s41, 0
  buffer_load_dwordx4 v8, s[24:27], s18 offen lds
  s_cmp_eq_u32 s19, 2
  s_cbranch_scc1 L_skA0_phF_kernel
  s_add_u32 m0, s36, 65536
  s_add_u32 s18, s42, 0
  buffer_load_dwordx4 v9, s[24:27], s18 offen lds
L_skA0_phF_kernel:
  s_waitcnt vmcnt(0)
  s_barrier
  s_add_u32 m0, s30, 16384
  s_add_u32 s18, s31, 128
  buffer_load_dwordx4 v2, s[20:23], s18 offen lds
  s_add_u32 m0, s32, 81920
  s_add_u32 s18, s38, 245760
  buffer_load_dwordx4 v5, s[24:27], s18 offen lds
  s_add_u32 m0, s30, 17408
  s_add_u32 s18, s31, 10368
  buffer_load_dwordx4 v3, s[20:23], s18 offen lds
  s_add_u32 m0, s33, 81920
  s_add_u32 s18, s39, 245760
  buffer_load_dwordx4 v6, s[24:27], s18 offen lds
  s_add_u32 m0, s30, 18432
  s_add_u32 s18, s31, 20608
  buffer_load_dwordx4 v2, s[20:23], s18 offen lds
  s_add_u32 m0, s34, 81920
  s_add_u32 s18, s40, 245760
  buffer_load_dwordx4 v7, s[24:27], s18 offen lds
  s_add_u32 m0, s30, 19456
  s_add_u32 s18, s31, 30848
  buffer_load_dwordx4 v3, s[20:23], s18 offen lds
  s_add_u32 m0, s35, 81920
  s_add_u32 s18, s41, 245760
  buffer_load_dwordx4 v8, s[24:27], s18 offen lds
  s_cmp_eq_u32 s19, 2
  s_cbranch_scc1 L_skA1_phF_kernel
  s_add_u32 m0, s36, 81920
  s_add_u32 s18, s42, 245760
  buffer_load_dwordx4 v9, s[24:27], s18 offen lds
L_skA1_phF_kernel:
  s_add_u32 m0, s30, 32768
  s_add_u32 s18, s31, 256
  buffer_load_dwordx4 v2, s[20:23], s18 offen lds
  s_add_u32 m0, s32, 98304
  s_add_u32 s18, s38, 491520
  buffer_load_dwordx4 v5, s[24:27], s18 offen lds
  s_add_u32 m0, s30, 33792
  s_add_u32 s18, s31, 10496
  buffer_load_dwordx4 v3, s[20:23], s18 offen lds
  s_add_u32 m0, s33, 98304
  s_add_u32 s18, s39, 491520
  buffer_load_dwordx4 v6, s[24:27], s18 offen lds
  s_add_u32 m0, s30, 34816
  s_add_u32 s18, s31, 20736
  buffer_load_dwordx4 v2, s[20:23], s18 offen lds
  s_add_u32 m0, s34, 98304
  s_add_u32 s18, s40, 491520
  buffer_load_dwordx4 v7, s[24:27], s18 offen lds
  s_add_u32 m0, s30, 35840
  s_add_u32 s18, s31, 30976
  buffer_load_dwordx4 v3, s[20:23], s18 offen lds
  s_add_u32 m0, s35, 98304
  s_add_u32 s18, s41, 491520
  buffer_load_dwordx4 v8, s[24:27], s18 offen lds
  s_cmp_eq_u32 s19, 2
  s_cbranch_scc1 L_skA2_phF_kernel
  s_add_u32 m0, s36, 98304
  s_add_u32 s18, s42, 491520
  buffer_load_dwordx4 v9, s[24:27], s18 offen lds
L_skA2_phF_kernel:
  s_waitcnt vmcnt(8)
  s_barrier
  s_add_u32 m0, s30, 49152
  s_add_u32 s18, s31, 384
  buffer_load_dwordx4 v2, s[20:23], s18 offen lds
  s_add_u32 m0, s32, 114688
  s_add_u32 s18, s38, 737280
  buffer_load_dwordx4 v5, s[24:27], s18 offen lds
  s_add_u32 m0, s30, 50176
  s_add_u32 s18, s31, 10624
  buffer_load_dwordx4 v3, s[20:23], s18 offen lds
  s_add_u32 m0, s33, 114688
  s_add_u32 s18, s39, 737280
  buffer_load_dwordx4 v6, s[24:27], s18 offen lds
  s_add_u32 m0, s30, 51200
  s_add_u32 s18, s31, 20864
  buffer_load_dwordx4 v2, s[20:23], s18 offen lds
  s_add_u32 m0, s34, 114688
  s_add_u32 s18, s40, 737280
  buffer_load_dwordx4 v7, s[24:27], s18 offen lds
  s_add_u32 m0, s30, 52224
  s_add_u32 s18, s31, 31104
  buffer_load_dwordx4 v3, s[20:23], s18 offen lds
  s_add_u32 m0, s35, 114688
  s_add_u32 s18, s41, 737280
  buffer_load_dwordx4 v8, s[24:27], s18 offen lds
  s_cmp_eq_u32 s19, 2
  s_cbranch_scc1 L_skA3_phF_kernel
  s_add_u32 m0, s36, 114688
  s_add_u32 s18, s42, 737280
  buffer_load_dwordx4 v9, s[24:27], s18 offen lds
L_skA3_phF_kernel:
  s_waitcnt vmcnt(8)
  s_barrier
  s_add_u32 m0, s30, 0
  s_add_u32 s18, s31, 512
  buffer_load_dwordx4 v2, s[20:23], s18 offen lds
  s_add_u32 m0, s32, 65536
  s_add_u32 s18, s38, 983040
  buffer_load_dwordx4 v5, s[24:27], s18 offen lds
  s_add_u32 m0, s30, 1024
  s_add_u32 s18, s31, 10752
  buffer_load_dwordx4 v3, s[20:23], s18 offen lds
  s_add_u32 m0, s33, 65536
  s_add_u32 s18, s39, 983040
  buffer_load_dwordx4 v6, s[24:27], s18 offen lds
  s_add_u32 m0, s30, 2048
  s_add_u32 s18, s31, 20992
  buffer_load_dwordx4 v2, s[20:23], s18 offen lds
  s_add_u32 m0, s34, 65536
  s_add_u32 s18, s40, 983040
  buffer_load_dwordx4 v7, s[24:27], s18 offen lds
  s_add_u32 m0, s30, 3072
  s_add_u32 s18, s31, 31232
  buffer_load_dwordx4 v3, s[20:23], s18 offen lds
  s_add_u32 m0, s35, 65536
  s_add_u32 s18, s41, 983040
  buffer_load_dwordx4 v8, s[24:27], s18 offen lds
  s_cmp_eq_u32 s19, 2
  s_cbranch_scc1 L_skA4_phF_kernel
  s_add_u32 m0, s36, 65536
  s_add_u32 s18, s42, 983040
  buffer_load_dwordx4 v9, s[24:27], s18 offen lds
L_skA4_phF_kernel:
  s_waitcnt vmcnt(8)
  s_barrier
  s_add_u32 m0, s30, 16384
  s_add_u32 s18, s31, 640
  buffer_load_dwordx4 v2, s[20:23], s18 offen lds
  s_add_u32 m0, s32, 81920
  s_add_u32 s18, s38, 1228800
  buffer_load_dwordx4 v5, s[24:27], s18 offen lds
  s_add_u32 m0, s30, 17408
  s_add_u32 s18, s31, 10880
  buffer_load_dwordx4 v3, s[20:23], s18 offen lds
  s_add_u32 m0, s33, 81920
  s_add_u32 s18, s39, 1228800
  buffer_load_dwordx4 v6, s[24:27], s18 offen lds
  s_add_u32 m0, s30, 18432
  s_add_u32 s18, s31, 21120
  buffer_load_dwordx4 v2, s[20:23], s18 offen lds
  s_add_u32 m0, s34, 81920
  s_add_u32 s18, s40, 1228800
  buffer_load_dwordx4 v7, s[24:27], s18 offen lds
  s_add_u32 m0, s30, 19456
  s_add_u32 s18, s31, 31360
  buffer_load_dwordx4 v3, s[20:23], s18 offen lds
  s_add_u32 m0, s35, 81920
  s_add_u32 s18, s41, 1228800
  buffer_load_dwordx4 v8, s[24:27], s18 offen lds
  s_cmp_eq_u32 s19, 2
  s_cbranch_scc1 L_skA5_phF_kernel
  s_add_u32 m0, s36, 81920
  s_add_u32 s18, s42, 1228800
  buffer_load_dwordx4 v9, s[24:27], s18 offen lds
L_skA5_phF_kernel:
  s_waitcnt vmcnt(8)
  s_barrier
  s_add_u32 m0, s30, 32768
  s_add_u32 s18, s31, 768
  buffer_load_dwordx4 v2, s[20:23], s18 offen lds
  s_add_u32 m0, s32, 98304
  s_add_u32 s18, s38, 1474560
  buffer_load_dwordx4 v5, s[24:27], s18 offen lds
  s_add_u32 m0, s30, 33792
  s_add_u32 s18, s31, 11008
  buffer_load_dwordx4 v3, s[20:23], s18 offen lds
  s_add_u32 m0, s33, 98304
  s_add_u32 s18, s39, 1474560
  buffer_load_dwordx4 v6, s[24:27], s18 offen lds
  s_add_u32 m0, s30, 34816
  s_add_u32 s18, s31, 21248
  buffer_load_dwordx4 v2, s[20:23], s18 offen lds
  s_add_u32 m0, s34, 98304
  s_add_u32 s18, s40, 1474560
  buffer_load_dwordx4 v7, s[24:27], s18 offen lds
  s_add_u32 m0, s30, 35840
  s_add_u32 s18, s31, 31488
  buffer_load_dwordx4 v3, s[20:23], s18 offen lds
  s_add_u32 m0, s35, 98304
  s_add_u32 s18, s41, 1474560
  buffer_load_dwordx4 v8, s[24:27], s18 offen lds
  s_cmp_eq_u32 s19, 2
  s_cbranch_scc1 L_skA6_phF_kernel
  s_add_u32 m0, s36, 98304
  s_add_u32 s18, s42, 1474560
  buffer_load_dwordx4 v9, s[24:27], s18 offen lds
L_skA6_phF_kernel:
  s_waitcnt vmcnt(8)
  s_barrier
  s_add_u32 m0, s30, 49152
  s_add_u32 s18, s31, 896
  buffer_load_dwordx4 v2, s[20:23], s18 offen lds
  s_add_u32 m0, s32, 114688
  s_add_u32 s18, s38, 1720320
  buffer_load_dwordx4 v5, s[24:27], s18 offen lds
  s_add_u32 m0, s30, 50176
  s_add_u32 s18, s31, 11136
  buffer_load_dwordx4 v3, s[20:23], s18 offen lds
  s_add_u32 m0, s33, 114688
  s_add_u32 s18, s39, 1720320
  buffer_load_dwordx4 v6, s[24:27], s18 offen lds
  s_add_u32 m0, s30, 51200
  s_add_u32 s18, s31, 21376
  buffer_load_dwordx4 v2, s[20:23], s18 offen lds
  s_add_u32 m0, s34, 114688
  s_add_u32 s18, s40, 1720320
  buffer_load_dwordx4 v7, s[24:27], s18 offen lds
  s_add_u32 m0, s30, 52224
  s_add_u32 s18, s31, 31616
  buffer_load_dwordx4 v3, s[20:23], s18 offen lds
  s_add_u32 m0, s35, 114688
  s_add_u32 s18, s41, 1720320
  buffer_load_dwordx4 v8, s[24:27], s18 offen lds
  s_cmp_eq_u32 s19, 2
  s_cbranch_scc1 L_skA7_phF_kernel
  s_add_u32 m0, s36, 114688
  s_add_u32 s18, s42, 1720320
  buffer_load_dwordx4 v9, s[24:27], s18 offen lds
L_skA7_phF_kernel:
  s_waitcnt vmcnt(8)
  s_barrier
  s_add_u32 m0, s30, 0
  s_add_u32 s18, s31, 1024
  buffer_load_dwordx4 v2, s[20:23], s18 offen lds
  s_add_u32 m0, s32, 65536
  s_add_u32 s18, s38, 1966080
  buffer_load_dwordx4 v5, s[24:27], s18 offen lds
  s_add_u32 m0, s30, 1024
  s_add_u32 s18, s31, 11264
  buffer_load_dwordx4 v3, s[20:23], s18 offen lds
  s_add_u32 m0, s33, 65536
  s_add_u32 s18, s39, 1966080
  buffer_load_dwordx4 v6, s[24:27], s18 offen lds
  s_add_u32 m0, s30, 2048
  s_add_u32 s18, s31, 21504
  buffer_load_dwordx4 v2, s[20:23], s18 offen lds
  s_add_u32 m0, s34, 65536
  s_add_u32 s18, s40, 1966080
  buffer_load_dwordx4 v7, s[24:27], s18 offen lds
  s_add_u32 m0, s30, 3072
  s_add_u32 s18, s31, 31744
  buffer_load_dwordx4 v3, s[20:23], s18 offen lds
  s_add_u32 m0, s35, 65536
  s_add_u32 s18, s41, 1966080
  buffer_load_dwordx4 v8, s[24:27], s18 offen lds
  s_cmp_eq_u32 s19, 2
  s_cbranch_scc1 L_skA8_phF_kernel
  s_add_u32 m0, s36, 65536
  s_add_u32 s18, s42, 1966080
  buffer_load_dwordx4 v9, s[24:27], s18 offen lds
L_skA8_phF_kernel:
  s_waitcnt vmcnt(8)
  s_barrier
  s_add_u32 m0, s30, 16384
  s_add_u32 s18, s31, 1152
  buffer_load_dwordx4 v2, s[20:23], s18 offen lds
  s_add_u32 m0, s32, 81920
  s_add_u32 s18, s38, 2211840
  buffer_load_dwordx4 v5, s[24:27], s18 offen lds
  s_add_u32 m0, s30, 17408
  s_add_u32 s18, s31, 11392
  buffer_load_dwordx4 v3, s[20:23], s18 offen lds
  s_add_u32 m0, s33, 81920
  s_add_u32 s18, s39, 2211840
  buffer_load_dwordx4 v6, s[24:27], s18 offen lds
  s_add_u32 m0, s30, 18432
  s_add_u32 s18, s31, 21632
  buffer_load_dwordx4 v2, s[20:23], s18 offen lds
  s_add_u32 m0, s34, 81920
  s_add_u32 s18, s40, 2211840
  buffer_load_dwordx4 v7, s[24:27], s18 offen lds
  s_add_u32 m0, s30, 19456
  s_add_u32 s18, s31, 31872
  buffer_load_dwordx4 v3, s[20:23], s18 offen lds
  s_add_u32 m0, s35, 81920
  s_add_u32 s18, s41, 2211840
  buffer_load_dwordx4 v8, s[24:27], s18 offen lds
  s_cmp_eq_u32 s19, 2
  s_cbranch_scc1 L_skA9_phF_kernel
  s_add_u32 m0, s36, 81920
  s_add_u32 s18, s42, 2211840
  buffer_load_dwordx4 v9, s[24:27], s18 offen lds
L_skA9_phF_kernel:
  s_waitcnt vmcnt(8)
  s_barrier
  s_waitcnt vmcnt(0)
  s_barrier
  s_barrier
  s_barrier
  s_branch L_help_phF_kernel
L_earlyA_phF_kernel:
  s_lshl_b32 s30, s29, 12
  s_mul_i32 s31, s29, 40960
  s_lshl_b32 s32, s15, 11
  s_mul_i32 s33, s15, 30720
  s_and_b32 s17, s15, 1
  s_lshl_b32 s17, s17, 7
  v_xor_b32 v5, s17, v4
  s_add_u32 m0, s30, 0
  s_add_u32 s18, s31, 0
  buffer_load_dwordx4 v2, s[20:23], s18 offen lds
  s_add_u32 m0, s32, 65536
  s_add_u32 s18, s33, 0
  buffer_load_dwordx4 v5, s[24:27], s18 offen lds
  s_add_u32 m0, s30, 1024
  s_add_u32 s18, s31, 10240
  buffer_load_dwordx4 v3, s[20:23], s18 offen lds
  s_add_u32 m0, s32, 66560
  s_add_u32 s18, s33, 15360
  buffer_load_dwordx4 v5, s[24:27], s18 offen lds
  s_add_u32 m0, s30, 2048
  s_add_u32 s18, s31, 20480
  buffer_load_dwordx4 v2, s[20:23], s18 offen lds
  s_add_u32 m0, s30, 3072
  s_add_u32 s18, s31, 30720
  buffer_load_dwordx4 v3, s[20:23], s18 offen lds
  s_add_u32 m0, s30, 16384
  s_add_u32 s18, s31, 128
  buffer_load_dwordx4 v2, s[20:23], s18 offen lds
  s_add_u32 m0, s32, 81920
  s_add_u32 s18, s33, 245760
  buffer_load_dwordx4 v5, s[24:27], s18 offen lds
  s_add_u32 m0, s30, 17408
  s_add_u32 s18, s31, 10368
  buffer_load_dwordx4 v3, s[20:23], s18 offen lds
  s_add_u32 m0, s32, 82944
  s_add_u32 s18, s33, 261120
  buffer_load_dwordx4 v5, s[24:27], s18 offen lds
  s_add_u32 m0, s30, 18432
  s_add_u32 s18, s31, 20608
  buffer_load_dwordx4 v2, s[20:23], s18 offen lds
  s_add_u32 m0, s30, 19456
  s_add_u32 s18, s31, 30848
  buffer_load_dwordx4 v3, s[20:23], s18 offen lds
  s_add_u32 m0, s30, 32768
  s_add_u32 s18, s31, 256
  buffer_load_dwordx4 v2, s[20:23], s18 offen lds
  s_add_u32 m0, s32, 98304
  s_add_u32 s18, s33, 491520
  buffer_load_dwordx4 v5, s[24:27], s18 offen lds
  s_add_u32 m0, s30, 33792
  s_add_u32 s18, s31, 10496
  buffer_load_dwordx4 v3, s[20:23], s18 offen lds
  s_add_u32 m0, s32, 99328
  s_add_u32 s18, s33, 506880
  buffer_load_dwordx4 v5, s[24:27], s18 offen lds
  s_add_u32 m0, s30, 34816
  s_add_u32 s18, s31, 20736
  buffer_load_dwordx4 v2, s[20:23], s18 offen lds
  s_add_u32 m0, s30, 35840
  s_add_u32 s18, s31, 30976
  buffer_load_dwordx4 v3, s[20:23], s18 offen lds
  s_add_u32 m0, s30, 49152
  s_add_u32 s18, s31, 384
  buffer_load_dwordx4 v2, s[20:23], s18 offen lds
  s_add_u32 m0, s32, 114688
  s_add_u32 s18, s33, 737280
  buffer_load_dwordx4 v5, s[24:27], s18 offen lds
  s_add_u32 m0, s30, 50176
  s_add_u32 s18, s31, 10624
  buffer_load_dwordx4 v3, s[20:23], s18 offen lds
  s_add_u32 m0, s32, 115712
  s_add_u32 s18, s33, 752640
  buffer_load_dwordx4 v5, s[24:27], s18 offen lds
  s_add_u32 m0, s30, 51200
  s_add_u32 s18, s31, 20864
  buffer_load_dwordx4 v2, s[20:23], s18 offen lds
  s_add_u32 m0, s30, 52224
  s_add_u32 s18, s31, 31104
  buffer_load_dwordx4 v3, s[20:23], s18 offen lds
  s_add_u32 s56, s8, 34603008
  s_addc_u32 s57, s9, 0
  s_and_b32 s57, s57, 0xffff
  s_mov_b32 s58, 1769472
  s_mov_b32 s59, 0x00020000
  s_and_b32 s60, s2, 7
  s_lshr_b32 s61, s2, 3
  v_mov_b32 v30, 0x40000000
  v_mov_b32 v32, 0
  v_and_b32 v31, 15, v0
  v_mul_u32_u24 v31, 2048, v31
  s_and_b32 s62, s60, 1
  s_lshl_b32 s62, s62, 3
  s_and_b32 s63, s61, 7
  s_add_u32 s62, s62, s63
  s_lshr_b32 s63, s60, 1
  s_lshl_b32 s63, s63, 2
  s_lshr_b32 s52, s61, 3
  s_add_u32 s63, s63, s52
  s_mul_i32 s52, s62, 2048
  s_mul_i32 s53, s63, 128
  s_add_u32 s52, s52, s53
  s_add_u32 s53, s52, 131072
  s_mov_b64 exec, 1
  v_mov_b32 v30, s53
  s_add_u32 s53, s52, 32768
  s_mov_b64 exec, 2
  v_mov_b32 v30, s53
  s_add_u32 s53, s52, 196608
  s_mov_b64 exec, 16
  v_mov_b32 v30, s53
  s_add_u32 s53, s52, 196612
  s_mov_b64 exec, 32
  v_mov_b32 v30, s53
  s_add_u32 s53, s52, 196616
  s_mov_b64 exec, 64
  v_mov_b32 v30, s53
  s_add_u32 s53, s52, 196620
  s_mov_b64 exec, 128
  v_mov_b32 v30, s53
  s_mul_i32 s52, s62, 128
  s_add_u32 s52, s52, 163840
  s_cmp_eq_u32 s63, 15
  s_cselect_b32 exec_lo, 0xffff0000, 0
  s_mov_b32 exec_hi, 0
  v_add_u32 v30, s52, v31
  s_lshr_b32 s52, s61, 4
  s_lshl_b32 s53, s60, 1
  s_add_u32 s52, s52, s53
  s_mul_i32 s52, s52, 128
  s_and_b32 s53, s61, 15
  s_mul_i32 s53, s53, 2048
  s_add_u32 s52, s52, s53
  s_add_u32 s52, s52, 65536
  s_mov_b64 exec, 4
  v_mov_b32 v30, s52
  s_and_b32 s62, s60, 3
  s_lshl_b32 s62, s62, 3
  s_and_b32 s63, s61, 7
  s_add_u32 s62, s62, s63
  s_lshr_b32 s63, s60, 2
  s_lshl_b32 s63, s63, 2
  s_lshr_b32 s52, s61, 3
  s_add_u32 s63, s63, s52
  s_and_b32 s52, s62, 1
  s_lshl_b32 s52, s52, 3
  s_add_u32 s52, s52, s63
  s_mul_i32 s52, s52, 128
  s_lshr_b32 s53, s62, 1
  s_mul_i32 s53, s53, 2048
  s_add_u32 s52, s52, s53
  s_mov_b64 exec, 8
  v_mov_b32 v30, s52
  s_lshr_b32 s53, s62, 1
  s_mul_i32 s53, s53, 128
  s_add_u32 s53, s53, 98304
  s_and_b32 s52, s62, 1
  s_or_b32 s52, s52, s63
  s_cmp_eq_u32 s52, 0
  s_cselect_b32 exec_hi, 0xffff, 0
  s_mov_b32 exec_lo, 0
  v_add_u32 v30, s53, v31
  s_mov_b64 exec, -1
  buffer_store_dword v32, v30, s[56:59], 0 offen sc1
  s_waitcnt vmcnt(19)
  s_barrier
  s_waitcnt vmcnt(13)
  s_barrier
  s_add_u32 m0, s30, 0
  s_add_u32 s18, s31, 512
  buffer_load_dwordx4 v2, s[20:23], s18 offen lds
  s_add_u32 m0, s32, 65536
  s_add_u32 s18, s33, 983040
  buffer_load_dwordx4 v5, s[24:27], s18 offen lds
  s_add_u32 m0, s30, 1024
  s_add_u32 s18, s31, 10752
  buffer_load_dwordx4 v3, s[20:23], s18 offen lds
  s_add_u32 m0, s32, 66560
  s_add_u32 s18, s33, 998400
  buffer_load_dwordx4 v5, s[24:27], s18 offen lds
  s_add_u32 m0, s30, 2048
  s_add_u32 s18, s31, 20992
  buffer_load_dwordx4 v2, s[20:23], s18 offen lds
  s_add_u32 m0, s30, 3072
  s_add_u32 s18, s31, 31232
  buffer_load_dwordx4 v3, s[20:23], s18 offen lds
  s_waitcnt vmcnt(13)
  s_barrier
  s_add_u32 m0, s30, 16384
  s_add_u32 s18, s31, 640
  buffer_load_dwordx4 v2, s[20:23], s18 offen lds
  s_add_u32 m0, s32, 81920
  s_add_u32 s18, s33, 1228800
  buffer_load_dwordx4 v5, s[24:27], s18 offen lds
  s_add_u32 m0, s30, 17408
  s_add_u32 s18, s31, 10880
  buffer_load_dwordx4 v3, s[20:23], s18 offen lds
  s_add_u32 m0, s32, 82944
  s_add_u32 s18, s33, 1244160
  buffer_load_dwordx4 v5, s[24:27], s18 offen lds
  s_add_u32 m0, s30, 18432
  s_add_u32 s18, s31, 21120
  buffer_load_dwordx4 v2, s[20:23], s18 offen lds
  s_add_u32 m0, s30, 19456
  s_add_u32 s18, s31, 31360
  buffer_load_dwordx4 v3, s[20:23], s18 offen lds
  s_waitcnt vmcnt(13)
  s_barrier
  s_add_u32 m0, s30, 32768
  s_add_u32 s18, s31, 768
  buffer_load_dwordx4 v2, s[20:23], s18 offen lds
  s_add_u32 m0, s32, 98304
  s_add_u32 s18, s33, 1474560
  buffer_load_dwordx4 v5, s[24:27], s18 offen lds
  s_add_u32 m0, s30, 33792
  s_add_u32 s18, s31, 11008
  buffer_load_dwordx4 v3, s[20:23], s18 offen lds
  s_add_u32 m0, s32, 99328
  s_add_u32 s18, s33, 1489920
  buffer_load_dwordx4 v5, s[24:27], s18 offen lds
  s_add_u32 m0, s30, 34816
  s_add_u32 s18, s31, 21248
  buffer_load_dwordx4 v2, s[20:23], s18 offen lds
  s_add_u32 m0, s30, 35840
  s_add_u32 s18, s31, 31488
  buffer_load_dwordx4 v3, s[20:23], s18 offen lds
  s_waitcnt vmcnt(12)
  s_barrier
  s_add_u32 m0, s30, 49152
  s_add_u32 s18, s31, 896
  buffer_load_dwordx4 v2, s[20:23], s18 offen lds
  s_add_u32 m0, s32, 114688
  s_add_u32 s18, s33, 1720320
  buffer_load_dwordx4 v5, s[24:27], s18 offen lds
  s_add_u32 m0, s30, 50176
  s_add_u32 s18, s31, 11136
  buffer_load_dwordx4 v3, s[20:23], s18 offen lds
  s_add_u32 m0, s32, 115712
  s_add_u32 s18, s33, 1735680
  buffer_load_dwordx4 v5, s[24:27], s18 offen lds
  s_add_u32 m0, s30, 51200
  s_add_u32 s18, s31, 21376
  buffer_load_dwordx4 v2, s[20:23], s18 offen lds
  s_add_u32 m0, s30, 52224
  s_add_u32 s18, s31, 31616
  buffer_load_dwordx4 v3, s[20:23], s18 offen lds
  s_waitcnt vmcnt(12)
  s_barrier
  s_add_u32 m0, s30, 0
  s_add_u32 s18, s31, 1024
  buffer_load_dwordx4 v2, s[20:23], s18 offen lds
  s_add_u32 m0, s32, 65536
  s_add_u32 s18, s33, 1966080
  buffer_load_dwordx4 v5, s[24:27], s18 offen lds
  s_add_u32 m0, s30, 1024
  s_add_u32 s18, s31, 11264
  buffer_load_dwordx4 v3, s[20:23], s18 offen lds
  s_add_u32 m0, s32, 66560
  s_add_u32 s18, s33, 1981440
  buffer_load_dwordx4 v5, s[24:27], s18 offen lds
  s_add_u32 m0, s30, 2048
  s_add_u32 s18, s31, 21504
  buffer_load_dwordx4 v2, s[20:23], s18 offen lds
  s_add_u32 m0, s30, 3072
  s_add_u32 s18, s31, 31744
  buffer_load_dwordx4 v3, s[20:23], s18 offen lds
  s_waitcnt vmcnt(12)
  s_barrier
  s_add_u32 m0, s30, 16384
  s_add_u32 s18, s31, 1152
  buffer_load_dwordx4 v2, s[20:23], s18 offen lds
  s_add_u32 m0, s32, 81920
  s_add_u32 s18, s33, 2211840
  buffer_load_dwordx4 v5, s[24:27], s18 offen lds
  s_add_u32 m0, s30, 17408
  s_add_u32 s18, s31, 11392
  buffer_load_dwordx4 v3, s[20:23], s18 offen lds
  s_add_u32 m0, s32, 82944
  s_add_u32 s18, s33, 2227200
  buffer_load_dwordx4 v5, s[24:27], s18 offen lds
  s_add_u32 m0, s30, 18432
  s_add_u32 s18, s31, 21632
  buffer_load_dwordx4 v2, s[20:23], s18 offen lds
  s_add_u32 m0, s30, 19456
  s_add_u32 s18, s31, 31872
  buffer_load_dwordx4 v3, s[20:23], s18 offen lds
  s_waitcnt vmcnt(12)
  s_barrier
  s_waitcnt vmcnt(6)
  s_barrier
  s_waitcnt vmcnt(0)
  s_barrier
  s_barrier
  s_barrier
  s_branch L_help_phF_kernel
L_idle_phF_kernel:
L_noz_phF_kernel:
  s_cmp_eq_u32 s10, 7
  s_cbranch_scc1 L_xpf_phF_kernel
  s_waitcnt lgkmcnt(0)
  s_sub_u32 s11, s14, 24
  s_lshl_b32 s11, s11, 1
  s_and_b32 s12, s13, 1
  s_add_u32 s11, s11, s12
  s_mul_i32 s11, s11, 7
  s_add_u32 s11, s11, s10
  s_add_u32 s11, s11, 540
  s_lshl_b32 s12, s10, 13
  s_add_u32 s12, s12, 65536
  s_cmp_ge_u32 s11, 640
  s_cbranch_scc1 L_rnone_phF_kernelw
  s_cmp_ge_u32 s11, 270
  s_cbranch_scc1 L_rdo_phF_kernelw
  s_cmp_ge_u32 s11, 135
  s_cselect_b32 s13, 1, 0
  s_mul_i32 s14, s13, 135
  s_sub_u32 s14, s11, s14
  s_mul_i32 s15, s14, 52429
  s_lshr_b32 s15, s15, 18
  s_mul_i32 s16, s15, 5
  s_sub_u32 s16, s14, s16
  s_lshl_b32 s17, s13, 3
  s_add_u32 s17, s17, 32
  s_load_dwordx2 s[4:5], s[0:1], s17
  v_lshrrev_b32 v3, 3, v0
  v_and_b32 v4, 2, v3
  v_and_b32 v5, 7, v0
  v_xor_b32 v4, v4, v5
  v_mul_u32_u24 v3, 3456, v3
  v_lshl_add_u32 v1, v4, 4, v3
  s_lshl_b32 s18, s15, 7
  v_add_u32 v1, s18, v1
  v_xor_b32 v2, 64, v1
  s_waitcnt lgkmcnt(0)
  s_mov_b32 s20, s4
  s_and_b32 s21, s5, 0xffff
  s_mov_b32 s22, 2211840
  s_mov_b32 s23, 0x00020000
  s_mul_i32 s19, s16, 442368
  s_add_u32 m0, s12, 0
  s_add_u32 s18, s19, 0
  buffer_load_dwordx4 v1, s[20:23], s18 offen nt lds
  s_add_u32 m0, s12, 1024
  s_add_u32 s18, s19, 27648
  buffer_load_dwordx4 v2, s[20:23], s18 offen nt lds
  s_add_u32 m0, s12, 2048
  s_add_u32 s18, s19, 55296
  buffer_load_dwordx4 v1, s[20:23], s18 offen nt lds
  s_add_u32 m0, s12, 3072
  s_add_u32 s18, s19, 82944
  buffer_load_dwordx4 v2, s[20:23], s18 offen nt lds
  s_add_u32 m0, s12, 4096
  s_add_u32 s18, s19, 110592
  buffer_load_dwordx4 v1, s[20:23], s18 offen nt lds
  s_add_u32 m0, s12, 5120
  s_add_u32 s18, s19, 138240
  buffer_load_dwordx4 v2, s[20:23], s18 offen nt lds
  s_add_u32 m0, s12, 6144
  s_add_u32 s18, s19, 165888
  buffer_load_dwordx4 v1, s[20:23], s18 offen nt lds
  s_add_u32 m0, s12, 7168
  s_add_u32 s18, s19, 193536
  buffer_load_dwordx4 v2, s[20:23], s18 offen nt lds
  s_add_u32 m0, s12, 8192
  s_add_u32 s18, s19, 221184
  buffer_load_dwordx4 v1, s[20:23], s18 offen nt lds
  s_add_u32 m0, s12, 9216
  s_add_u32 s18, s19, 248832
  buffer_load_dwordx4 v2, s[20:23], s18 offen nt lds
  s_add_u32 m0, s12, 10240
  s_add_u32 s18, s19, 276480
  buffer_load_dwordx4 v1, s[20:23], s18 offen nt lds
  s_add_u32 m0, s12, 11264
  s_add_u32 s18, s19, 304128
  buffer_load_dwordx4 v2, s[20:23], s18 offen nt lds
  s_add_u32 m0, s12, 12288
  s_add_u32 s18, s19, 331776
  buffer_load_dwordx4 v1, s[20:23], s18 offen nt lds
  s_add_u32 m0, s12, 13312
  s_add_u32 s18, s19, 359424
  buffer_load_dwordx4 v2, s[20:23], s18 offen nt lds
  s_add_u32 m0, s12, 14336
  s_add_u32 s18, s19, 387072
  buffer_load_dwordx4 v1, s[20:23], s18 offen nt lds
  s_add_u32 m0, s12, 15360
  s_add_u32 s18, s19, 414720
  buffer_load_dwordx4 v2, s[20:23], s18 offen nt lds
  v_lshrrev_b32 v7, 4, v0
  v_lshrrev_b32 v8, 2, v0
  v_and_b32 v8, 3, v8
  v_and_b32 v9, 3, v0
  v_lshl_add_u32 v10, v7, 3, v8
  v_lshlrev_b32 v10, 7, v10
  v_and_b32 v11, 1, v7
  v_lshlrev_b32 v11, 2, v11
  v_and_b32 v12, 2, v8
  v_or_b32 v11, v11, v12
  v_lshrrev_b32 v12, 1, v9
  v_xor_b32 v11, v11, v12
  v_lshl_add_u32 v10, v11, 4, v10
  v_and_b32 v12, 1, v9
  v_lshl_add_u32 v10, v12, 3, v10
  v_add_u32 v3, s12, v10
  v_xor_b32 v4, 32, v3
  v_xor_b32 v5, 64, v3
  v_xor_b32 v6, 96, v3
  v_lshrrev_b32 v8, 1, v7
  v_lshlrev_b32 v8, 10, v8
  v_and_b32 v9, 1, v7
  v_lshl_add_u32 v8, v9, 8, v8
  v_and_b32 v9, 15, v0
  v_lshl_add_u32 v8, v9, 4, v8
  v_lshlrev_b32 v10, 4, v7
  v_mov_b32 v11, 0x40000000
  v_cmp_eq_u32 vcc, 0, v9
  s_nop 1
  v_cndmask_b32 v10, v11, v10, vcc
  v_mov_b32 v7, v8
  v_mov_b32 v8, v10
  s_add_u32 s24, s8, 25165824
  s_addc_u32 s25, s9, 0
  s_and_b32 s25, s25, 0xffff
  s_mov_b32 s26, 4423680
  s_mov_b32 s27, 0x00020000
  s_add_u32 s28, s8, 14942208
  s_addc_u32 s29, s9, 0
  s_and_b32 s29, s29, 0xffff
  s_mov_b32 s30, 69120
  s_mov_b32 s31, 0x00020000
  s_mul_i32 s18, s15, 160
  s_lshl_b32 s19, s16, 3
  s_add_u32 s18, s18, s19
  s_lshl_b32 s18, s18, 10
  s_lshl_b32 s19, s13, 9
  s_add_u32 s33, s18, s19
  v_mov_b32 v10, 0x3f803f80
  v_mov_b32 v11, 0x3f803f80
  v_mov_b32 v12, 0x3f803f80
  v_mov_b32 v13, 0x3f803f80
  s_waitcnt vmcnt(0)
  ds_read_b64_tr_b16 v[14:15], v3 offset:0
  ds_read_b64_tr_b16 v[16:17], v3 offset:512
  ds_read_b64_tr_b16 v[18:19], v4 offset:0
  ds_read_b64_tr_b16 v[20:21], v4 offset:512
  ds_read_b64_tr_b16 v[22:23], v5 offset:0
  ds_read_b64_tr_b16 v[24:25], v5 offset:512
  ds_read_b64_tr_b16 v[26:27], v6 offset:0
  ds_read_b64_tr_b16 v[28:29], v6 offset:512
  ds_read_b64_tr_b16 v[30:31], v3 offset:4096
  ds_read_b64_tr_b16 v[32:33], v3 offset:4608
  ds_read_b64_tr_b16 v[34:35], v4 offset:4096
  ds_read_b64_tr_b16 v[36:37], v4 offset:4608
  ds_read_b64_tr_b16 v[38:39], v5 offset:4096
  ds_read_b64_tr_b16 v[40:41], v5 offset:4608
  ds_read_b64_tr_b16 v[42:43], v6 offset:4096
  ds_read_b64_tr_b16 v[44:45], v6 offset:4608
  ds_read_b64_tr_b16 v[46:47], v3 offset:8192
  ds_read_b64_tr_b16 v[48:49], v3 offset:8704
  ds_read_b64_tr_b16 v[50:51], v4 offset:8192
  ds_read_b64_tr_b16 v[52:53], v4 offset:8704
  ds_read_b64_tr_b16 v[54:55], v5 offset:8192
  ds_read_b64_tr_b16 v[56:57], v5 offset:8704
  ds_read_b64_tr_b16 v[58:59], v6 offset:8192
  ds_read_b64_tr_b16 v[60:61], v6 offset:8704
  ds_read_b64_tr_b16 v[62:63], v3 offset:12288
  ds_read_b64_tr_b16 v[64:65], v3 offset:12800
  ds_read_b64_tr_b16 v[66:67], v4 offset:12288
  ds_read_b64_tr_b16 v[68:69], v4 offset:12800
  ds_read_b64_tr_b16 v[70:71], v5 offset:12288
  ds_read_b64_tr_b16 v[72:73], v5 offset:12800
  ds_read_b64_tr_b16 v[74:75], v6 offset:12288
  ds_read_b64_tr_b16 v[76:77], v6 offset:12800
  s_add_u32 s18, s33, 0
  s_waitcnt lgkmcnt(15)
  buffer_store_dwordx4 v[14:17], v7, s[24:27], s18 offen sc1
  v_mfma_f32_16x16x32_bf16 v[78:81], v[14:17], v[10:13], 0
  s_add_u32 s18, s33, 40960
  buffer_store_dwordx4 v[18:21], v7, s[24:27], s18 offen sc1
  v_mfma_f32_16x16x32_bf16 v[82:85], v[18:21], v[10:13], 0
  s_add_u32 s18, s33, 81920
  buffer_store_dwordx4 v[22:25], v7, s[24:27], s18 offen sc1
  v_mfma_f32_16x16x32_bf16 v[86:89], v[22:25], v[10:13], 0
  s_add_u32 s18, s33, 122880
  buffer_store_dwordx4 v[26:29], v7, s[24:27], s18 offen sc1
  v_mfma_f32_16x16x32_bf16 v[90:93], v[26:29], v[10:13], 0
  s_add_u32 s18, s33, 2048
  buffer_store_dwordx4 v[30:33], v7, s[24:27], s18 offen sc1
  v_mfma_f32_16x16x32_bf16 v[78:81], v[30:33], v[10:13], v[78:81]
  s_add_u32 s18, s33, 43008
  buffer_store_dwordx4 v[34:37], v7, s[24:27], s18 offen sc1
  v_mfma_f32_16x16x32_bf16 v[82:85], v[34:37], v[10:13], v[82:85]
  s_add_u32 s18, s33, 83968
  buffer_store_dwordx4 v[38:41], v7, s[24:27], s18 offen sc1
  v_mfma_f32_16x16x32_bf16 v[86:89], v[38:41], v[10:13], v[86:89]
  s_add_u32 s18, s33, 124928
  buffer_store_dwordx4 v[42:45], v7, s[24:27], s18 offen sc1
  v_mfma_f32_16x16x32_bf16 v[90:93], v[42:45], v[10:13], v[90:93]
  s_add_u32 s18, s33, 4096
  s_waitcnt lgkmcnt(14)
  buffer_store_dwordx4 v[46:49], v7, s[24:27], s18 offen sc1
  v_mfma_f32_16x16x32_bf16 v[78:81], v[46:49], v[10:13], v[78:81]
  s_add_u32 s18, s33, 45056
  s_waitcnt lgkmcnt(12)
  buffer_store_dwordx4 v[50:53], v7, s[24:27], s18 offen sc1
  v_mfma_f32_16x16x32_bf16 v[82:85], v[50:53], v[10:13], v[82:85]
  s_add_u32 s18, s33, 86016
  s_waitcnt lgkmcnt(10)
  buffer_store_dwordx4 v[54:57], v7, s[24:27], s18 offen sc1
  v_mfma_f32_16x16x32_bf16 v[86:89], v[54:57], v[10:13], v[86:89]
  s_add_u32 s18, s33, 126976
  s_waitcnt lgkmcnt(8)
  buffer_store_dwordx4 v[58:61], v7, s[24:27], s18 offen sc1
  v_mfma_f32_16x16x32_bf16 v[90:93], v[58:61], v[10:13], v[90:93]
  s_add_u32 s18, s33, 6144
  s_waitcnt lgkmcnt(6)
  buffer_store_dwordx4 v[62:65], v7, s[24:27], s18 offen sc1
  v_mfma_f32_16x16x32_bf16 v[78:81], v[62:65], v[10:13], v[78:81]
  s_add_u32 s18, s33, 47104
  s_waitcnt lgkmcnt(4)
  buffer_store_dwordx4 v[66:69], v7, s[24:27], s18 offen sc1
  v_mfma_f32_16x16x32_bf16 v[82:85], v[66:69], v[10:13], v[82:85]
  s_add_u32 s18, s33, 88064
  s_waitcnt lgkmcnt(2)
  buffer_store_dwordx4 v[70:73], v7, s[24:27], s18 offen sc1
  v_mfma_f32_16x16x32_bf16 v[86:89], v[70:73], v[10:13], v[86:89]
  s_add_u32 s18, s33, 129024
  s_waitcnt lgkmcnt(0)
  buffer_store_dwordx4 v[74:77], v7, s[24:27], s18 offen sc1
  v_mfma_f32_16x16x32_bf16 v[90:93], v[74:77], v[10:13], v[90:93]
  s_mul_i32 s18, s16, 3456
  s_mul_i32 s19, s13, 1728
  s_add_u32 s18, s18, s19
  s_lshl_b32 s19, s15, 6
  s_add_u32 s18, s18, s19
  s_lshl_b32 s18, s18, 2
  buffer_store_dwordx4 v[78:81], v8, s[28:31], s18 offen offset:0 sc1
  buffer_store_dwordx4 v[82:85], v8, s[28:31], s18 offen offset:64 sc1
  buffer_store_dwordx4 v[86:89], v8, s[28:31], s18 offen offset:128 sc1
  buffer_store_dwordx4 v[90:93], v8, s[28:31], s18 offen offset:192 sc1
  s_branch L_rdone_phF_kernelw
L_rdo_phF_kernelw:
  s_cmp_ge_u32 s11, 540
  s_cselect_b32 s13, 1, 0
  s_mul_i32 s14, s13, 270
  s_add_u32 s14, s14, 270
  s_sub_u32 s14, s11, s14
  s_mul_i32 s15, s14, 52429
  s_lshr_b32 s15, s15, 18
  s_mul_i32 s16, s15, 5
  s_sub_u32 s16, s14, s16
  s_cmp_eq_u32 s13, 1
  s_mov_b32 s17, 48
  s_cmp_eq_u32 s13, 1
  s_cselect_b32 s17, 16, s17
  s_load_dwordx2 s[4:5], s[0:1], s17
  s_lshl_b32 s34, s15, 5
  s_mov_b32 s35, 16
  s_mov_b32 s36, 8
  s_mov_b32 s37, 4
  s_cmp_eq_u32 s13, 0
  s_cbranch_scc1 L_rrow_phF_kernelw
  s_mul_i32 s34, s15, 40
  s_mov_b32 s35, 24
  s_mov_b32 s36, 4
  s_mov_b32 s37, 8
  s_cmp_lt_u32 s15, 16
  s_cbranch_scc1 L_rrow_phF_kernelw
  s_sub_u32 s34, s15, 16
  s_mul_i32 s34, s34, 160
  s_add_u32 s34, s34, 16
  s_mov_b32 s35, 80
  s_mov_b32 s36, 40
  s_mov_b32 s37, 4
L_rrow_phF_kernelw:
  v_lshrrev_b32 v3, 4, v0
  v_lshlrev_b32 v4, 1, v3
  v_and_b32 v5, 15, v0
  v_xor_b32 v4, v4, v5
  v_mul_u32_u24 v3, 1280, v3
  v_lshl_add_u32 v1, v4, 4, v3
  s_lshl_b32 s18, s16, 8
  v_add_u32 v1, s18, v1
  v_xor_b32 v2, 128, v1
  s_mul_i32 s34, s34, 1280
  s_mul_i32 s35, s35, 1280
  s_mul_i32 s36, s36, 1280
  s_mul_i32 s37, s37, 1280
  s_waitcnt lgkmcnt(0)
  s_cmp_eq_u32 s13, 1
  s_mov_b32 s18, 2211840
  s_cmp_eq_u32 s13, 1
  s_cselect_b32 s18, 819200, s18
  s_mov_b32 s20, s4
  s_and_b32 s21, s5, 0xffff
  s_mov_b32 s22, s18
  s_mov_b32 s23, 0x00020000
  s_mov_b32 s18, s34
  s_add_u32 m0, s12, 0
  s_nop 0
  buffer_load_dwordx4 v1, s[20:23], s18 offen nt lds
  s_mov_b32 s18, s34
  s_add_u32 s18, s18, s37
  s_add_u32 m0, s12, 1024
  s_nop 0
  buffer_load_dwordx4 v1, s[20:23], s18 offen nt lds
  s_mov_b32 s18, s34
  s_add_u32 s18, s18, s36
  s_add_u32 m0, s12, 2048
  s_nop 0
  buffer_load_dwordx4 v2, s[20:23], s18 offen nt lds
  s_mov_b32 s18, s34
  s_add_u32 s18, s18, s36
  s_add_u32 s18, s18, s37
  s_add_u32 m0, s12, 3072
  s_nop 0
  buffer_load_dwordx4 v2, s[20:23], s18 offen nt lds
  s_mov_b32 s18, s34
  s_add_u32 s18, s18, s35
  s_add_u32 m0, s12, 4096
  s_nop 0
  buffer_load_dwordx4 v1, s[20:23], s18 offen nt lds
  s_mov_b32 s18, s34
  s_add_u32 s18, s18, s35
  s_add_u32 s18, s18, s37
  s_add_u32 m0, s12, 5120
  s_nop 0
  buffer_load_dwordx4 v1, s[20:23], s18 offen nt lds
  s_mov_b32 s18, s34
  s_add_u32 s18, s18, s35
  s_add_u32 s18, s18, s36
  s_add_u32 m0, s12, 6144
  s_nop 0
  buffer_load_dwordx4 v2, s[20:23], s18 offen nt lds
  s_mov_b32 s18, s34
  s_add_u32 s18, s18, s35
  s_add_u32 s18, s18, s36
  s_add_u32 s18, s18, s37
  s_add_u32 m0, s12, 7168
  s_nop 0
  buffer_load_dwordx4 v2, s[20:23], s18 offen nt lds
  v_lshrrev_b32 v11, 4, v0
  v_lshrrev_b32 v12, 2, v0
  v_and_b32 v12, 3, v12
  v_and_b32 v13, 3, v0
  v_lshl_add_u32 v14, v11, 3, v12
  v_lshlrev_b32 v14, 8, v14
  v_and_b32 v15, 1, v11
  v_lshlrev_b32 v15, 3, v15
  v_lshl_or_b32 v15, v12, 1, v15
  v_lshrrev_b32 v16, 1, v13
  v_xor_b32 v15, v15, v16
  v_lshl_add_u32 v14, v15, 4, v14
  v_and_b32 v16, 1, v13
  v_lshl_add_u32 v14, v16, 3, v14
  v_add_u32 v3, s12, v14
  v_xor_b32 v4, 32, v3
  v_xor_b32 v5, 64, v3
  v_xor_b32 v6, 96, v3
  v_xor_b32 v7, 128, v3
  v_xor_b32 v8, 160, v3
  v_xor_b32 v9, 192, v3
  v_xor_b32 v10, 224, v3
  v_lshlrev_b32 v11, 4, v0
  s_mov_b32 s18, 30408704
  s_cmp_eq_u32 s13, 1
  s_cselect_b32 s18, 33554432, s18
  s_add_u32 s24, s8, s18
  s_addc_u32 s25, s9, 0
  s_and_b32 s25, s25, 0xffff
  s_mov_b32 s26, 2211840
  s_cmp_eq_u32 s13, 1
  s_cselect_b32 s26, 819200, s26
  s_mov_b32 s27, 0x00020000
  s_mov_b32 s33, 54
  s_cmp_eq_u32 s13, 1
  s_cselect_b32 s33, 20, s33
  s_waitcnt vmcnt(0)
  ds_read_b64_tr_b16 v[20:21], v3 offset:0
  ds_read_b64_tr_b16 v[22:23], v3 offset:1024
  ds_read_b64_tr_b16 v[24:25], v4 offset:0
  ds_read_b64_tr_b16 v[26:27], v4 offset:1024
  ds_read_b64_tr_b16 v[28:29], v5 offset:0
  ds_read_b64_tr_b16 v[30:31], v5 offset:1024
  ds_read_b64_tr_b16 v[32:33], v6 offset:0
  ds_read_b64_tr_b16 v[34:35], v6 offset:1024
  ds_read_b64_tr_b16 v[36:37], v7 offset:0
  ds_read_b64_tr_b16 v[38:39], v7 offset:1024
  ds_read_b64_tr_b16 v[40:41], v8 offset:0
  ds_read_b64_tr_b16 v[42:43], v8 offset:1024
  ds_read_b64_tr_b16 v[44:45], v9 offset:0
  ds_read_b64_tr_b16 v[46:47], v9 offset:1024
  ds_read_b64_tr_b16 v[48:49], v10 offset:0
  ds_read_b64_tr_b16 v[50:51], v10 offset:1024
  s_lshl_b32 s34, s16, 3
  s_add_u32 s34, s34, 0
  s_mul_i32 s35, s34, 52429
  s_lshr_b32 s35, s35, 18
  s_mul_i32 s36, s35, 5
  s_sub_u32 s36, s34, s36
  s_mul_i32 s35, s35, s33
  s_add_u32 s35, s35, s15
  s_mul_i32 s35, s35, 5
  s_add_u32 s35, s35, s36
  s_lshl_b32 s35, s35, 10
  s_waitcnt lgkmcnt(14)
  buffer_store_dwordx4 v[20:23], v11, s[24:27], s35 offen sc1
  s_lshl_b32 s34, s16, 3
  s_add_u32 s34, s34, 1
  s_mul_i32 s35, s34, 52429
  s_lshr_b32 s35, s35, 18
  s_mul_i32 s36, s35, 5
  s_sub_u32 s36, s34, s36
  s_mul_i32 s35, s35, s33
  s_add_u32 s35, s35, s15
  s_mul_i32 s35, s35, 5
  s_add_u32 s35, s35, s36
  s_lshl_b32 s35, s35, 10
  s_waitcnt lgkmcnt(12)
  buffer_store_dwordx4 v[24:27], v11, s[24:27], s35 offen sc1
  s_lshl_b32 s34, s16, 3
  s_add_u32 s34, s34, 2
  s_mul_i32 s35, s34, 52429
  s_lshr_b32 s35, s35, 18
  s_mul_i32 s36, s35, 5
  s_sub_u32 s36, s34, s36
  s_mul_i32 s35, s35, s33
  s_add_u32 s35, s35, s15
  s_mul_i32 s35, s35, 5
  s_add_u32 s35, s35, s36
  s_lshl_b32 s35, s35, 10
  s_waitcnt lgkmcnt(10)
  buffer_store_dwordx4 v[28:31], v11, s[24:27], s35 offen sc1
  s_lshl_b32 s34, s16, 3
  s_add_u32 s34, s34, 3
  s_mul_i32 s35, s34, 52429
  s_lshr_b32 s35, s35, 18
  s_mul_i32 s36, s35, 5
  s_sub_u32 s36, s34, s36
  s_mul_i32 s35, s35, s33
  s_add_u32 s35, s35, s15
  s_mul_i32 s35, s35, 5
  s_add_u32 s35, s35, s36
  s_lshl_b32 s35, s35, 10
  s_waitcnt lgkmcnt(8)
  buffer_store_dwordx4 v[32:35], v11, s[24:27], s35 offen sc1
  s_lshl_b32 s34, s16, 3
  s_add_u32 s34, s34, 4
  s_mul_i32 s35, s34, 52429
  s_lshr_b32 s35, s35, 18
  s_mul_i32 s36, s35, 5
  s_sub_u32 s36, s34, s36
  s_mul_i32 s35, s35, s33
  s_add_u32 s35, s35, s15
  s_mul_i32 s35, s35, 5
  s_add_u32 s35, s35, s36
  s_lshl_b32 s35, s35, 10
  s_waitcnt lgkmcnt(6)
  buffer_store_dwordx4 v[36:39], v11, s[24:27], s35 offen sc1
  s_lshl_b32 s34, s16, 3
  s_add_u32 s34, s34, 5
  s_mul_i32 s35, s34, 52429
  s_lshr_b32 s35, s35, 18
  s_mul_i32 s36, s35, 5
  s_sub_u32 s36, s34, s36
  s_mul_i32 s35, s35, s33
  s_add_u32 s35, s35, s15
  s_mul_i32 s35, s35, 5
  s_add_u32 s35, s35, s36
  s_lshl_b32 s35, s35, 10
  s_waitcnt lgkmcnt(4)
  buffer_store_dwordx4 v[40:43], v11, s[24:27], s35 offen sc1
  s_lshl_b32 s34, s16, 3
  s_add_u32 s34, s34, 6
  s_mul_i32 s35, s34, 52429
  s_lshr_b32 s35, s35, 18
  s_mul_i32 s36, s35, 5
  s_sub_u32 s36, s34, s36
  s_mul_i32 s35, s35, s33
  s_add_u32 s35, s35, s15
  s_mul_i32 s35, s35, 5
  s_add_u32 s35, s35, s36
  s_lshl_b32 s35, s35, 10
  s_waitcnt lgkmcnt(2)
  buffer_store_dwordx4 v[44:47], v11, s[24:27], s35 offen sc1
  s_lshl_b32 s34, s16, 3
  s_add_u32 s34, s34, 7
  s_mul_i32 s35, s34, 52429
  s_lshr_b32 s35, s35, 18
  s_mul_i32 s36, s35, 5
  s_sub_u32 s36, s34, s36
  s_mul_i32 s35, s35, s33
  s_add_u32 s35, s35, s15
  s_mul_i32 s35, s35, 5
  s_add_u32 s35, s35, s36
  s_lshl_b32 s35, s35, 10
  s_waitcnt lgkmcnt(0)
  buffer_store_dwordx4 v[48:51], v11, s[24:27], s35 offen sc1
  s_branch L_rdone_phF_kernelw
L_rnone_phF_kernelw:
L_rdone_phF_kernelw:
  s_waitcnt vmcnt(0)
  s_load_dwordx2 s[4:5], s[0:1], 0
  s_waitcnt lgkmcnt(0)
  s_barrier
  s_nop 11
  s_cmp_ge_u32 s10, 4
  s_cbranch_scc1 L_help_phF_kernel
  s_branch L_postA_phF_kernel
L_xpf_phF_kernel:
  v_lshrrev_b32 v20, 3, v0
  v_mul_u32_u24 v20, 1280, v20
  v_lshrrev_b32 v21, 4, v0
  v_and_b32 v22, 7, v0
  v_xor_b32 v22, v22, v21
  s_mul_i32 s16, s11, 163840
  v_add_u32 v20, s16, v20
  v_lshl_add_u32 v2, v22, 4, v20
  v_xor_b32 v3, 64, v2
  s_waitcnt lgkmcnt(0)
  s_mov_b32 s20, s4
  s_and_b32 s21, s5, 0xffff
  s_mov_b32 s22, 2621440
  s_mov_b32 s23, 0x00020000
  s_lshl_b32 s30, s29, 12
  s_mul_i32 s31, s29, 40960
  s_add_u32 m0, s30, 0
  s_add_u32 s18, s31, 0
  buffer_load_dwordx4 v2, s[20:23], s18 offen lds
  s_add_u32 m0, s30, 1024
  s_add_u32 s18, s31, 10240
  buffer_load_dwordx4 v3, s[20:23], s18 offen lds
  s_add_u32 m0, s30, 2048
  s_add_u32 s18, s31, 20480
  buffer_load_dwordx4 v2, s[20:23], s18 offen lds
  s_add_u32 m0, s30, 3072
  s_add_u32 s18, s31, 30720
  buffer_load_dwordx4 v3, s[20:23], s18 offen lds
  s_add_u32 m0, s30, 16384
  s_add_u32 s18, s31, 128
  buffer_load_dwordx4 v2, s[20:23], s18 offen lds
  s_add_u32 m0, s30, 17408
  s_add_u32 s18, s31, 10368
  buffer_load_dwordx4 v3, s[20:23], s18 offen lds
  s_add_u32 m0, s30, 18432
  s_add_u32 s18, s31, 20608
  buffer_load_dwordx4 v2, s[20:23], s18 offen lds
  s_add_u32 m0, s30, 19456
  s_add_u32 s18, s31, 30848
  buffer_load_dwordx4 v3, s[20:23], s18 offen lds
  s_add_u32 m0, s30, 32768
  s_add_u32 s18, s31, 256
  buffer_load_dwordx4 v2, s[20:23], s18 offen lds
  s_add_u32 m0, s30, 33792
  s_add_u32 s18, s31, 10496
  buffer_load_dwordx4 v3, s[20:23], s18 offen lds
  s_add_u32 m0, s30, 34816
  s_add_u32 s18, s31, 20736
  buffer_load_dwordx4 v2, s[20:23], s18 offen lds
  s_add_u32 m0, s30, 35840
  s_add_u32 s18, s31, 30976
  buffer_load_dwordx4 v3, s[20:23], s18 offen lds
  s_add_u32 m0, s30, 49152
  s_add_u32 s18, s31, 384
  buffer_load_dwordx4 v2, s[20:23], s18 offen lds
  s_add_u32 m0, s30, 50176
  s_add_u32 s18, s31, 10624
  buffer_load_dwordx4 v3, s[20:23], s18 offen lds
  s_add_u32 m0, s30, 51200
  s_add_u32 s18, s31, 20864
  buffer_load_dwordx4 v2, s[20:23], s18 offen lds
  s_add_u32 m0, s30, 52224
  s_add_u32 s18, s31, 31104
  buffer_load_dwordx4 v3, s[20:23], s18 offen lds
  s_add_u32 m0, s30, 0
  s_add_u32 s18, s31, 512
  buffer_load_dwordx4 v2, s[20:23], s18 offen lds
  s_add_u32 m0, s30, 1024
  s_add_u32 s18, s31, 10752
  buffer_load_dwordx4 v3, s[20:23], s18 offen lds
  s_add_u32 m0, s30, 2048
  s_add_u32 s18, s31, 20992
  buffer_load_dwordx4 v2, s[20:23], s18 offen lds
  s_add_u32 m0, s30, 3072
  s_add_u32 s18, s31, 31232
  buffer_load_dwordx4 v3, s[20:23], s18 offen lds
  s_add_u32 m0, s30, 16384
  s_add_u32 s18, s31, 640
  buffer_load_dwordx4 v2, s[20:23], s18 offen lds
  s_add_u32 m0, s30, 17408
  s_add_u32 s18, s31, 10880
  buffer_load_dwordx4 v3, s[20:23], s18 offen lds
  s_add_u32 m0, s30, 18432
  s_add_u32 s18, s31, 21120
  buffer_load_dwordx4 v2, s[20:23], s18 offen lds
  s_add_u32 m0, s30, 19456
  s_add_u32 s18, s31, 31360
  buffer_load_dwordx4 v3, s[20:23], s18 offen lds
  s_add_u32 m0, s30, 32768
  s_add_u32 s18, s31, 768
  buffer_load_dwordx4 v2, s[20:23], s18 offen lds
  s_add_u32 m0, s30, 33792
  s_add_u32 s18, s31, 11008
  buffer_load_dwordx4 v3, s[20:23], s18 offen lds
  s_add_u32 m0, s30, 34816
  s_add_u32 s18, s31, 21248
  buffer_load_dwordx4 v2, s[20:23], s18 offen lds
  s_add_u32 m0, s30, 35840
  s_add_u32 s18, s31, 31488
  buffer_load_dwordx4 v3, s[20:23], s18 offen lds
  s_add_u32 m0, s30, 49152
  s_add_u32 s18, s31, 896
  buffer_load_dwordx4 v2, s[20:23], s18 offen lds
  s_add_u32 m0, s30, 50176
  s_add_u32 s18, s31, 11136
  buffer_load_dwordx4 v3, s[20:23], s18 offen lds
  s_add_u32 m0, s30, 51200
  s_add_u32 s18, s31, 21376
  buffer_load_dwordx4 v2, s[20:23], s18 offen lds
  s_add_u32 m0, s30, 52224
  s_add_u32 s18, s31, 31616
  buffer_load_dwordx4 v3, s[20:23], s18 offen lds
  s_add_u32 m0, s30, 0
  s_add_u32 s18, s31, 1024
  buffer_load_dwordx4 v2, s[20:23], s18 offen lds
  s_add_u32 m0, s30, 1024
  s_add_u32 s18, s31, 11264
  buffer_load_dwordx4 v3, s[20:23], s18 offen lds
  s_add_u32 m0, s30, 2048
  s_add_u32 s18, s31, 21504
  buffer_load_dwordx4 v2, s[20:23], s18 offen lds
  s_add_u32 m0, s30, 3072
  s_add_u32 s18, s31, 31744
  buffer_load_dwordx4 v3, s[20:23], s18 offen lds
  s_add_u32 m0, s30, 16384
  s_add_u32 s18, s31, 1152
  buffer_load_dwordx4 v2, s[20:23], s18 offen lds
  s_add_u32 m0, s30, 17408
  s_add_u32 s18, s31, 11392
  buffer_load_dwordx4 v3, s[20:23], s18 offen lds
  s_add_u32 m0, s30, 18432
  s_add_u32 s18, s31, 21632
  buffer_load_dwordx4 v2, s[20:23], s18 offen lds
  s_add_u32 m0, s30, 19456
  s_add_u32 s18, s31, 31872
  buffer_load_dwordx4 v3, s[20:23], s18 offen lds
  s_add_u32 s56, s8, 34603008
  s_addc_u32 s57, s9, 0
  s_and_b32 s57, s57, 0xffff
  s_mov_b32 s58, 1769472
  s_mov_b32 s59, 0x00020000
  s_and_b32 s60, s2, 7
  s_lshr_b32 s61, s2, 3
  v_mov_b32 v30, 0x40000000
  v_mov_b32 v32, 0
  v_and_b32 v31, 15, v0
  v_mul_u32_u24 v31, 2048, v31
  s_and_b32 s62, s60, 1
  s_lshl_b32 s62, s62, 3
  s_and_b32 s63, s61, 7
  s_add_u32 s62, s62, s63
  s_lshr_b32 s63, s60, 1
  s_lshl_b32 s63, s63, 2
  s_lshr_b32 s52, s61, 3
  s_add_u32 s63, s63, s52
  s_mul_i32 s52, s62, 2048
  s_mul_i32 s53, s63, 128
  s_add_u32 s52, s52, s53
  s_add_u32 s53, s52, 131072
  s_mov_b64 exec, 1
  v_mov_b32 v30, s53
  s_add_u32 s53, s52, 32768
  s_mov_b64 exec, 2
  v_mov_b32 v30, s53
  s_add_u32 s53, s52, 196608
  s_mov_b64 exec, 16
  v_mov_b32 v30, s53
  s_add_u32 s53, s52, 196612
  s_mov_b64 exec, 32
  v_mov_b32 v30, s53
  s_add_u32 s53, s52, 196616
  s_mov_b64 exec, 64
  v_mov_b32 v30, s53
  s_add_u32 s53, s52, 196620
  s_mov_b64 exec, 128
  v_mov_b32 v30, s53
  s_mul_i32 s52, s62, 128
  s_add_u32 s52, s52, 163840
  s_cmp_eq_u32 s63, 15
  s_cselect_b32 exec_lo, 0xffff0000, 0
  s_mov_b32 exec_hi, 0
  v_add_u32 v30, s52, v31
  s_lshr_b32 s52, s61, 4
  s_lshl_b32 s53, s60, 1
  s_add_u32 s52, s52, s53
  s_mul_i32 s52, s52, 128
  s_and_b32 s53, s61, 15
  s_mul_i32 s53, s53, 2048
  s_add_u32 s52, s52, s53
  s_add_u32 s52, s52, 65536
  s_mov_b64 exec, 4
  v_mov_b32 v30, s52
  s_and_b32 s62, s60, 3
  s_lshl_b32 s62, s62, 3
  s_and_b32 s63, s61, 7
  s_add_u32 s62, s62, s63
  s_lshr_b32 s63, s60, 2
  s_lshl_b32 s63, s63, 2
  s_lshr_b32 s52, s61, 3
  s_add_u32 s63, s63, s52
  s_and_b32 s52, s62, 1
  s_lshl_b32 s52, s52, 3
  s_add_u32 s52, s52, s63
  s_mul_i32 s52, s52, 128
  s_lshr_b32 s53, s62, 1
  s_mul_i32 s53, s53, 2048
  s_add_u32 s52, s52, s53
  s_mov_b64 exec, 8
  v_mov_b32 v30, s52
  s_lshr_b32 s53, s62, 1
  s_mul_i32 s53, s53, 128
  s_add_u32 s53, s53, 98304
  s_and_b32 s52, s62, 1
  s_or_b32 s52, s52, s63
  s_cmp_eq_u32 s52, 0
  s_cselect_b32 exec_hi, 0xffff, 0
  s_mov_b32 exec_lo, 0
  v_add_u32 v30, s53, v31
  s_mov_b64 exec, -1
  buffer_store_dword v32, v30, s[56:59], 0 offen sc1
  s_waitcnt vmcnt(0)
  s_barrier
  s_branch L_help_phF_kernel
L_help_phF_kernel:
  s_and_b32 s13, s2, 7
  s_lshr_b32 s14, s2, 3
  s_lshr_b32 s12, s14, 4
  s_lshl_b32 s13, s13, 1
  s_add_u32 s12, s12, s13
  s_and_b32 s11, s14, 15
  s_sub_u32 s38, s10, 4
  s_mul_i32 s16, s12, 5
  s_lshl_b32 s17, s11, 7
  s_sub_u32 s17, s17, 256
  s_lshl_b32 s17, s17, 4
  s_lshl_b32 s18, s38, 3
  s_add_u32 s18, s18, 0
  s_min_u32 s18, s18, 29
  s_mul_i32 s19, s18, 43
  s_lshr_b32 s19, s19, 8
  s_mul_i32 s26, s19, 6
  s_sub_u32 s26, s18, s26
  s_lshl_b32 s26, s26, 10
  s_mul_i32 s27, s19, 6208
  s_add_u32 s27, s27, s26
  s_add_u32 s40, s27, 31232
  s_add_u32 s19, s19, s16
  s_add_u32 s19, s19, 160
  s_lshl_b32 s19, s19, 15
  s_add_u32 s26, s26, s17
  s_max_i32 s26, s26, 0
  s_add_u32 s41, s19, s26
  s_lshl_b32 s18, s38, 3
  s_add_u32 s18, s18, 1
  s_min_u32 s18, s18, 29
  s_mul_i32 s19, s18, 43
  s_lshr_b32 s19, s19, 8
  s_mul_i32 s26, s19, 6
  s_sub_u32 s26, s18, s26
  s_lshl_b32 s26, s26, 10
  s_mul_i32 s27, s19, 6208
  s_add_u32 s27, s27, s26
  s_add_u32 s42, s27, 31232
  s_add_u32 s19, s19, s16
  s_add_u32 s19, s19, 160
  s_lshl_b32 s19, s19, 15
  s_add_u32 s26, s26, s17
  s_max_i32 s26, s26, 0
  s_add_u32 s43, s19, s26
  s_lshl_b32 s18, s38, 3
  s_add_u32 s18, s18, 2
  s_min_u32 s18, s18, 29
  s_mul_i32 s19, s18, 43
  s_lshr_b32 s19, s19, 8
  s_mul_i32 s26, s19, 6
  s_sub_u32 s26, s18, s26
  s_lshl_b32 s26, s26, 10
  s_mul_i32 s27, s19, 6208
  s_add_u32 s27, s27, s26
  s_add_u32 s44, s27, 31232
  s_add_u32 s19, s19, s16
  s_add_u32 s19, s19, 160
  s_lshl_b32 s19, s19, 15
  s_add_u32 s26, s26, s17
  s_max_i32 s26, s26, 0
  s_add_u32 s45, s19, s26
  s_lshl_b32 s18, s38, 3
  s_add_u32 s18, s18, 3
  s_min_u32 s18, s18, 29
  s_mul_i32 s19, s18, 43
  s_lshr_b32 s19, s19, 8
  s_mul_i32 s26, s19, 6
  s_sub_u32 s26, s18, s26
  s_lshl_b32 s26, s26, 10
  s_mul_i32 s27, s19, 6208
  s_add_u32 s27, s27, s26
  s_add_u32 s46, s27, 31232
  s_add_u32 s19, s19, s16
  s_add_u32 s19, s19, 160
  s_lshl_b32 s19, s19, 15
  s_add_u32 s26, s26, s17
  s_max_i32 s26, s26, 0
  s_add_u32 s47, s19, s26
  s_lshl_b32 s18, s38, 3
  s_add_u32 s18, s18, 4
  s_min_u32 s18, s18, 29
  s_mul_i32 s19, s18, 43
  s_lshr_b32 s19, s19, 8
  s_mul_i32 s26, s19, 6
  s_sub_u32 s26, s18, s26
  s_lshl_b32 s26, s26, 10
  s_mul_i32 s27, s19, 6208
  s_add_u32 s27, s27, s26
  s_add_u32 s48, s27, 31232
  s_add_u32 s19, s19, s16
  s_add_u32 s19, s19, 160
  s_lshl_b32 s19, s19, 15
  s_add_u32 s26, s26, s17
  s_max_i32 s26, s26, 0
  s_add_u32 s49, s19, s26
  s_lshl_b32 s18, s38, 3
  s_add_u32 s18, s18, 5
  s_min_u32 s18, s18, 29
  s_mul_i32 s19, s18, 43
  s_lshr_b32 s19, s19, 8
  s_mul_i32 s26, s19, 6
  s_sub_u32 s26, s18, s26
  s_lshl_b32 s26, s26, 10
  s_mul_i32 s27, s19, 6208
  s_add_u32 s27, s27, s26
  s_add_u32 s50, s27, 31232
  s_add_u32 s19, s19, s16
  s_add_u32 s19, s19, 160
  s_lshl_b32 s19, s19, 15
  s_add_u32 s26, s26, s17
  s_max_i32 s26, s26, 0
  s_add_u32 s51, s19, s26
  s_lshl_b32 s18, s38, 3
  s_add_u32 s18, s18, 6
  s_min_u32 s18, s18, 29
  s_mul_i32 s19, s18, 43
  s_lshr_b32 s19, s19, 8
  s_mul_i32 s26, s19, 6
  s_sub_u32 s26, s18, s26
  s_lshl_b32 s26, s26, 10
  s_mul_i32 s27, s19, 6208
  s_add_u32 s27, s27, s26
  s_add_u32 s78, s27, 31232
  s_add_u32 s19, s19, s16
  s_add_u32 s19, s19, 160
  s_lshl_b32 s19, s19, 15
  s_add_u32 s26, s26, s17
  s_max_i32 s26, s26, 0
  s_add_u32 s79, s19, s26
  s_lshl_b32 s18, s38, 3
  s_add_u32 s18, s18, 7
  s_min_u32 s18, s18, 29
  s_mul_i32 s19, s18, 43
  s_lshr_b32 s19, s19, 8
  s_mul_i32 s26, s19, 6
  s_sub_u32 s26, s18, s26
  s_lshl_b32 s26, s26, 10
  s_mul_i32 s27, s19, 6208
  s_add_u32 s27, s27, s26
  s_add_u32 s80, s27, 31232
  s_add_u32 s19, s19, s16
  s_add_u32 s19, s19, 160
  s_lshl_b32 s19, s19, 15
  s_add_u32 s26, s26, s17
  s_max_i32 s26, s26, 0
  s_add_u32 s81, s19, s26
  s_add_u32 s56, s8, 34603008
  s_addc_u32 s57, s9, 0
  s_and_b32 s57, s57, 0xffff
  s_mov_b32 s58, 1769472
  s_mov_b32 s59, 0x00020000
  s_mov_b32 s54, 1
  v_lshrrev_b32 v70, 4, v0
  v_min_u32 v70, 2, v70
  v_bfe_u32 v71, v0, 1, 3
  v_min_u32 v71, 2, v71
  v_cmp_eq_u32 vcc, 0, v70
  s_nop 1
  v_cndmask_b32 v71, v71, 0, vcc
  v_sub_u32 v71, s11, v71
  v_max_i32 v71, 0, v71
  v_and_b32 v72, 1, v0
  s_mul_i32 s52, s12, 5
  v_lshl_add_u32 v72, v72, 2, s52
  v_lshrrev_b32 v72, 4, v72
  v_mad_u32_u24 v72, v70, 5, v72
  v_mul_u32_u24 v71, 2048, v71
  v_mul_u32_u24 v72, 128, v72
  v_add_u32 v71, v71, v72
  v_add_u32 v74, 131072, v71
  s_and_b32 s60, s2, 7
  s_lshr_b32 s61, s2, 3
  s_and_b32 s62, s60, 1
  s_lshl_b32 s62, s62, 3
  s_and_b32 s63, s61, 7
  s_add_u32 s62, s62, s63
  s_lshr_b32 s63, s60, 1
  s_lshl_b32 s63, s63, 2
  s_lshr_b32 s52, s61, 3
  s_add_u32 s63, s63, s52
  s_mul_i32 s52, s62, 2048
  s_mul_i32 s53, s63, 128
  s_add_u32 s52, s52, s53
  s_add_u32 s52, s52, 131072
  v_mov_b32 v73, s52
  s_mov_b32 s82, 1
  s_mov_b32 s83, 0
  s_cmp_lg_u32 s63, 15
  s_cbranch_scc1 L_nidle_phF_kernel
  s_mul_i32 s52, s62, 128
  s_add_u32 s52, s52, 163840
  v_and_b32 v73, 15, v0
  v_mul_u32_u24 v73, 2048, v73
  v_add_u32 v73, s52, v73
  s_mov_b32 s82, 0xffff
L_nidle_phF_kernel:
  s_mul_i32 s52, s11, 2048
  s_add_u32 s52, s52, 163840
  v_and_b32 v75, 15, v0
  v_mul_u32_u24 v75, 128, v75
  v_add_u32 v75, s52, v75
  s_barrier
  s_cmp_lg_u32 s10, 7
  s_cbranch_scc1 L_nsa_phF_kernel
  v_mov_b32 v76, s54
  s_mov_b64 exec, s[82:83]
  buffer_store_dword v76, v73, s[56:59], 0 offen sc1
  s_mov_b64 exec, -1
  s_mov_b32 s30, 0
L_pa_phF_kernel:
  buffer_load_dword v76, v74, s[56:59], 0 offen sc1
  s_waitcnt vmcnt(0)
  v_cmp_ne_u32 vcc, s54, v76
  s_nop 4
  s_cbranch_vccz L_pa_phF_kernel_ok
  s_add_u32 s30, s30, 1
  s_cmp_lt_u32 s30, 0x4000
  s_cbranch_scc1 L_pa_phF_kernel
L_pa_phF_kernel_ok:
L_nsa_phF_kernel:
  s_barrier
  s_mov_b32 s20, s8
  s_and_b32 s21, s9, 0xffff
  s_mov_b32 s22, 7864320
  s_mov_b32 s23, 0x00020000
  v_lshlrev_b32 v60, 4, v0
  s_mov_b32 m0, s40
  s_nop 0
  buffer_load_dwordx4 v60, s[20:23], s41 offen lds
  s_mov_b32 m0, s42
  s_nop 0
  buffer_load_dwordx4 v60, s[20:23], s43 offen lds
  s_mov_b32 m0, s44
  s_nop 0
  buffer_load_dwordx4 v60, s[20:23], s45 offen lds
  s_mov_b32 m0, s46
  s_nop 0
  buffer_load_dwordx4 v60, s[20:23], s47 offen lds
  s_mov_b32 m0, s48
  s_nop 0
  buffer_load_dwordx4 v60, s[20:23], s49 offen lds
  s_mov_b32 m0, s50
  s_nop 0
  buffer_load_dwordx4 v60, s[20:23], s51 offen lds
  s_mov_b32 m0, s78
  s_nop 0
  buffer_load_dwordx4 v60, s[20:23], s79 offen lds
  s_mov_b32 m0, s80
  s_nop 0
  buffer_load_dwordx4 v60, s[20:23], s81 offen lds
  s_barrier
  s_lshl_b32 s11, s38, 8
  s_add_u32 s11, s11, s2
  s_lshl_b32 s12, s38, 14
  s_add_u32 s12, s12, 69120
  s_cmp_ge_u32 s11, 540
  s_cbranch_scc1 L_rnone_phF_kernel
  s_cmp_ge_u32 s11, 270
  s_cbranch_scc1 L_rdo_phF_kernel
  s_cmp_ge_u32 s11, 135
  s_cselect_b32 s13, 1, 0
  s_mul_i32 s14, s13, 135
  s_sub_u32 s14, s11, s14
  s_mul_i32 s15, s14, 52429
  s_lshr_b32 s15, s15, 18
  s_mul_i32 s16, s15, 5
  s_sub_u32 s16, s14, s16
  s_lshl_b32 s17, s13, 3
  s_add_u32 s17, s17, 32
  s_load_dwordx2 s[4:5], s[0:1], s17
  v_lshrrev_b32 v3, 3, v0
  v_and_b32 v4, 2, v3
  v_and_b32 v5, 7, v0
  v_xor_b32 v4, v4, v5
  v_mul_u32_u24 v3, 3456, v3
  v_lshl_add_u32 v1, v4, 4, v3
  s_lshl_b32 s18, s15, 7
  v_add_u32 v1, s18, v1
  v_xor_b32 v2, 64, v1
  s_waitcnt lgkmcnt(0)
  s_mov_b32 s20, s4
  s_and_b32 s21, s5, 0xffff
  s_mov_b32 s22, 2211840
  s_mov_b32 s23, 0x00020000
  s_mul_i32 s19, s16, 442368
  s_add_u32 m0, s12, 0
  s_add_u32 s18, s19, 0
  buffer_load_dwordx4 v1, s[20:23], s18 offen nt lds
  s_add_u32 m0, s12, 1024
  s_add_u32 s18, s19, 27648
  buffer_load_dwordx4 v2, s[20:23], s18 offen nt lds
  s_add_u32 m0, s12, 2048
  s_add_u32 s18, s19, 55296
  buffer_load_dwordx4 v1, s[20:23], s18 offen nt lds
  s_add_u32 m0, s12, 3072
  s_add_u32 s18, s19, 82944
  buffer_load_dwordx4 v2, s[20:23], s18 offen nt lds
  s_add_u32 m0, s12, 4096
  s_add_u32 s18, s19, 110592
  buffer_load_dwordx4 v1, s[20:23], s18 offen nt lds
  s_add_u32 m0, s12, 5120
  s_add_u32 s18, s19, 138240
  buffer_load_dwordx4 v2, s[20:23], s18 offen nt lds
  s_add_u32 m0, s12, 6144
  s_add_u32 s18, s19, 165888
  buffer_load_dwordx4 v1, s[20:23], s18 offen nt lds
  s_add_u32 m0, s12, 7168
  s_add_u32 s18, s19, 193536
  buffer_load_dwordx4 v2, s[20:23], s18 offen nt lds
  s_add_u32 m0, s12, 8192
  s_add_u32 s18, s19, 221184
  buffer_load_dwordx4 v1, s[20:23], s18 offen nt lds
  s_add_u32 m0, s12, 9216
  s_add_u32 s18, s19, 248832
  buffer_load_dwordx4 v2, s[20:23], s18 offen nt lds
  s_add_u32 m0, s12, 10240
  s_add_u32 s18, s19, 276480
  buffer_load_dwordx4 v1, s[20:23], s18 offen nt lds
  s_add_u32 m0, s12, 11264
  s_add_u32 s18, s19, 304128
  buffer_load_dwordx4 v2, s[20:23], s18 offen nt lds
  s_add_u32 m0, s12, 12288
  s_add_u32 s18, s19, 331776
  buffer_load_dwordx4 v1, s[20:23], s18 offen nt lds
  s_add_u32 m0, s12, 13312
  s_add_u32 s18, s19, 359424
  buffer_load_dwordx4 v2, s[20:23], s18 offen nt lds
  s_add_u32 m0, s12, 14336
  s_add_u32 s18, s19, 387072
  buffer_load_dwordx4 v1, s[20:23], s18 offen nt lds
  s_add_u32 m0, s12, 15360
  s_add_u32 s18, s19, 414720
  buffer_load_dwordx4 v2, s[20:23], s18 offen nt lds
  s_waitcnt vmcnt(16)
  s_barrier
  v_lshrrev_b32 v7, 4, v0
  v_lshrrev_b32 v8, 2, v0
  v_and_b32 v8, 3, v8
  v_and_b32 v9, 3, v0
  v_lshl_add_u32 v10, v7, 3, v8
  v_lshlrev_b32 v10, 7, v10
  v_and_b32 v11, 1, v7
  v_lshlrev_b32 v11, 2, v11
  v_and_b32 v12, 2, v8
  v_or_b32 v11, v11, v12
  v_lshrrev_b32 v12, 1, v9
  v_xor_b32 v11, v11, v12
  v_lshl_add_u32 v10, v11, 4, v10
  v_and_b32 v12, 1, v9
  v_lshl_add_u32 v10, v12, 3, v10
  v_add_u32 v3, s12, v10
  v_xor_b32 v4, 32, v3
  v_xor_b32 v5, 64, v3
  v_xor_b32 v6, 96, v3
  v_lshrrev_b32 v8, 1, v7
  v_lshlrev_b32 v8, 10, v8
  v_and_b32 v9, 1, v7
  v_lshl_add_u32 v8, v9, 8, v8
  v_and_b32 v9, 15, v0
  v_lshl_add_u32 v8, v9, 4, v8
  v_lshlrev_b32 v10, 4, v7
  v_mov_b32 v11, 0x40000000
  v_cmp_eq_u32 vcc, 0, v9
  s_nop 1
  v_cndmask_b32 v10, v11, v10, vcc
  v_mov_b32 v7, v8
  v_mov_b32 v8, v10
  s_add_u32 s24, s8, 25165824
  s_addc_u32 s25, s9, 0
  s_and_b32 s25, s25, 0xffff
  s_mov_b32 s26, 4423680
  s_mov_b32 s27, 0x00020000
  s_add_u32 s28, s8, 14942208
  s_addc_u32 s29, s9, 0
  s_and_b32 s29, s29, 0xffff
  s_mov_b32 s30, 69120
  s_mov_b32 s31, 0x00020000
  s_mul_i32 s18, s15, 160
  s_lshl_b32 s19, s16, 3
  s_add_u32 s18, s18, s19
  s_lshl_b32 s18, s18, 10
  s_lshl_b32 s19, s13, 9
  s_add_u32 s33, s18, s19
  v_mov_b32 v10, 0x3f803f80
  v_mov_b32 v11, 0x3f803f80
  v_mov_b32 v12, 0x3f803f80
  v_mov_b32 v13, 0x3f803f80
  s_waitcnt vmcnt(0)
  ds_read_b64_tr_b16 v[14:15], v3 offset:0
  ds_read_b64_tr_b16 v[16:17], v3 offset:512
  ds_read_b64_tr_b16 v[18:19], v4 offset:0
  ds_read_b64_tr_b16 v[20:21], v4 offset:512
  ds_read_b64_tr_b16 v[22:23], v5 offset:0
  ds_read_b64_tr_b16 v[24:25], v5 offset:512
  ds_read_b64_tr_b16 v[26:27], v6 offset:0
  ds_read_b64_tr_b16 v[28:29], v6 offset:512
  ds_read_b64_tr_b16 v[30:31], v3 offset:4096
  ds_read_b64_tr_b16 v[32:33], v3 offset:4608
  ds_read_b64_tr_b16 v[34:35], v4 offset:4096
  ds_read_b64_tr_b16 v[36:37], v4 offset:4608
  ds_read_b64_tr_b16 v[38:39], v5 offset:4096
  ds_read_b64_tr_b16 v[40:41], v5 offset:4608
  ds_read_b64_tr_b16 v[42:43], v6 offset:4096
  ds_read_b64_tr_b16 v[44:45], v6 offset:4608
  ds_read_b64_tr_b16 v[46:47], v3 offset:8192
  ds_read_b64_tr_b16 v[48:49], v3 offset:8704
  ds_read_b64_tr_b16 v[50:51], v4 offset:8192
  ds_read_b64_tr_b16 v[52:53], v4 offset:8704
  ds_read_b64_tr_b16 v[54:55], v5 offset:8192
  ds_read_b64_tr_b16 v[56:57], v5 offset:8704
  ds_read_b64_tr_b16 v[58:59], v6 offset:8192
  ds_read_b64_tr_b16 v[60:61], v6 offset:8704
  ds_read_b64_tr_b16 v[62:63], v3 offset:12288
  ds_read_b64_tr_b16 v[64:65], v3 offset:12800
  ds_read_b64_tr_b16 v[66:67], v4 offset:12288
  ds_read_b64_tr_b16 v[68:69], v4 offset:12800
  ds_read_b64_tr_b16 v[70:71], v5 offset:12288
  ds_read_b64_tr_b16 v[72:73], v5 offset:12800
  ds_read_b64_tr_b16 v[74:75], v6 offset:12288
  ds_read_b64_tr_b16 v[76:77], v6 offset:12800
  s_add_u32 s18, s33, 0
  s_waitcnt lgkmcnt(15)
  buffer_store_dwordx4 v[14:17], v7, s[24:27], s18 offen sc1
  v_mfma_f32_16x16x32_bf16 v[78:81], v[14:17], v[10:13], 0
  s_add_u32 s18, s33, 40960
  buffer_store_dwordx4 v[18:21], v7, s[24:27], s18 offen sc1
  v_mfma_f32_16x16x32_bf16 v[82:85], v[18:21], v[10:13], 0
  s_add_u32 s18, s33, 81920
  buffer_store_dwordx4 v[22:25], v7, s[24:27], s18 offen sc1
  v_mfma_f32_16x16x32_bf16 v[86:89], v[22:25], v[10:13], 0
  s_add_u32 s18, s33, 122880
  buffer_store_dwordx4 v[26:29], v7, s[24:27], s18 offen sc1
  v_mfma_f32_16x16x32_bf16 v[90:93], v[26:29], v[10:13], 0
  s_add_u32 s18, s33, 2048
  buffer_store_dwordx4 v[30:33], v7, s[24:27], s18 offen sc1
  v_mfma_f32_16x16x32_bf16 v[78:81], v[30:33], v[10:13], v[78:81]
  s_add_u32 s18, s33, 43008
  buffer_store_dwordx4 v[34:37], v7, s[24:27], s18 offen sc1
  v_mfma_f32_16x16x32_bf16 v[82:85], v[34:37], v[10:13], v[82:85]
  s_add_u32 s18, s33, 83968
  buffer_store_dwordx4 v[38:41], v7, s[24:27], s18 offen sc1
  v_mfma_f32_16x16x32_bf16 v[86:89], v[38:41], v[10:13], v[86:89]
  s_add_u32 s18, s33, 124928
  buffer_store_dwordx4 v[42:45], v7, s[24:27], s18 offen sc1
  v_mfma_f32_16x16x32_bf16 v[90:93], v[42:45], v[10:13], v[90:93]
  s_add_u32 s18, s33, 4096
  s_waitcnt lgkmcnt(14)
  buffer_store_dwordx4 v[46:49], v7, s[24:27], s18 offen sc1
  v_mfma_f32_16x16x32_bf16 v[78:81], v[46:49], v[10:13], v[78:81]
  s_add_u32 s18, s33, 45056
  s_waitcnt lgkmcnt(12)
  buffer_store_dwordx4 v[50:53], v7, s[24:27], s18 offen sc1
  v_mfma_f32_16x16x32_bf16 v[82:85], v[50:53], v[10:13], v[82:85]
  s_add_u32 s18, s33, 86016
  s_waitcnt lgkmcnt(10)
  buffer_store_dwordx4 v[54:57], v7, s[24:27], s18 offen sc1
  v_mfma_f32_16x16x32_bf16 v[86:89], v[54:57], v[10:13], v[86:89]
  s_add_u32 s18, s33, 126976
  s_waitcnt lgkmcnt(8)
  buffer_store_dwordx4 v[58:61], v7, s[24:27], s18 offen sc1
  v_mfma_f32_16x16x32_bf16 v[90:93], v[58:61], v[10:13], v[90:93]
  s_add_u32 s18, s33, 6144
  s_waitcnt lgkmcnt(6)
  buffer_store_dwordx4 v[62:65], v7, s[24:27], s18 offen sc1
  v_mfma_f32_16x16x32_bf16 v[78:81], v[62:65], v[10:13], v[78:81]
  s_add_u32 s18, s33, 47104
  s_waitcnt lgkmcnt(4)
  buffer_store_dwordx4 v[66:69], v7, s[24:27], s18 offen sc1
  v_mfma_f32_16x16x32_bf16 v[82:85], v[66:69], v[10:13], v[82:85]
  s_add_u32 s18, s33, 88064
  s_waitcnt lgkmcnt(2)
  buffer_store_dwordx4 v[70:73], v7, s[24:27], s18 offen sc1
  v_mfma_f32_16x16x32_bf16 v[86:89], v[70:73], v[10:13], v[86:89]
  s_add_u32 s18, s33, 129024
  s_waitcnt lgkmcnt(0)
  buffer_store_dwordx4 v[74:77], v7, s[24:27], s18 offen sc1
  v_mfma_f32_16x16x32_bf16 v[90:93], v[74:77], v[10:13], v[90:93]
  s_mul_i32 s18, s16, 3456
  s_mul_i32 s19, s13, 1728
  s_add_u32 s18, s18, s19
  s_lshl_b32 s19, s15, 6
  s_add_u32 s18, s18, s19
  s_lshl_b32 s18, s18, 2
  buffer_store_dwordx4 v[78:81], v8, s[28:31], s18 offen offset:0 sc1
  buffer_store_dwordx4 v[82:85], v8, s[28:31], s18 offen offset:64 sc1
  buffer_store_dwordx4 v[86:89], v8, s[28:31], s18 offen offset:128 sc1
  buffer_store_dwordx4 v[90:93], v8, s[28:31], s18 offen offset:192 sc1
  s_branch L_rdone_phF_kernel
L_rdo_phF_kernel:
  s_cmp_ge_u32 s11, 540
  s_cselect_b32 s13, 1, 0
  s_mul_i32 s14, s13, 270
  s_add_u32 s14, s14, 270
  s_sub_u32 s14, s11, s14
  s_mul_i32 s15, s14, 52429
  s_lshr_b32 s15, s15, 18
  s_mul_i32 s16, s15, 5
  s_sub_u32 s16, s14, s16
  s_cmp_eq_u32 s13, 1
  s_mov_b32 s17, 48
  s_cmp_eq_u32 s13, 1
  s_cselect_b32 s17, 16, s17
  s_load_dwordx2 s[4:5], s[0:1], s17
  s_lshl_b32 s34, s15, 5
  s_mov_b32 s35, 16
  s_mov_b32 s36, 8
  s_mov_b32 s37, 4
  s_cmp_eq_u32 s13, 0
  s_cbranch_scc1 L_rrow_phF_kernel
  s_mul_i32 s34, s15, 40
  s_mov_b32 s35, 24
  s_mov_b32 s36, 4
  s_mov_b32 s37, 8
  s_cmp_lt_u32 s15, 16
  s_cbranch_scc1 L_rrow_phF_kernel
  s_sub_u32 s34, s15, 16
  s_mul_i32 s34, s34, 160
  s_add_u32 s34, s34, 16
  s_mov_b32 s35, 80
  s_mov_b32 s36, 40
  s_mov_b32 s37, 4
L_rrow_phF_kernel:
  v_lshrrev_b32 v3, 4, v0
  v_lshlrev_b32 v4, 1, v3
  v_and_b32 v5, 15, v0
  v_xor_b32 v4, v4, v5
  v_mul_u32_u24 v3, 1280, v3
  v_lshl_add_u32 v1, v4, 4, v3
  s_lshl_b32 s18, s16, 8
  v_add_u32 v1, s18, v1
  v_xor_b32 v2, 128, v1
  s_mul_i32 s34, s34, 1280
  s_mul_i32 s35, s35, 1280
  s_mul_i32 s36, s36, 1280
  s_mul_i32 s37, s37, 1280
  s_waitcnt lgkmcnt(0)
  s_cmp_eq_u32 s13, 1
  s_mov_b32 s18, 2211840
  s_cmp_eq_u32 s13, 1
  s_cselect_b32 s18, 819200, s18
  s_mov_b32 s20, s4
  s_and_b32 s21, s5, 0xffff
  s_mov_b32 s22, s18
  s_mov_b32 s23, 0x00020000
  s_mov_b32 s18, s34
  s_add_u32 m0, s12, 0
  s_nop 0
  buffer_load_dwordx4 v1, s[20:23], s18 offen nt lds
  s_mov_b32 s18, s34
  s_add_u32 s18, s18, s37
  s_add_u32 m0, s12, 1024
  s_nop 0
  buffer_load_dwordx4 v1, s[20:23], s18 offen nt lds
  s_mov_b32 s18, s34
  s_add_u32 s18, s18, s36
  s_add_u32 m0, s12, 2048
  s_nop 0
  buffer_load_dwordx4 v2, s[20:23], s18 offen nt lds
  s_mov_b32 s18, s34
  s_add_u32 s18, s18, s36
  s_add_u32 s18, s18, s37
  s_add_u32 m0, s12, 3072
  s_nop 0
  buffer_load_dwordx4 v2, s[20:23], s18 offen nt lds
  s_mov_b32 s18, s34
  s_add_u32 s18, s18, s35
  s_add_u32 m0, s12, 4096
  s_nop 0
  buffer_load_dwordx4 v1, s[20:23], s18 offen nt lds
  s_mov_b32 s18, s34
  s_add_u32 s18, s18, s35
  s_add_u32 s18, s18, s37
  s_add_u32 m0, s12, 5120
  s_nop 0
  buffer_load_dwordx4 v1, s[20:23], s18 offen nt lds
  s_mov_b32 s18, s34
  s_add_u32 s18, s18, s35
  s_add_u32 s18, s18, s36
  s_add_u32 m0, s12, 6144
  s_nop 0
  buffer_load_dwordx4 v2, s[20:23], s18 offen nt lds
  s_mov_b32 s18, s34
  s_add_u32 s18, s18, s35
  s_add_u32 s18, s18, s36
  s_add_u32 s18, s18, s37
  s_add_u32 m0, s12, 7168
  s_nop 0
  buffer_load_dwordx4 v2, s[20:23], s18 offen nt lds
  s_waitcnt vmcnt(8)
  s_barrier
  v_lshrrev_b32 v11, 4, v0
  v_lshrrev_b32 v12, 2, v0
  v_and_b32 v12, 3, v12
  v_and_b32 v13, 3, v0
  v_lshl_add_u32 v14, v11, 3, v12
  v_lshlrev_b32 v14, 8, v14
  v_and_b32 v15, 1, v11
  v_lshlrev_b32 v15, 3, v15
  v_lshl_or_b32 v15, v12, 1, v15
  v_lshrrev_b32 v16, 1, v13
  v_xor_b32 v15, v15, v16
  v_lshl_add_u32 v14, v15, 4, v14
  v_and_b32 v16, 1, v13
  v_lshl_add_u32 v14, v16, 3, v14
  v_add_u32 v3, s12, v14
  v_xor_b32 v4, 32, v3
  v_xor_b32 v5, 64, v3
  v_xor_b32 v6, 96, v3
  v_xor_b32 v7, 128, v3
  v_xor_b32 v8, 160, v3
  v_xor_b32 v9, 192, v3
  v_xor_b32 v10, 224, v3
  v_lshlrev_b32 v11, 4, v0
  s_mov_b32 s18, 30408704
  s_cmp_eq_u32 s13, 1
  s_cselect_b32 s18, 33554432, s18
  s_add_u32 s24, s8, s18
  s_addc_u32 s25, s9, 0
  s_and_b32 s25, s25, 0xffff
  s_mov_b32 s26, 2211840
  s_cmp_eq_u32 s13, 1
  s_cselect_b32 s26, 819200, s26
  s_mov_b32 s27, 0x00020000
  s_mov_b32 s33, 54
  s_cmp_eq_u32 s13, 1
  s_cselect_b32 s33, 20, s33
  s_waitcnt vmcnt(0)
  ds_read_b64_tr_b16 v[20:21], v3 offset:0
  ds_read_b64_tr_b16 v[22:23], v3 offset:1024
  ds_read_b64_tr_b16 v[24:25], v4 offset:0
  ds_read_b64_tr_b16 v[26:27], v4 offset:1024
  ds_read_b64_tr_b16 v[28:29], v5 offset:0
  ds_read_b64_tr_b16 v[30:31], v5 offset:1024
  ds_read_b64_tr_b16 v[32:33], v6 offset:0
  ds_read_b64_tr_b16 v[34:35], v6 offset:1024
  ds_read_b64_tr_b16 v[36:37], v7 offset:0
  ds_read_b64_tr_b16 v[38:39], v7 offset:1024
  ds_read_b64_tr_b16 v[40:41], v8 offset:0
  ds_read_b64_tr_b16 v[42:43], v8 offset:1024
  ds_read_b64_tr_b16 v[44:45], v9 offset:0
  ds_read_b64_tr_b16 v[46:47], v9 offset:1024
  ds_read_b64_tr_b16 v[48:49], v10 offset:0
  ds_read_b64_tr_b16 v[50:51], v10 offset:1024
  s_lshl_b32 s34, s16, 3
  s_add_u32 s34, s34, 0
  s_mul_i32 s35, s34, 52429
  s_lshr_b32 s35, s35, 18
  s_mul_i32 s36, s35, 5
  s_sub_u32 s36, s34, s36
  s_mul_i32 s35, s35, s33
  s_add_u32 s35, s35, s15
  s_mul_i32 s35, s35, 5
  s_add_u32 s35, s35, s36
  s_lshl_b32 s35, s35, 10
  s_waitcnt lgkmcnt(14)
  buffer_store_dwordx4 v[20:23], v11, s[24:27], s35 offen sc1
  s_lshl_b32 s34, s16, 3
  s_add_u32 s34, s34, 1
  s_mul_i32 s35, s34, 52429
  s_lshr_b32 s35, s35, 18
  s_mul_i32 s36, s35, 5
  s_sub_u32 s36, s34, s36
  s_mul_i32 s35, s35, s33
  s_add_u32 s35, s35, s15
  s_mul_i32 s35, s35, 5
  s_add_u32 s35, s35, s36
  s_lshl_b32 s35, s35, 10
  s_waitcnt lgkmcnt(12)
  buffer_store_dwordx4 v[24:27], v11, s[24:27], s35 offen sc1
  s_lshl_b32 s34, s16, 3
  s_add_u32 s34, s34, 2
  s_mul_i32 s35, s34, 52429
  s_lshr_b32 s35, s35, 18
  s_mul_i32 s36, s35, 5
  s_sub_u32 s36, s34, s36
  s_mul_i32 s35, s35, s33
  s_add_u32 s35, s35, s15
  s_mul_i32 s35, s35, 5
  s_add_u32 s35, s35, s36
  s_lshl_b32 s35, s35, 10
  s_waitcnt lgkmcnt(10)
  buffer_store_dwordx4 v[28:31], v11, s[24:27], s35 offen sc1
  s_lshl_b32 s34, s16, 3
  s_add_u32 s34, s34, 3
  s_mul_i32 s35, s34, 52429
  s_lshr_b32 s35, s35, 18
  s_mul_i32 s36, s35, 5
  s_sub_u32 s36, s34, s36
  s_mul_i32 s35, s35, s33
  s_add_u32 s35, s35, s15
  s_mul_i32 s35, s35, 5
  s_add_u32 s35, s35, s36
  s_lshl_b32 s35, s35, 10
  s_waitcnt lgkmcnt(8)
  buffer_store_dwordx4 v[32:35], v11, s[24:27], s35 offen sc1
  s_lshl_b32 s34, s16, 3
  s_add_u32 s34, s34, 4
  s_mul_i32 s35, s34, 52429
  s_lshr_b32 s35, s35, 18
  s_mul_i32 s36, s35, 5
  s_sub_u32 s36, s34, s36
  s_mul_i32 s35, s35, s33
  s_add_u32 s35, s35, s15
  s_mul_i32 s35, s35, 5
  s_add_u32 s35, s35, s36
  s_lshl_b32 s35, s35, 10
  s_waitcnt lgkmcnt(6)
  buffer_store_dwordx4 v[36:39], v11, s[24:27], s35 offen sc1
  s_lshl_b32 s34, s16, 3
  s_add_u32 s34, s34, 5
  s_mul_i32 s35, s34, 52429
  s_lshr_b32 s35, s35, 18
  s_mul_i32 s36, s35, 5
  s_sub_u32 s36, s34, s36
  s_mul_i32 s35, s35, s33
  s_add_u32 s35, s35, s15
  s_mul_i32 s35, s35, 5
  s_add_u32 s35, s35, s36
  s_lshl_b32 s35, s35, 10
  s_waitcnt lgkmcnt(4)
  buffer_store_dwordx4 v[40:43], v11, s[24:27], s35 offen sc1
  s_lshl_b32 s34, s16, 3
  s_add_u32 s34, s34, 6
  s_mul_i32 s35, s34, 52429
  s_lshr_b32 s35, s35, 18
  s_mul_i32 s36, s35, 5
  s_sub_u32 s36, s34, s36
  s_mul_i32 s35, s35, s33
  s_add_u32 s35, s35, s15
  s_mul_i32 s35, s35, 5
  s_add_u32 s35, s35, s36
  s_lshl_b32 s35, s35, 10
  s_waitcnt lgkmcnt(2)
  buffer_store_dwordx4 v[44:47], v11, s[24:27], s35 offen sc1
  s_lshl_b32 s34, s16, 3
  s_add_u32 s34, s34, 7
  s_mul_i32 s35, s34, 52429
  s_lshr_b32 s35, s35, 18
  s_mul_i32 s36, s35, 5
  s_sub_u32 s36, s34, s36
  s_mul_i32 s35, s35, s33
  s_add_u32 s35, s35, s15
  s_mul_i32 s35, s35, 5
  s_add_u32 s35, s35, s36
  s_lshl_b32 s35, s35, 10
  s_waitcnt lgkmcnt(0)
  buffer_store_dwordx4 v[48:51], v11, s[24:27], s35 offen sc1
  s_branch L_rdone_phF_kernel
L_rnone_phF_kernel:
  s_waitcnt vmcnt(0)
  s_barrier
  s_cmp_lg_u32 s10, 7
  s_cbranch_scc1 L_nw1_phF_kernel
  buffer_load_dword v77, v75, s[56:59], 0 offen sc1
  s_waitcnt vmcnt(0)
  v_cmp_ne_u32 vcc, s54, v77
  s_nop 4
  s_cbranch_vccz L_nw1_phF_kernel
  s_mov_b32 s30, 0
L_pw_phF_kernel:
  buffer_load_dword v77, v75, s[56:59], 0 offen sc1
  s_waitcnt vmcnt(0)
  v_cmp_ne_u32 vcc, s54, v77
  s_nop 4
  s_cbranch_vccz L_pw_phF_kernel_ok
  s_add_u32 s30, s30, 1
  s_cmp_lt_u32 s30, 0x4000
  s_cbranch_scc1 L_pw_phF_kernel
L_pw_phF_kernel_ok:
L_nw1_phF_kernel:
L_rdone_phF_kernel:
  s_barrier
  s_and_b32 s13, s2, 7
  s_lshr_b32 s14, s2, 3
  s_lshr_b32 s12, s14, 4
  s_lshl_b32 s13, s13, 1
  s_add_u32 s12, s12, s13
  s_and_b32 s11, s14, 15
  s_mov_b32 s62, s11
  s_mov_b32 s61, s12
  s_and_b32 s13, s2, 7
  s_lshr_b32 s14, s2, 3
  s_and_b32 s11, s13, 3
  s_lshl_b32 s11, s11, 3
  s_and_b32 s15, s14, 7
  s_add_u32 s11, s11, s15
  s_lshr_b32 s12, s13, 2
  s_lshl_b32 s12, s12, 2
  s_lshr_b32 s15, s14, 3
  s_add_u32 s12, s12, s15
  s_mov_b32 s44, 0
  s_sub_u32 s19, s10, 4
  v_lshlrev_b32 v2, 4, v0
  s_mul_i32 s16, s12, 20
  s_add_u32 s16, s16, s19
  s_mul_i32 s16, s16, 5120
  s_mul_i32 s17, s44, 20480
  s_add_u32 s17, s17, s16
  s_add_u32 s26, s16, 102400
  s_mul_i32 s28, s19, 5120
  s_waitcnt lgkmcnt(0)
  s_add_u32 s20, s8, 33554432
  s_addc_u32 s21, s9, 0
  s_and_b32 s21, s21, 0xffff
  s_mov_b32 s22, 819200
  s_mov_b32 s23, 0x00020000
  s_add_u32 m0, s28, 0
  s_nop 0
  buffer_load_dwordx4 v2, s[20:23], s17 offen lds
  buffer_load_dwordx4 v2, s[20:23], s17 offen offset:1024 lds
  buffer_load_dwordx4 v2, s[20:23], s17 offen offset:2048 lds
  buffer_load_dwordx4 v2, s[20:23], s17 offen offset:3072 lds
  s_add_u32 m0, s28, 4096
  s_add_u32 s18, s17, 4096
  buffer_load_dwordx4 v2, s[20:23], s18 offen lds
  s_add_u32 s17, s17, 20480
  s_cmp_eq_u32 s17, s26
  s_cselect_b32 s17, s16, s17
  s_add_u32 m0, s28, 20480
  s_nop 0
  buffer_load_dwordx4 v2, s[20:23], s17 offen lds
  buffer_load_dwordx4 v2, s[20:23], s17 offen offset:1024 lds
  buffer_load_dwordx4 v2, s[20:23], s17 offen offset:2048 lds
  buffer_load_dwordx4 v2, s[20:23], s17 offen offset:3072 lds
  s_add_u32 m0, s28, 24576
  s_add_u32 s18, s17, 4096
  buffer_load_dwordx4 v2, s[20:23], s18 offen lds
  s_add_u32 s17, s17, 20480
  s_cmp_eq_u32 s17, s26
  s_cselect_b32 s17, s16, s17
  s_lshr_b32 s63, s11, 1
  s_lshl_b32 s53, s11, 3
  s_add_u32 s53, s53, s12
  s_mul_i32 s52, s62, 2048
  s_mul_i32 s53, s61, 128
  s_add_u32 s52, s52, s53
  s_add_u32 s52, s52, 65536
  v_mov_b32 v20, s52
  s_mul_i32 s52, s63, 2048
  s_add_u32 s52, s52, 65536
  v_and_b32 v22, 15, v0
  v_mul_u32_u24 v22, 128, v22
  v_add_u32 v22, s52, v22
  v_add_u32 v23, 32768, v22
  s_mul_i32 s52, s63, 128
  s_add_u32 s52, s52, 98304
  v_and_b32 v24, 15, v0
  v_mul_u32_u24 v24, 2048, v24
  v_add_u32 v24, s52, v24
  s_waitcnt vmcnt(10)
  s_barrier
  s_cmp_eq_u32 s10, 7
  s_cbranch_scc1 L_w7o_phF_kernel
  s_branch L_nso_phF_kernel
L_w7o_phF_kernel:
  v_mov_b32 v21, s54
  s_mov_b64 exec, 1
  buffer_store_dword v21, v20, s[56:59], 0 offen sc1
  s_mov_b64 exec, -1
  s_mov_b32 s30, 0
L_po_phF_kernel:
  buffer_load_dword v21, v22, s[56:59], 0 offen sc1
  s_waitcnt vmcnt(0)
  v_cmp_ne_u32 vcc, s54, v21
  s_nop 4
  s_cbranch_vccz L_po_phF_kernel_ok
  s_add_u32 s30, s30, 1
  s_cmp_lt_u32 s30, 0x4000
  s_cbranch_scc1 L_po_phF_kernel
L_po_phF_kernel_ok:
  s_and_b32 s52, s11, 1
  s_or_b32 s52, s52, s12
  s_cmp_lg_u32 s52, 0
  s_cbranch_scc1 L_nld_phF_kernel
  v_mov_b32 v21, s54
  s_mov_b64 exec, 0xffff
  buffer_store_dword v21, v24, s[56:59], 0 offen sc1
  s_mov_b64 exec, -1
L_nld_phF_kernel:
L_nso_phF_kernel:
  s_barrier
  s_waitcnt vmcnt(5)
  s_barrier
  s_add_u32 m0, s28, 40960
  s_nop 0
  buffer_load_dwordx4 v2, s[20:23], s17 offen lds
  buffer_load_dwordx4 v2, s[20:23], s17 offen offset:1024 lds
  buffer_load_dwordx4 v2, s[20:23], s17 offen offset:2048 lds
  buffer_load_dwordx4 v2, s[20:23], s17 offen offset:3072 lds
  s_add_u32 m0, s28, 45056
  s_add_u32 s18, s17, 4096
  buffer_load_dwordx4 v2, s[20:23], s18 offen lds
  s_add_u32 s17, s17, 20480
  s_cmp_eq_u32 s17, s26
  s_cselect_b32 s17, s16, s17
  s_add_u32 m0, s28, 61440
  s_nop 0
  buffer_load_dwordx4 v2, s[20:23], s17 offen lds
  buffer_load_dwordx4 v2, s[20:23], s17 offen offset:1024 lds
  buffer_load_dwordx4 v2, s[20:23], s17 offen offset:2048 lds
  buffer_load_dwordx4 v2, s[20:23], s17 offen offset:3072 lds
  s_add_u32 m0, s28, 65536
  s_add_u32 s18, s17, 4096
  buffer_load_dwordx4 v2, s[20:23], s18 offen lds
  s_add_u32 s17, s17, 20480
  s_cmp_eq_u32 s17, s26
  s_cselect_b32 s17, s16, s17
  s_add_u32 m0, s28, 81920
  s_nop 0
  buffer_load_dwordx4 v2, s[20:23], s17 offen lds
  buffer_load_dwordx4 v2, s[20:23], s17 offen offset:1024 lds
  buffer_load_dwordx4 v2, s[20:23], s17 offen offset:2048 lds
  buffer_load_dwordx4 v2, s[20:23], s17 offen offset:3072 lds
  s_add_u32 m0, s28, 86016
  s_add_u32 s18, s17, 4096
  buffer_load_dwordx4 v2, s[20:23], s18 offen lds
  s_add_u32 s17, s17, 20480
  s_cmp_eq_u32 s17, s26
  s_cselect_b32 s17, s16, s17
  s_waitcnt vmcnt(15)
  s_barrier
  s_waitcnt vmcnt(10)
  s_barrier
  s_waitcnt vmcnt(5)
  s_barrier
  s_waitcnt vmcnt(0)
  s_cmp_lg_u32 s10, 7
  s_cbranch_scc1 L_nr1_phF_kernel
  buffer_load_dword v25, v23, s[56:59], 0 offen sc1
L_nr1_phF_kernel:
  s_barrier
  s_cmp_lg_u32 s10, 7
  s_cbranch_scc1 L_nr2_phF_kernel
  s_waitcnt vmcnt(0)
  v_cmp_ne_u32 vcc, s54, v25
  s_nop 4
  s_cbranch_vccz L_nr2_phF_kernel
  s_mov_b32 s30, 0
L_rf_phF_kernel:
  buffer_load_dword v25, v23, s[56:59], 0 offen sc1
  s_waitcnt vmcnt(0)
  v_cmp_ne_u32 vcc, s54, v25
  s_nop 4
  s_cbranch_vccz L_rf_phF_kernel_ok
  s_add_u32 s30, s30, 1
  s_cmp_lt_u32 s30, 0x4000
  s_cbranch_scc1 L_rf_phF_kernel
L_rf_phF_kernel_ok:
L_nr2_phF_kernel:
  s_barrier
  s_lshr_b32 s60, s11, 1
  s_and_b32 s61, s11, 1
  s_lshl_b32 s61, s61, 3
  s_add_u32 s61, s61, s12
  s_and_b32 s11, s13, 1
  s_lshl_b32 s11, s11, 3
  s_and_b32 s15, s14, 7
  s_add_u32 s11, s11, s15
  s_lshr_b32 s12, s13, 1
  s_lshl_b32 s12, s12, 2
  s_lshr_b32 s29, s14, 3
  s_add_u32 s12, s12, s29
  s_mov_b32 s33, s12
  s_mul_i32 s12, s12, 27
  s_lshr_b32 s12, s12, 2
  s_mov_b32 s55, s33
  s_sub_u32 s28, s10, 4
  v_lshlrev_b32 v2, 4, v0
  s_add_u32 s20, s8, 25165824
  s_addc_u32 s21, s9, 0
  s_and_b32 s21, s21, 0xffff
  s_mov_b32 s22, 4423680
  s_mov_b32 s23, 0x00020000
  s_add_u32 s24, s8, 11534336
  s_addc_u32 s25, s9, 0
  s_and_b32 s25, s25, 0xffff
  s_mov_b32 s26, 2621440
  s_mov_b32 s27, 0x00020000
  s_add_u32 s32, s8, 14942208
  s_addc_u32 s33, s9, 0
  s_and_b32 s33, s33, 0xffff
  s_mov_b32 s34, 69120
  s_mov_b32 s35, 0x00020000
  s_cmp_eq_u32 s28, 3
  s_cbranch_scc1 L_early_phF_kernel
  s_mul_i32 s16, s28, 4
  s_lshl_b32 s30, s15, 1
  s_add_u32 s30, s30, s16
  s_add_u32 s30, s30, 2
  s_add_u32 s17, s30, 0
  s_sub_u32 s19, s17, 14
  s_cmp_ge_u32 s17, 14
  s_cselect_b32 s17, s19, s17
  s_lshr_b32 s30, s17, 1
  s_add_u32 s30, s30, s12
  s_mul_i32 s30, s30, 40960
  s_and_b32 s31, s17, 1
  s_lshl_b32 s31, s31, 10
  s_add_u32 s40, s30, s31
  s_lshl_b32 s41, s17, 10
  s_mul_i32 s16, s28, 4
  s_add_u32 s16, s16, 1
  s_lshl_b32 s30, s15, 1
  s_add_u32 s30, s30, s16
  s_add_u32 s30, s30, 2
  s_add_u32 s17, s30, 0
  s_sub_u32 s19, s17, 14
  s_cmp_ge_u32 s17, 14
  s_cselect_b32 s17, s19, s17
  s_lshr_b32 s30, s17, 1
  s_add_u32 s30, s30, s12
  s_mul_i32 s30, s30, 40960
  s_and_b32 s31, s17, 1
  s_lshl_b32 s31, s31, 10
  s_add_u32 s42, s30, s31
  s_lshl_b32 s43, s17, 10
  s_mul_i32 s16, s28, 4
  s_add_u32 s16, s16, 2
  s_lshl_b32 s30, s15, 1
  s_add_u32 s30, s30, s16
  s_add_u32 s30, s30, 2
  s_add_u32 s17, s30, 0
  s_sub_u32 s19, s17, 14
  s_cmp_ge_u32 s17, 14
  s_cselect_b32 s17, s19, s17
  s_lshr_b32 s30, s17, 1
  s_add_u32 s30, s30, s12
  s_mul_i32 s30, s30, 40960
  s_and_b32 s31, s17, 1
  s_lshl_b32 s31, s31, 10
  s_add_u32 s44, s30, s31
  s_lshl_b32 s45, s17, 10
  s_mul_i32 s16, s28, 4
  s_add_u32 s16, s16, 3
  s_lshl_b32 s30, s15, 1
  s_add_u32 s30, s30, s16
  s_add_u32 s30, s30, 2
  s_add_u32 s17, s30, 0
  s_sub_u32 s19, s17, 14
  s_cmp_ge_u32 s17, 14
  s_cselect_b32 s17, s19, s17
  s_lshr_b32 s30, s17, 1
  s_add_u32 s30, s30, s12
  s_mul_i32 s30, s30, 40960
  s_and_b32 s31, s17, 1
  s_lshl_b32 s31, s31, 10
  s_add_u32 s46, s30, s31
  s_lshl_b32 s47, s17, 10
  s_mul_i32 s16, s28, 2
  s_lshl_b32 s30, s29, 1
  s_add_u32 s30, s30, s16
  s_add_u32 s30, s30, 2
  s_and_b32 s17, s30, 7
  s_lshr_b32 s30, s17, 1
  s_lshl_b32 s31, s11, 2
  s_add_u32 s30, s30, s31
  s_mul_i32 s30, s30, 40960
  s_and_b32 s31, s17, 1
  s_lshl_b32 s31, s31, 10
  s_add_u32 s48, s30, s31
  s_lshl_b32 s49, s17, 10
  s_add_u32 s49, s49, 14336
  s_mul_i32 s16, s28, 2
  s_add_u32 s16, s16, 1
  s_lshl_b32 s30, s29, 1
  s_add_u32 s30, s30, s16
  s_add_u32 s30, s30, 2
  s_and_b32 s17, s30, 7
  s_lshr_b32 s30, s17, 1
  s_lshl_b32 s31, s11, 2
  s_add_u32 s30, s30, s31
  s_mul_i32 s30, s30, 40960
  s_and_b32 s31, s17, 1
  s_lshl_b32 s31, s31, 10
  s_add_u32 s50, s30, s31
  s_lshl_b32 s51, s17, 10
  s_add_u32 s51, s51, 14336
  s_add_u32 m0, s41, 0
  s_add_u32 s18, s40, 0
  buffer_load_dwordx4 v2, s[20:23], s18 offen lds
  s_add_u32 m0, s43, 0
  s_add_u32 s18, s42, 0
  buffer_load_dwordx4 v2, s[20:23], s18 offen lds
  s_add_u32 m0, s45, 0
  s_add_u32 s18, s44, 0
  buffer_load_dwordx4 v2, s[20:23], s18 offen lds
  s_add_u32 m0, s47, 0
  s_add_u32 s18, s46, 0
  buffer_load_dwordx4 v2, s[20:23], s18 offen lds
  s_add_u32 m0, s41, 22528
  s_add_u32 s18, s40, 2048
  buffer_load_dwordx4 v2, s[20:23], s18 offen lds
  s_add_u32 m0, s43, 22528
  s_add_u32 s18, s42, 2048
  buffer_load_dwordx4 v2, s[20:23], s18 offen lds
  s_add_u32 m0, s45, 22528
  s_add_u32 s18, s44, 2048
  buffer_load_dwordx4 v2, s[20:23], s18 offen lds
  s_add_u32 m0, s47, 22528
  s_add_u32 s18, s46, 2048
  buffer_load_dwordx4 v2, s[20:23], s18 offen lds
  s_add_u32 m0, s41, 45056
  s_add_u32 s18, s40, 4096
  buffer_load_dwordx4 v2, s[20:23], s18 offen lds
  s_add_u32 m0, s43, 45056
  s_add_u32 s18, s42, 4096
  buffer_load_dwordx4 v2, s[20:23], s18 offen lds
  s_add_u32 m0, s45, 45056
  s_add_u32 s18, s44, 4096
  buffer_load_dwordx4 v2, s[20:23], s18 offen lds
  s_add_u32 m0, s47, 45056
  s_add_u32 s18, s46, 4096
  buffer_load_dwordx4 v2, s[20:23], s18 offen lds
  s_barrier
  s_barrier
  s_add_u32 m0, s49, 0
  s_add_u32 s18, s48, 0
  buffer_load_dwordx4 v2, s[24:27], s18 offen lds
  s_add_u32 m0, s51, 0
  s_add_u32 s18, s50, 0
  buffer_load_dwordx4 v2, s[24:27], s18 offen lds
  s_add_u32 m0, s49, 22528
  s_add_u32 s18, s48, 2048
  buffer_load_dwordx4 v2, s[24:27], s18 offen lds
  s_add_u32 m0, s51, 22528
  s_add_u32 s18, s50, 2048
  buffer_load_dwordx4 v2, s[24:27], s18 offen lds
  s_add_u32 m0, s49, 45056
  s_add_u32 s18, s48, 4096
  buffer_load_dwordx4 v2, s[24:27], s18 offen lds
  s_add_u32 m0, s51, 45056
  s_add_u32 s18, s50, 4096
  buffer_load_dwordx4 v2, s[24:27], s18 offen lds
  s_waitcnt vmcnt(4)
  s_barrier
  s_add_u32 m0, s41, 67584
  s_add_u32 s18, s40, 6144
  buffer_load_dwordx4 v2, s[20:23], s18 offen lds
  s_add_u32 m0, s43, 67584
  s_add_u32 s18, s42, 6144
  buffer_load_dwordx4 v2, s[20:23], s18 offen lds
  s_add_u32 m0, s45, 67584
  s_add_u32 s18, s44, 6144
  buffer_load_dwordx4 v2, s[20:23], s18 offen lds
  s_add_u32 m0, s47, 67584
  s_add_u32 s18, s46, 6144
  buffer_load_dwordx4 v2, s[20:23], s18 offen lds
  s_add_u32 m0, s49, 67584
  s_add_u32 s18, s48, 6144
  buffer_load_dwordx4 v2, s[24:27], s18 offen lds
  s_add_u32 m0, s51, 67584
  s_add_u32 s18, s50, 6144
  buffer_load_dwordx4 v2, s[24:27], s18 offen lds
  s_waitcnt vmcnt(8)
  s_barrier
  s_add_u32 m0, s41, 90112
  s_add_u32 s18, s40, 8192
  buffer_load_dwordx4 v2, s[20:23], s18 offen lds
  s_add_u32 m0, s43, 90112
  s_add_u32 s18, s42, 8192
  buffer_load_dwordx4 v2, s[20:23], s18 offen lds
  s_add_u32 m0, s45, 90112
  s_add_u32 s18, s44, 8192
  buffer_load_dwordx4 v2, s[20:23], s18 offen lds
  s_add_u32 m0, s47, 90112
  s_add_u32 s18, s46, 8192
  buffer_load_dwordx4 v2, s[20:23], s18 offen lds
  s_add_u32 m0, s49, 90112
  s_add_u32 s18, s48, 8192
  buffer_load_dwordx4 v2, s[24:27], s18 offen lds
  s_add_u32 m0, s51, 90112
  s_add_u32 s18, s50, 8192
  buffer_load_dwordx4 v2, s[24:27], s18 offen lds
  s_lshl_b32 s17, s28, 6
  v_add_u32 v3, s17, v0
  v_lshrrev_b32 v4, 5, v3
  v_bfe_u32 v5, v3, 4, 1
  v_and_b32 v6, 15, v3
  v_add_u32 v4, s12, v4
  v_lshl_add_u32 v6, v4, 4, v6
  v_mul_u32_u24 v5, 1728, v5
  v_add_u32 v6, v6, v5
  v_lshlrev_b32 v6, 2, v6
  v_mov_b32 v7, 0x40000000
  v_cmp_gt_u32 vcc, 224, v3
  s_nop 1
  v_cndmask_b32 v6, v7, v6, vcc
  s_mov_b32 s18, 0
  buffer_load_dword v8, v6, s[32:35], s18 offen
  s_mov_b32 s18, 13824
  buffer_load_dword v9, v6, s[32:35], s18 offen
  s_mov_b32 s18, 27648
  buffer_load_dword v10, v6, s[32:35], s18 offen
  s_mov_b32 s18, 41472
  buffer_load_dword v11, v6, s[32:35], s18 offen
  s_mov_b32 s18, 55296
  buffer_load_dword v12, v6, s[32:35], s18 offen
  s_waitcnt vmcnt(12)
  s_barrier
  s_add_u32 m0, s41, 112640
  s_add_u32 s18, s40, 10240
  buffer_load_dwordx4 v2, s[20:23], s18 offen lds
  s_add_u32 m0, s43, 112640
  s_add_u32 s18, s42, 10240
  buffer_load_dwordx4 v2, s[20:23], s18 offen lds
  s_add_u32 m0, s45, 112640
  s_add_u32 s18, s44, 10240
  buffer_load_dwordx4 v2, s[20:23], s18 offen lds
  s_add_u32 m0, s47, 112640
  s_add_u32 s18, s46, 10240
  buffer_load_dwordx4 v2, s[20:23], s18 offen lds
  s_add_u32 m0, s49, 112640
  s_add_u32 s18, s48, 10240
  buffer_load_dwordx4 v2, s[24:27], s18 offen lds
  s_add_u32 m0, s51, 112640
  s_add_u32 s18, s50, 10240
  buffer_load_dwordx4 v2, s[24:27], s18 offen lds
  s_waitcnt vmcnt(12)
  s_barrier
  s_add_u32 m0, s41, 135168
  s_add_u32 s18, s40, 12288
  buffer_load_dwordx4 v2, s[20:23], s18 offen lds
  s_add_u32 m0, s43, 135168
  s_add_u32 s18, s42, 12288
  buffer_load_dwordx4 v2, s[20:23], s18 offen lds
  s_add_u32 m0, s45, 135168
  s_add_u32 s18, s44, 12288
  buffer_load_dwordx4 v2, s[20:23], s18 offen lds
  s_add_u32 m0, s47, 135168
  s_add_u32 s18, s46, 12288
  buffer_load_dwordx4 v2, s[20:23], s18 offen lds
  s_add_u32 m0, s49, 135168
  s_add_u32 s18, s48, 12288
  buffer_load_dwordx4 v2, s[24:27], s18 offen lds
  s_add_u32 m0, s51, 135168
  s_add_u32 s18, s50, 12288
  buffer_load_dwordx4 v2, s[24:27], s18 offen lds
  s_waitcnt vmcnt(12)
  s_barrier
  s_add_u32 m0, s41, 0
  s_add_u32 s18, s40, 14336
  buffer_load_dwordx4 v2, s[20:23], s18 offen lds
  s_add_u32 m0, s43, 0
  s_add_u32 s18, s42, 14336
  buffer_load_dwordx4 v2, s[20:23], s18 offen lds
  s_add_u32 m0, s45, 0
  s_add_u32 s18, s44, 14336
  buffer_load_dwordx4 v2, s[20:23], s18 offen lds
  s_add_u32 m0, s47, 0
  s_add_u32 s18, s46, 14336
  buffer_load_dwordx4 v2, s[20:23], s18 offen lds
  s_add_u32 m0, s49, 0
  s_add_u32 s18, s48, 14336
  buffer_load_dwordx4 v2, s[24:27], s18 offen lds
  s_add_u32 m0, s51, 0
  s_add_u32 s18, s50, 14336
  buffer_load_dwordx4 v2, s[24:27], s18 offen lds
  s_waitcnt vmcnt(12)
  s_barrier
  s_add_u32 m0, s41, 22528
  s_add_u32 s18, s40, 16384
  buffer_load_dwordx4 v2, s[20:23], s18 offen lds
  s_add_u32 m0, s43, 22528
  s_add_u32 s18, s42, 16384
  buffer_load_dwordx4 v2, s[20:23], s18 offen lds
  s_add_u32 m0, s45, 22528
  s_add_u32 s18, s44, 16384
  buffer_load_dwordx4 v2, s[20:23], s18 offen lds
  s_add_u32 m0, s47, 22528
  s_add_u32 s18, s46, 16384
  buffer_load_dwordx4 v2, s[20:23], s18 offen lds
  s_add_u32 m0, s49, 22528
  s_add_u32 s18, s48, 16384
  buffer_load_dwordx4 v2, s[24:27], s18 offen lds
  s_add_u32 m0, s51, 22528
  s_add_u32 s18, s50, 16384
  buffer_load_dwordx4 v2, s[24:27], s18 offen lds
  s_waitcnt vmcnt(12)
  s_barrier
  s_add_u32 m0, s41, 45056
  s_add_u32 s18, s40, 18432
  buffer_load_dwordx4 v2, s[20:23], s18 offen lds
  s_add_u32 m0, s43, 45056
  s_add_u32 s18, s42, 18432
  buffer_load_dwordx4 v2, s[20:23], s18 offen lds
  s_add_u32 m0, s45, 45056
  s_add_u32 s18, s44, 18432
  buffer_load_dwordx4 v2, s[20:23], s18 offen lds
  s_add_u32 m0, s47, 45056
  s_add_u32 s18, s46, 18432
  buffer_load_dwordx4 v2, s[20:23], s18 offen lds
  s_add_u32 m0, s49, 45056
  s_add_u32 s18, s48, 18432
  buffer_load_dwordx4 v2, s[24:27], s18 offen lds
  s_add_u32 m0, s51, 45056
  s_add_u32 s18, s50, 18432
  buffer_load_dwordx4 v2, s[24:27], s18 offen lds
  s_waitcnt vmcnt(12)
  s_barrier
  s_add_u32 m0, s41, 67584
  s_add_u32 s18, s40, 20480
  buffer_load_dwordx4 v2, s[20:23], s18 offen lds
  s_add_u32 m0, s43, 67584
  s_add_u32 s18, s42, 20480
  buffer_load_dwordx4 v2, s[20:23], s18 offen lds
  s_add_u32 m0, s45, 67584
  s_add_u32 s18, s44, 20480
  buffer_load_dwordx4 v2, s[20:23], s18 offen lds
  s_add_u32 m0, s47, 67584
  s_add_u32 s18, s46, 20480
  buffer_load_dwordx4 v2, s[20:23], s18 offen lds
  s_add_u32 m0, s49, 67584
  s_add_u32 s18, s48, 20480
  buffer_load_dwordx4 v2, s[24:27], s18 offen lds
  s_add_u32 m0, s51, 67584
  s_add_u32 s18, s50, 20480
  buffer_load_dwordx4 v2, s[24:27], s18 offen lds
  s_waitcnt vmcnt(12)
  s_barrier
  s_add_u32 m0, s41, 90112
  s_add_u32 s18, s40, 22528
  buffer_load_dwordx4 v2, s[20:23], s18 offen lds
  s_add_u32 m0, s43, 90112
  s_add_u32 s18, s42, 22528
  buffer_load_dwordx4 v2, s[20:23], s18 offen lds
  s_add_u32 m0, s45, 90112
  s_add_u32 s18, s44, 22528
  buffer_load_dwordx4 v2, s[20:23], s18 offen lds
  s_add_u32 m0, s47, 90112
  s_add_u32 s18, s46, 22528
  buffer_load_dwordx4 v2, s[20:23], s18 offen lds
  s_add_u32 m0, s49, 90112
  s_add_u32 s18, s48, 22528
  buffer_load_dwordx4 v2, s[24:27], s18 offen lds
  s_add_u32 m0, s51, 90112
  s_add_u32 s18, s50, 22528
  buffer_load_dwordx4 v2, s[24:27], s18 offen lds
  s_waitcnt vmcnt(12)
  s_barrier
  s_add_u32 m0, s41, 112640
  s_add_u32 s18, s40, 24576
  buffer_load_dwordx4 v2, s[20:23], s18 offen lds
  s_add_u32 m0, s43, 112640
  s_add_u32 s18, s42, 24576
  buffer_load_dwordx4 v2, s[20:23], s18 offen lds
  s_add_u32 m0, s45, 112640
  s_add_u32 s18, s44, 24576
  buffer_load_dwordx4 v2, s[20:23], s18 offen lds
  s_add_u32 m0, s47, 112640
  s_add_u32 s18, s46, 24576
  buffer_load_dwordx4 v2, s[20:23], s18 offen lds
  s_add_u32 m0, s49, 112640
  s_add_u32 s18, s48, 24576
  buffer_load_dwordx4 v2, s[24:27], s18 offen lds
  s_add_u32 m0, s51, 112640
  s_add_u32 s18, s50, 24576
  buffer_load_dwordx4 v2, s[24:27], s18 offen lds
  v_add_f32 v8, v8, v9
  v_add_f32 v10, v10, v11
  v_add_f32 v8, v8, v12
  v_add_f32 v8, v8, v10
  v_lshlrev_b32 v3, 2, v3
  v_add_u32 v3, 157696, v3
  ds_write_b32 v3, v8
  s_waitcnt lgkmcnt(0)
  s_waitcnt vmcnt(12)
  s_barrier
  s_add_u32 m0, s41, 135168
  s_add_u32 s18, s40, 26624
  buffer_load_dwordx4 v2, s[20:23], s18 offen lds
  s_add_u32 m0, s43, 135168
  s_add_u32 s18, s42, 26624
  buffer_load_dwordx4 v2, s[20:23], s18 offen lds
  s_add_u32 m0, s45, 135168
  s_add_u32 s18, s44, 26624
  buffer_load_dwordx4 v2, s[20:23], s18 offen lds
  s_add_u32 m0, s47, 135168
  s_add_u32 s18, s46, 26624
  buffer_load_dwordx4 v2, s[20:23], s18 offen lds
  s_add_u32 m0, s49, 135168
  s_add_u32 s18, s48, 26624
  buffer_load_dwordx4 v2, s[24:27], s18 offen lds
  s_add_u32 m0, s51, 135168
  s_add_u32 s18, s50, 26624
  buffer_load_dwordx4 v2, s[24:27], s18 offen lds
  s_waitcnt vmcnt(12)
  s_barrier
  s_add_u32 m0, s41, 0
  s_add_u32 s18, s40, 28672
  buffer_load_dwordx4 v2, s[20:23], s18 offen lds
  s_add_u32 m0, s43, 0
  s_add_u32 s18, s42, 28672
  buffer_load_dwordx4 v2, s[20:23], s18 offen lds
  s_add_u32 m0, s45, 0
  s_add_u32 s18, s44, 28672
  buffer_load_dwordx4 v2, s[20:23], s18 offen lds
  s_add_u32 m0, s47, 0
  s_add_u32 s18, s46, 28672
  buffer_load_dwordx4 v2, s[20:23], s18 offen lds
  s_add_u32 m0, s49, 0
  s_add_u32 s18, s48, 28672
  buffer_load_dwordx4 v2, s[24:27], s18 offen lds
  s_add_u32 m0, s51, 0
  s_add_u32 s18, s50, 28672
  buffer_load_dwordx4 v2, s[24:27], s18 offen lds
  s_waitcnt vmcnt(12)
  s_barrier
  s_add_u32 m0, s41, 22528
  s_add_u32 s18, s40, 30720
  buffer_load_dwordx4 v2, s[20:23], s18 offen lds
  s_add_u32 m0, s43, 22528
  s_add_u32 s18, s42, 30720
  buffer_load_dwordx4 v2, s[20:23], s18 offen lds
  s_add_u32 m0, s45, 22528
  s_add_u32 s18, s44, 30720
  buffer_load_dwordx4 v2, s[20:23], s18 offen lds
  s_add_u32 m0, s47, 22528
  s_add_u32 s18, s46, 30720
  buffer_load_dwordx4 v2, s[20:23], s18 offen lds
  s_add_u32 m0, s49, 22528
  s_add_u32 s18, s48, 30720
  buffer_load_dwordx4 v2, s[24:27], s18 offen lds
  s_add_u32 m0, s51, 22528
  s_add_u32 s18, s50, 30720
  buffer_load_dwordx4 v2, s[24:27], s18 offen lds
  s_waitcnt vmcnt(12)
  s_barrier
  s_add_u32 m0, s41, 45056
  s_add_u32 s18, s40, 32768
  buffer_load_dwordx4 v2, s[20:23], s18 offen lds
  s_add_u32 m0, s43, 45056
  s_add_u32 s18, s42, 32768
  buffer_load_dwordx4 v2, s[20:23], s18 offen lds
  s_add_u32 m0, s45, 45056
  s_add_u32 s18, s44, 32768
  buffer_load_dwordx4 v2, s[20:23], s18 offen lds
  s_add_u32 m0, s47, 45056
  s_add_u32 s18, s46, 32768
  buffer_load_dwordx4 v2, s[20:23], s18 offen lds
  s_add_u32 m0, s49, 45056
  s_add_u32 s18, s48, 32768
  buffer_load_dwordx4 v2, s[24:27], s18 offen lds
  s_add_u32 m0, s51, 45056
  s_add_u32 s18, s50, 32768
  buffer_load_dwordx4 v2, s[24:27], s18 offen lds
  s_waitcnt vmcnt(12)
  s_barrier
  s_add_u32 m0, s41, 67584
  s_add_u32 s18, s40, 34816
  buffer_load_dwordx4 v2, s[20:23], s18 offen lds
  s_add_u32 m0, s43, 67584
  s_add_u32 s18, s42, 34816
  buffer_load_dwordx4 v2, s[20:23], s18 offen lds
  s_add_u32 m0, s45, 67584
  s_add_u32 s18, s44, 34816
  buffer_load_dwordx4 v2, s[20:23], s18 offen lds
  s_add_u32 m0, s47, 67584
  s_add_u32 s18, s46, 34816
  buffer_load_dwordx4 v2, s[20:23], s18 offen lds
  s_add_u32 m0, s49, 67584
  s_add_u32 s18, s48, 34816
  buffer_load_dwordx4 v2, s[24:27], s18 offen lds
  s_add_u32 m0, s51, 67584
  s_add_u32 s18, s50, 34816
  buffer_load_dwordx4 v2, s[24:27], s18 offen lds
  s_waitcnt vmcnt(12)
  s_barrier
  s_add_u32 m0, s41, 90112
  s_add_u32 s18, s40, 36864
  buffer_load_dwordx4 v2, s[20:23], s18 offen lds
  s_add_u32 m0, s43, 90112
  s_add_u32 s18, s42, 36864
  buffer_load_dwordx4 v2, s[20:23], s18 offen lds
  s_add_u32 m0, s45, 90112
  s_add_u32 s18, s44, 36864
  buffer_load_dwordx4 v2, s[20:23], s18 offen lds
  s_add_u32 m0, s47, 90112
  s_add_u32 s18, s46, 36864
  buffer_load_dwordx4 v2, s[20:23], s18 offen lds
  s_add_u32 m0, s49, 90112
  s_add_u32 s18, s48, 36864
  buffer_load_dwordx4 v2, s[24:27], s18 offen lds
  s_add_u32 m0, s51, 90112
  s_add_u32 s18, s50, 36864
  buffer_load_dwordx4 v2, s[24:27], s18 offen lds
  s_waitcnt vmcnt(12)
  s_barrier
  s_add_u32 m0, s41, 112640
  s_add_u32 s18, s40, 38912
  buffer_load_dwordx4 v2, s[20:23], s18 offen lds
  s_add_u32 m0, s43, 112640
  s_add_u32 s18, s42, 38912
  buffer_load_dwordx4 v2, s[20:23], s18 offen lds
  s_add_u32 m0, s45, 112640
  s_add_u32 s18, s44, 38912
  buffer_load_dwordx4 v2, s[20:23], s18 offen lds
  s_add_u32 m0, s47, 112640
  s_add_u32 s18, s46, 38912
  buffer_load_dwordx4 v2, s[20:23], s18 offen lds
  s_add_u32 m0, s49, 112640
  s_add_u32 s18, s48, 38912
  buffer_load_dwordx4 v2, s[24:27], s18 offen lds
  s_add_u32 m0, s51, 112640
  s_add_u32 s18, s50, 38912
  buffer_load_dwordx4 v2, s[24:27], s18 offen lds
  s_waitcnt vmcnt(12)
  s_barrier
  s_waitcnt vmcnt(6)
  s_barrier
  s_waitcnt vmcnt(0)
  s_barrier
  s_and_b32 s11, s13, 3
  s_lshl_b32 s11, s11, 3
  s_and_b32 s15, s14, 7
  s_add_u32 s11, s11, s15
  s_lshr_b32 s12, s13, 2
  s_lshl_b32 s12, s12, 2
  s_lshr_b32 s15, s14, 3
  s_add_u32 s12, s12, s15
  s_mov_b32 s44, 0
  s_sub_u32 s19, s10, 4
  v_lshlrev_b32 v2, 4, v0
  s_mul_i32 s16, s12, 54
  s_add_u32 s16, s16, s19
  s_mul_i32 s16, s16, 5120
  s_mul_i32 s17, s44, 15360
  s_add_u32 s17, s17, s16
  s_add_u32 s26, s16, 276480
  s_mul_i32 s28, s19, 5120
  s_waitcnt lgkmcnt(0)
  s_add_u32 s20, s8, 30408704
  s_addc_u32 s21, s9, 0
  s_and_b32 s21, s21, 0xffff
  s_mov_b32 s22, 2211840
  s_mov_b32 s23, 0x00020000
  s_lshl_b32 s19, s19, 3
  s_mul_i32 s16, s12, 276480
  s_lshr_b32 s17, 196864, s19
  s_and_b32 s17, s17, 0xff
  s_mul_i32 s17, s17, 5120
  s_add_u32 s17, s17, s16
  s_add_u32 m0, s28, 0
  s_nop 0
  buffer_load_dwordx4 v2, s[20:23], s17 offen lds
  buffer_load_dwordx4 v2, s[20:23], s17 offen offset:1024 lds
  buffer_load_dwordx4 v2, s[20:23], s17 offen offset:2048 lds
  buffer_load_dwordx4 v2, s[20:23], s17 offen offset:3072 lds
  s_add_u32 m0, s28, 4096
  s_add_u32 s18, s17, 4096
  buffer_load_dwordx4 v2, s[20:23], s18 offen lds
  s_lshr_b32 s17, 657156, s19
  s_and_b32 s17, s17, 0xff
  s_mul_i32 s17, s17, 5120
  s_add_u32 s17, s17, s16
  s_add_u32 m0, s28, 15360
  s_nop 0
  buffer_load_dwordx4 v2, s[20:23], s17 offen lds
  buffer_load_dwordx4 v2, s[20:23], s17 offen offset:1024 lds
  buffer_load_dwordx4 v2, s[20:23], s17 offen offset:2048 lds
  buffer_load_dwordx4 v2, s[20:23], s17 offen offset:3072 lds
  s_add_u32 m0, s28, 19456
  s_add_u32 s18, s17, 4096
  buffer_load_dwordx4 v2, s[20:23], s18 offen lds
  s_lshr_b32 s17, 1117707, s19
  s_and_b32 s17, s17, 0xff
  s_mul_i32 s17, s17, 5120
  s_add_u32 s17, s17, s16
  s_add_u32 m0, s28, 30720
  s_nop 0
  buffer_load_dwordx4 v2, s[20:23], s17 offen lds
  buffer_load_dwordx4 v2, s[20:23], s17 offen offset:1024 lds
  buffer_load_dwordx4 v2, s[20:23], s17 offen offset:2048 lds
  buffer_load_dwordx4 v2, s[20:23], s17 offen offset:3072 lds
  s_add_u32 m0, s28, 34816
  s_add_u32 s18, s17, 4096
  buffer_load_dwordx4 v2, s[20:23], s18 offen lds
  s_lshr_b32 s17, 1578260, s19
  s_and_b32 s17, s17, 0xff
  s_mul_i32 s17, s17, 5120
  s_add_u32 s17, s17, s16
  s_add_u32 m0, s28, 46080
  s_nop 0
  buffer_load_dwordx4 v2, s[20:23], s17 offen lds
  buffer_load_dwordx4 v2, s[20:23], s17 offen offset:1024 lds
  buffer_load_dwordx4 v2, s[20:23], s17 offen offset:2048 lds
  buffer_load_dwordx4 v2, s[20:23], s17 offen offset:3072 lds
  s_add_u32 m0, s28, 50176
  s_add_u32 s18, s17, 4096
  buffer_load_dwordx4 v2, s[20:23], s18 offen lds
  s_lshr_b32 s17, 1973275, s19
  s_and_b32 s17, s17, 0xff
  s_mul_i32 s17, s17, 5120
  s_add_u32 s17, s17, s16
  s_add_u32 m0, s28, 61440
  s_nop 0
  buffer_load_dwordx4 v2, s[20:23], s17 offen lds
  buffer_load_dwordx4 v2, s[20:23], s17 offen offset:1024 lds
  buffer_load_dwordx4 v2, s[20:23], s17 offen offset:2048 lds
  buffer_load_dwordx4 v2, s[20:23], s17 offen offset:3072 lds
  s_add_u32 m0, s28, 65536
  s_add_u32 s18, s17, 4096
  buffer_load_dwordx4 v2, s[20:23], s18 offen lds
  s_lshr_b32 s17, 2433567, s19
  s_and_b32 s17, s17, 0xff
  s_mul_i32 s17, s17, 5120
  s_add_u32 s17, s17, s16
  s_add_u32 m0, s28, 138240
  s_nop 0
  buffer_load_dwordx4 v2, s[20:23], s17 offen lds
  buffer_load_dwordx4 v2, s[20:23], s17 offen offset:1024 lds
  buffer_load_dwordx4 v2, s[20:23], s17 offen offset:2048 lds
  buffer_load_dwordx4 v2, s[20:23], s17 offen offset:3072 lds
  s_add_u32 m0, s28, 142336
  s_add_u32 s18, s17, 4096
  buffer_load_dwordx4 v2, s[20:23], s18 offen lds
  s_barrier
  s_lshr_b32 s17, 2894118, s19
  s_and_b32 s17, s17, 0xff
  s_mul_i32 s17, s17, 5120
  s_add_u32 s17, s17, s16
  s_add_u32 m0, s28, 76800
  s_nop 0
  buffer_load_dwordx4 v2, s[20:23], s17 offen lds
  buffer_load_dwordx4 v2, s[20:23], s17 offen offset:1024 lds
  buffer_load_dwordx4 v2, s[20:23], s17 offen offset:2048 lds
  buffer_load_dwordx4 v2, s[20:23], s17 offen offset:3072 lds
  s_add_u32 m0, s28, 80896
  s_add_u32 s18, s17, 4096
  buffer_load_dwordx4 v2, s[20:23], s18 offen lds
  s_lshr_b32 s17, 3354671, s19
  s_and_b32 s17, s17, 0xff
  s_mul_i32 s17, s17, 5120
  s_add_u32 s17, s17, s16
  s_add_u32 m0, s28, 92160
  s_nop 0
  buffer_load_dwordx4 v2, s[20:23], s17 offen lds
  buffer_load_dwordx4 v2, s[20:23], s17 offen offset:1024 lds
  buffer_load_dwordx4 v2, s[20:23], s17 offen offset:2048 lds
  buffer_load_dwordx4 v2, s[20:23], s17 offen offset:3072 lds
  s_add_u32 m0, s28, 96256
  s_add_u32 s18, s17, 4096
  buffer_load_dwordx4 v2, s[20:23], s18 offen lds
  s_lshr_b32 s17, 394498, s19
  s_and_b32 s17, s17, 0xff
  s_mul_i32 s17, s17, 5120
  s_add_u32 s17, s17, s16
  s_add_u32 m0, s28, 107520
  s_nop 0
  buffer_load_dwordx4 v2, s[20:23], s17 offen lds
  buffer_load_dwordx4 v2, s[20:23], s17 offen offset:1024 lds
  buffer_load_dwordx4 v2, s[20:23], s17 offen offset:2048 lds
  buffer_load_dwordx4 v2, s[20:23], s17 offen offset:3072 lds
  s_add_u32 m0, s28, 111616
  s_add_u32 s18, s17, 4096
  buffer_load_dwordx4 v2, s[20:23], s18 offen lds
  s_lshr_b32 s17, 788744, s19
  s_and_b32 s17, s17, 0xff
  s_mul_i32 s17, s17, 5120
  s_add_u32 s17, s17, s16
  s_add_u32 m0, s28, 122880
  s_nop 0
  buffer_load_dwordx4 v2, s[20:23], s17 offen lds
  buffer_load_dwordx4 v2, s[20:23], s17 offen offset:1024 lds
  buffer_load_dwordx4 v2, s[20:23], s17 offen offset:2048 lds
  buffer_load_dwordx4 v2, s[20:23], s17 offen offset:3072 lds
  s_add_u32 m0, s28, 126976
  s_add_u32 s18, s17, 4096
  buffer_load_dwordx4 v2, s[20:23], s18 offen lds
  s_barrier
  s_waitcnt vmcnt(45)
  s_barrier
  s_waitcnt vmcnt(40)
  s_barrier
  s_lshr_b32 s17, 1052429, s19
  s_and_b32 s17, s17, 0xff
  s_mul_i32 s17, s17, 5120
  s_add_u32 s17, s17, s16
  s_add_u32 m0, s28, 0
  s_nop 0
  buffer_load_dwordx4 v2, s[20:23], s17 offen lds
  buffer_load_dwordx4 v2, s[20:23], s17 offen offset:1024 lds
  buffer_load_dwordx4 v2, s[20:23], s17 offen offset:2048 lds
  buffer_load_dwordx4 v2, s[20:23], s17 offen offset:3072 lds
  s_add_u32 m0, s28, 4096
  s_add_u32 s18, s17, 4096
  buffer_load_dwordx4 v2, s[20:23], s18 offen lds
  s_waitcnt vmcnt(40)
  s_barrier
  s_lshr_b32 s17, 1446674, s19
  s_and_b32 s17, s17, 0xff
  s_mul_i32 s17, s17, 5120
  s_add_u32 s17, s17, s16
  s_add_u32 m0, s28, 15360
  s_nop 0
  buffer_load_dwordx4 v2, s[20:23], s17 offen lds
  buffer_load_dwordx4 v2, s[20:23], s17 offen offset:1024 lds
  buffer_load_dwordx4 v2, s[20:23], s17 offen offset:2048 lds
  buffer_load_dwordx4 v2, s[20:23], s17 offen offset:3072 lds
  s_add_u32 m0, s28, 19456
  s_add_u32 s18, s17, 4096
  buffer_load_dwordx4 v2, s[20:23], s18 offen lds
  s_waitcnt vmcnt(40)
  s_barrier
  s_lshr_b32 s17, 1710359, s19
  s_and_b32 s17, s17, 0xff
  s_mul_i32 s17, s17, 5120
  s_add_u32 s17, s17, s16
  s_add_u32 m0, s28, 30720
  s_nop 0
  buffer_load_dwordx4 v2, s[20:23], s17 offen lds
  buffer_load_dwordx4 v2, s[20:23], s17 offen offset:1024 lds
  buffer_load_dwordx4 v2, s[20:23], s17 offen offset:2048 lds
  buffer_load_dwordx4 v2, s[20:23], s17 offen offset:3072 lds
  s_add_u32 m0, s28, 34816
  s_add_u32 s18, s17, 4096
  buffer_load_dwordx4 v2, s[20:23], s18 offen lds
  s_waitcnt vmcnt(40)
  s_barrier
  s_lshr_b32 s17, 2170909, s19
  s_and_b32 s17, s17, 0xff
  s_mul_i32 s17, s17, 5120
  s_add_u32 s17, s17, s16
  s_add_u32 m0, s28, 46080
  s_nop 0
  buffer_load_dwordx4 v2, s[20:23], s17 offen lds
  buffer_load_dwordx4 v2, s[20:23], s17 offen offset:1024 lds
  buffer_load_dwordx4 v2, s[20:23], s17 offen offset:2048 lds
  buffer_load_dwordx4 v2, s[20:23], s17 offen offset:3072 lds
  s_add_u32 m0, s28, 50176
  s_add_u32 s18, s17, 4096
  buffer_load_dwordx4 v2, s[20:23], s18 offen lds
  s_waitcnt vmcnt(40)
  s_barrier
  s_lshr_b32 s17, 2565155, s19
  s_and_b32 s17, s17, 0xff
  s_mul_i32 s17, s17, 5120
  s_add_u32 s17, s17, s16
  s_add_u32 m0, s28, 61440
  s_nop 0
  buffer_load_dwordx4 v2, s[20:23], s17 offen lds
  buffer_load_dwordx4 v2, s[20:23], s17 offen offset:1024 lds
  buffer_load_dwordx4 v2, s[20:23], s17 offen offset:2048 lds
  buffer_load_dwordx4 v2, s[20:23], s17 offen offset:3072 lds
  s_add_u32 m0, s28, 65536
  s_add_u32 s18, s17, 4096
  buffer_load_dwordx4 v2, s[20:23], s18 offen lds
  s_waitcnt vmcnt(40)
  s_barrier
  s_lshr_b32 s17, 2828840, s19
  s_and_b32 s17, s17, 0xff
  s_mul_i32 s17, s17, 5120
  s_add_u32 s17, s17, s16
  s_add_u32 m0, s28, 138240
  s_nop 0
  buffer_load_dwordx4 v2, s[20:23], s17 offen lds
  buffer_load_dwordx4 v2, s[20:23], s17 offen offset:1024 lds
  buffer_load_dwordx4 v2, s[20:23], s17 offen offset:2048 lds
  buffer_load_dwordx4 v2, s[20:23], s17 offen offset:3072 lds
  s_add_u32 m0, s28, 142336
  s_add_u32 s18, s17, 4096
  buffer_load_dwordx4 v2, s[20:23], s18 offen lds
  s_waitcnt vmcnt(40)
  s_barrier
  s_lshr_b32 s17, 3223085, s19
  s_and_b32 s17, s17, 0xff
  s_mul_i32 s17, s17, 5120
  s_add_u32 s17, s17, s16
  s_add_u32 m0, s28, 76800
  s_nop 0
  buffer_load_dwordx4 v2, s[20:23], s17 offen lds
  buffer_load_dwordx4 v2, s[20:23], s17 offen offset:1024 lds
  buffer_load_dwordx4 v2, s[20:23], s17 offen offset:2048 lds
  buffer_load_dwordx4 v2, s[20:23], s17 offen offset:3072 lds
  s_add_u32 m0, s28, 80896
  s_add_u32 s18, s17, 4096
  buffer_load_dwordx4 v2, s[20:23], s18 offen lds
  s_waitcnt vmcnt(40)
  s_barrier
  s_lshr_b32 s17, 3486770, s19
  s_and_b32 s17, s17, 0xff
  s_mul_i32 s17, s17, 5120
  s_add_u32 s17, s17, s16
  s_add_u32 m0, s28, 92160
  s_nop 0
  buffer_load_dwordx4 v2, s[20:23], s17 offen lds
  buffer_load_dwordx4 v2, s[20:23], s17 offen offset:1024 lds
  buffer_load_dwordx4 v2, s[20:23], s17 offen offset:2048 lds
  buffer_load_dwordx4 v2, s[20:23], s17 offen offset:3072 lds
  s_add_u32 m0, s28, 96256
  s_add_u32 s18, s17, 4096
  buffer_load_dwordx4 v2, s[20:23], s18 offen lds
  s_waitcnt vmcnt(40)
  s_barrier
  s_waitcnt vmcnt(35)
  s_barrier
  s_waitcnt vmcnt(30)
  s_barrier
  s_waitcnt vmcnt(25)
  s_barrier
  s_waitcnt vmcnt(20)
  s_barrier
  s_waitcnt vmcnt(15)
  s_barrier
  s_waitcnt vmcnt(10)
  s_barrier
  s_waitcnt vmcnt(5)
  s_barrier
  s_waitcnt vmcnt(0)
  s_barrier
  s_barrier
  s_endpgm
L_early_phF_kernel:
  s_lshl_b32 s17, s15, 1
  s_add_u32 s17, s17, 0
  s_sub_u32 s19, s17, 14
  s_cmp_ge_u32 s17, 14
  s_cselect_b32 s17, s19, s17
  s_lshr_b32 s30, s17, 1
  s_add_u32 s30, s30, s12
  s_mul_i32 s30, s30, 40960
  s_and_b32 s31, s17, 1
  s_lshl_b32 s31, s31, 10
  s_add_u32 s40, s30, s31
  s_lshl_b32 s41, s17, 10
  s_lshl_b32 s17, s15, 1
  s_add_u32 s17, s17, 1
  s_sub_u32 s19, s17, 14
  s_cmp_ge_u32 s17, 14
  s_cselect_b32 s17, s19, s17
  s_lshr_b32 s30, s17, 1
  s_add_u32 s30, s30, s12
  s_mul_i32 s30, s30, 40960
  s_and_b32 s31, s17, 1
  s_lshl_b32 s31, s31, 10
  s_add_u32 s42, s30, s31
  s_lshl_b32 s43, s17, 10
  s_lshl_b32 s17, s29, 1
  s_lshr_b32 s30, s17, 1
  s_lshl_b32 s31, s11, 2
  s_add_u32 s30, s30, s31
  s_mul_i32 s30, s30, 40960
  s_and_b32 s31, s17, 1
  s_lshl_b32 s31, s31, 10
  s_add_u32 s44, s30, s31
  s_lshl_b32 s45, s17, 10
  s_add_u32 s45, s45, 14336
  s_lshl_b32 s17, s29, 1
  s_add_u32 s17, s17, 1
  s_lshr_b32 s30, s17, 1
  s_lshl_b32 s31, s11, 2
  s_add_u32 s30, s30, s31
  s_mul_i32 s30, s30, 40960
  s_and_b32 s31, s17, 1
  s_lshl_b32 s31, s31, 10
  s_add_u32 s46, s30, s31
  s_lshl_b32 s47, s17, 10
  s_add_u32 s47, s47, 14336
  s_add_u32 m0, s41, 0
  s_add_u32 s18, s40, 0
  buffer_load_dwordx4 v2, s[20:23], s18 offen lds
  s_add_u32 m0, s43, 0
  s_add_u32 s18, s42, 0
  buffer_load_dwordx4 v2, s[20:23], s18 offen lds
  s_add_u32 m0, s41, 22528
  s_add_u32 s18, s40, 2048
  buffer_load_dwordx4 v2, s[20:23], s18 offen lds
  s_add_u32 m0, s43, 22528
  s_add_u32 s18, s42, 2048
  buffer_load_dwordx4 v2, s[20:23], s18 offen lds
  s_add_u32 m0, s41, 45056
  s_add_u32 s18, s40, 4096
  buffer_load_dwordx4 v2, s[20:23], s18 offen lds
  s_add_u32 m0, s43, 45056
  s_add_u32 s18, s42, 4096
  buffer_load_dwordx4 v2, s[20:23], s18 offen lds
  s_add_u32 m0, s41, 67584
  s_add_u32 s18, s40, 6144
  buffer_load_dwordx4 v2, s[20:23], s18 offen lds
  s_add_u32 m0, s43, 67584
  s_add_u32 s18, s42, 6144
  buffer_load_dwordx4 v2, s[20:23], s18 offen lds
  s_add_u32 m0, s41, 90112
  s_add_u32 s18, s40, 8192
  buffer_load_dwordx4 v2, s[20:23], s18 offen lds
  s_add_u32 m0, s43, 90112
  s_add_u32 s18, s42, 8192
  buffer_load_dwordx4 v2, s[20:23], s18 offen lds
  s_mov_b32 s62, s60
  s_mov_b32 s63, s11
  s_lshl_b32 s53, s11, 4
  s_add_u32 s53, s53, s55
  s_mul_i32 s52, s62, 2048
  s_mul_i32 s53, s61, 128
  s_add_u32 s52, s52, s53
  v_mov_b32 v20, s52
  s_mul_i32 s52, s63, 2048
  v_and_b32 v22, 15, v0
  v_mul_u32_u24 v22, 128, v22
  v_add_u32 v22, s52, v22
  s_barrier
  v_mov_b32 v21, s54
  s_mov_b64 exec, 1
  buffer_store_dword v21, v20, s[56:59], 0 offen sc1
  s_mov_b64 exec, -1
  s_mov_b32 s30, 0
L_ph_phF_kernel:
  buffer_load_dword v21, v22, s[56:59], 0 offen sc1
  s_waitcnt vmcnt(0)
  v_cmp_ne_u32 vcc, s54, v21
  s_nop 4
  s_cbranch_vccz L_ph_phF_kernel_ok
  s_add_u32 s30, s30, 1
  s_cmp_lt_u32 s30, 0x4000
  s_cbranch_scc1 L_ph_phF_kernel
L_ph_phF_kernel_ok:
  s_barrier
  s_add_u32 m0, s45, 0
  s_add_u32 s18, s44, 0
  buffer_load_dwordx4 v2, s[24:27], s18 offen lds
  s_add_u32 m0, s47, 0
  s_add_u32 s18, s46, 0
  buffer_load_dwordx4 v2, s[24:27], s18 offen lds
  s_add_u32 m0, s45, 22528
  s_add_u32 s18, s44, 2048
  buffer_load_dwordx4 v2, s[24:27], s18 offen lds
  s_add_u32 m0, s47, 22528
  s_add_u32 s18, s46, 2048
  buffer_load_dwordx4 v2, s[24:27], s18 offen lds
  s_add_u32 m0, s45, 45056
  s_add_u32 s18, s44, 4096
  buffer_load_dwordx4 v2, s[24:27], s18 offen lds
  s_add_u32 m0, s47, 45056
  s_add_u32 s18, s46, 4096
  buffer_load_dwordx4 v2, s[24:27], s18 offen lds
  s_add_u32 m0, s45, 67584
  s_add_u32 s18, s44, 6144
  buffer_load_dwordx4 v2, s[24:27], s18 offen lds
  s_add_u32 m0, s47, 67584
  s_add_u32 s18, s46, 6144
  buffer_load_dwordx4 v2, s[24:27], s18 offen lds
  s_add_u32 m0, s45, 90112
  s_add_u32 s18, s44, 8192
  buffer_load_dwordx4 v2, s[24:27], s18 offen lds
  s_add_u32 m0, s47, 90112
  s_add_u32 s18, s46, 8192
  buffer_load_dwordx4 v2, s[24:27], s18 offen lds
  s_waitcnt vmcnt(8)
  s_barrier
  s_add_u32 m0, s41, 112640
  s_add_u32 s18, s40, 10240
  buffer_load_dwordx4 v2, s[20:23], s18 offen lds
  s_add_u32 m0, s43, 112640
  s_add_u32 s18, s42, 10240
  buffer_load_dwordx4 v2, s[20:23], s18 offen lds
  s_add_u32 m0, s45, 112640
  s_add_u32 s18, s44, 10240
  buffer_load_dwordx4 v2, s[24:27], s18 offen lds
  s_add_u32 m0, s47, 112640
  s_add_u32 s18, s46, 10240
  buffer_load_dwordx4 v2, s[24:27], s18 offen lds
  s_waitcnt vmcnt(10)
  s_barrier
  s_add_u32 m0, s41, 135168
  s_add_u32 s18, s40, 12288
  buffer_load_dwordx4 v2, s[20:23], s18 offen lds
  s_add_u32 m0, s43, 135168
  s_add_u32 s18, s42, 12288
  buffer_load_dwordx4 v2, s[20:23], s18 offen lds
  s_add_u32 m0, s45, 135168
  s_add_u32 s18, s44, 12288
  buffer_load_dwordx4 v2, s[24:27], s18 offen lds
  s_add_u32 m0, s47, 135168
  s_add_u32 s18, s46, 12288
  buffer_load_dwordx4 v2, s[24:27], s18 offen lds
  s_lshl_b32 s17, s28, 6
  v_add_u32 v3, s17, v0
  v_lshrrev_b32 v4, 5, v3
  v_bfe_u32 v5, v3, 4, 1
  v_and_b32 v6, 15, v3
  v_add_u32 v4, s12, v4
  v_lshl_add_u32 v6, v4, 4, v6
  v_mul_u32_u24 v5, 1728, v5
  v_add_u32 v6, v6, v5
  v_lshlrev_b32 v6, 2, v6
  v_mov_b32 v7, 0x40000000
  v_cmp_gt_u32 vcc, 224, v3
  s_nop 1
  v_cndmask_b32 v6, v7, v6, vcc
  s_mov_b32 s18, 0
  buffer_load_dword v8, v6, s[32:35], s18 offen
  s_mov_b32 s18, 13824
  buffer_load_dword v9, v6, s[32:35], s18 offen
  s_mov_b32 s18, 27648
  buffer_load_dword v10, v6, s[32:35], s18 offen
  s_mov_b32 s18, 41472
  buffer_load_dword v11, v6, s[32:35], s18 offen
  s_mov_b32 s18, 55296
  buffer_load_dword v12, v6, s[32:35], s18 offen
  s_waitcnt vmcnt(12)
  s_barrier
  s_add_u32 m0, s41, 0
  s_add_u32 s18, s40, 14336
  buffer_load_dwordx4 v2, s[20:23], s18 offen lds
  s_add_u32 m0, s43, 0
  s_add_u32 s18, s42, 14336
  buffer_load_dwordx4 v2, s[20:23], s18 offen lds
  s_add_u32 m0, s45, 0
  s_add_u32 s18, s44, 14336
  buffer_load_dwordx4 v2, s[24:27], s18 offen lds
  s_add_u32 m0, s47, 0
  s_add_u32 s18, s46, 14336
  buffer_load_dwordx4 v2, s[24:27], s18 offen lds
  s_waitcnt vmcnt(14)
  s_barrier
  s_add_u32 m0, s41, 22528
  s_add_u32 s18, s40, 16384
  buffer_load_dwordx4 v2, s[20:23], s18 offen lds
  s_add_u32 m0, s43, 22528
  s_add_u32 s18, s42, 16384
  buffer_load_dwordx4 v2, s[20:23], s18 offen lds
  s_add_u32 m0, s45, 22528
  s_add_u32 s18, s44, 16384
  buffer_load_dwordx4 v2, s[24:27], s18 offen lds
  s_add_u32 m0, s47, 22528
  s_add_u32 s18, s46, 16384
  buffer_load_dwordx4 v2, s[24:27], s18 offen lds
  s_waitcnt vmcnt(16)
  s_barrier
  s_add_u32 m0, s41, 45056
  s_add_u32 s18, s40, 18432
  buffer_load_dwordx4 v2, s[20:23], s18 offen lds
  s_add_u32 m0, s43, 45056
  s_add_u32 s18, s42, 18432
  buffer_load_dwordx4 v2, s[20:23], s18 offen lds
  s_add_u32 m0, s45, 45056
  s_add_u32 s18, s44, 18432
  buffer_load_dwordx4 v2, s[24:27], s18 offen lds
  s_add_u32 m0, s47, 45056
  s_add_u32 s18, s46, 18432
  buffer_load_dwordx4 v2, s[24:27], s18 offen lds
  s_waitcnt vmcnt(16)
  s_barrier
  s_add_u32 m0, s41, 67584
  s_add_u32 s18, s40, 20480
  buffer_load_dwordx4 v2, s[20:23], s18 offen lds
  s_add_u32 m0, s43, 67584
  s_add_u32 s18, s42, 20480
  buffer_load_dwordx4 v2, s[20:23], s18 offen lds
  s_add_u32 m0, s45, 67584
  s_add_u32 s18, s44, 20480
  buffer_load_dwordx4 v2, s[24:27], s18 offen lds
  s_add_u32 m0, s47, 67584
  s_add_u32 s18, s46, 20480
  buffer_load_dwordx4 v2, s[24:27], s18 offen lds
  s_waitcnt vmcnt(16)
  s_barrier
  s_add_u32 m0, s41, 90112
  s_add_u32 s18, s40, 22528
  buffer_load_dwordx4 v2, s[20:23], s18 offen lds
  s_add_u32 m0, s43, 90112
  s_add_u32 s18, s42, 22528
  buffer_load_dwordx4 v2, s[20:23], s18 offen lds
  s_add_u32 m0, s45, 90112
  s_add_u32 s18, s44, 22528
  buffer_load_dwordx4 v2, s[24:27], s18 offen lds
  s_add_u32 m0, s47, 90112
  s_add_u32 s18, s46, 22528
  buffer_load_dwordx4 v2, s[24:27], s18 offen lds
  s_waitcnt vmcnt(16)
  s_barrier
  s_add_u32 m0, s41, 112640
  s_add_u32 s18, s40, 24576
  buffer_load_dwordx4 v2, s[20:23], s18 offen lds
  s_add_u32 m0, s43, 112640
  s_add_u32 s18, s42, 24576
  buffer_load_dwordx4 v2, s[20:23], s18 offen lds
  s_add_u32 m0, s45, 112640
  s_add_u32 s18, s44, 24576
  buffer_load_dwordx4 v2, s[24:27], s18 offen lds
  s_add_u32 m0, s47, 112640
  s_add_u32 s18, s46, 24576
  buffer_load_dwordx4 v2, s[24:27], s18 offen lds
  s_waitcnt vmcnt(16)
  s_barrier
  s_add_u32 m0, s41, 135168
  s_add_u32 s18, s40, 26624
  buffer_load_dwordx4 v2, s[20:23], s18 offen lds
  s_add_u32 m0, s43, 135168
  s_add_u32 s18, s42, 26624
  buffer_load_dwordx4 v2, s[20:23], s18 offen lds
  s_add_u32 m0, s45, 135168
  s_add_u32 s18, s44, 26624
  buffer_load_dwordx4 v2, s[24:27], s18 offen lds
  s_add_u32 m0, s47, 135168
  s_add_u32 s18, s46, 26624
  buffer_load_dwordx4 v2, s[24:27], s18 offen lds
  s_waitcnt vmcnt(16)
  s_barrier
  s_add_u32 m0, s41, 0
  s_add_u32 s18, s40, 28672
  buffer_load_dwordx4 v2, s[20:23], s18 offen lds
  s_add_u32 m0, s43, 0
  s_add_u32 s18, s42, 28672
  buffer_load_dwordx4 v2, s[20:23], s18 offen lds
  s_add_u32 m0, s45, 0
  s_add_u32 s18, s44, 28672
  buffer_load_dwordx4 v2, s[24:27], s18 offen lds
  s_add_u32 m0, s47, 0
  s_add_u32 s18, s46, 28672
  buffer_load_dwordx4 v2, s[24:27], s18 offen lds
  v_add_f32 v8, v8, v9
  v_add_f32 v10, v10, v11
  v_add_f32 v8, v8, v12
  v_add_f32 v8, v8, v10
  v_lshlrev_b32 v3, 2, v3
  v_add_u32 v3, 157696, v3
  ds_write_b32 v3, v8
  s_waitcnt lgkmcnt(0)
  s_waitcnt vmcnt(16)
  s_barrier
  s_add_u32 m0, s41, 22528
  s_add_u32 s18, s40, 30720
  buffer_load_dwordx4 v2, s[20:23], s18 offen lds
  s_add_u32 m0, s43, 22528
  s_add_u32 s18, s42, 30720
  buffer_load_dwordx4 v2, s[20:23], s18 offen lds
  s_add_u32 m0, s45, 22528
  s_add_u32 s18, s44, 30720
  buffer_load_dwordx4 v2, s[24:27], s18 offen lds
  s_add_u32 m0, s47, 22528
  s_add_u32 s18, s46, 30720
  buffer_load_dwordx4 v2, s[24:27], s18 offen lds
  s_waitcnt vmcnt(16)
  s_barrier
  s_add_u32 m0, s41, 45056
  s_add_u32 s18, s40, 32768
  buffer_load_dwordx4 v2, s[20:23], s18 offen lds
  s_add_u32 m0, s43, 45056
  s_add_u32 s18, s42, 32768
  buffer_load_dwordx4 v2, s[20:23], s18 offen lds
  s_add_u32 m0, s45, 45056
  s_add_u32 s18, s44, 32768
  buffer_load_dwordx4 v2, s[24:27], s18 offen lds
  s_add_u32 m0, s47, 45056
  s_add_u32 s18, s46, 32768
  buffer_load_dwordx4 v2, s[24:27], s18 offen lds
  s_waitcnt vmcnt(16)
  s_barrier
  s_add_u32 m0, s41, 67584
  s_add_u32 s18, s40, 34816
  buffer_load_dwordx4 v2, s[20:23], s18 offen lds
  s_add_u32 m0, s43, 67584
  s_add_u32 s18, s42, 34816
  buffer_load_dwordx4 v2, s[20:23], s18 offen lds
  s_add_u32 m0, s45, 67584
  s_add_u32 s18, s44, 34816
  buffer_load_dwordx4 v2, s[24:27], s18 offen lds
  s_add_u32 m0, s47, 67584
  s_add_u32 s18, s46, 34816
  buffer_load_dwordx4 v2, s[24:27], s18 offen lds
  s_waitcnt vmcnt(16)
  s_barrier
  s_add_u32 m0, s41, 90112
  s_add_u32 s18, s40, 36864
  buffer_load_dwordx4 v2, s[20:23], s18 offen lds
  s_add_u32 m0, s43, 90112
  s_add_u32 s18, s42, 36864
  buffer_load_dwordx4 v2, s[20:23], s18 offen lds
  s_add_u32 m0, s45, 90112
  s_add_u32 s18, s44, 36864
  buffer_load_dwordx4 v2, s[24:27], s18 offen lds
  s_add_u32 m0, s47, 90112
  s_add_u32 s18, s46, 36864
  buffer_load_dwordx4 v2, s[24:27], s18 offen lds
  s_waitcnt vmcnt(16)
  s_barrier
  s_add_u32 m0, s41, 112640
  s_add_u32 s18, s40, 38912
  buffer_load_dwordx4 v2, s[20:23], s18 offen lds
  s_add_u32 m0, s43, 112640
  s_add_u32 s18, s42, 38912
  buffer_load_dwordx4 v2, s[20:23], s18 offen lds
  s_add_u32 m0, s45, 112640
  s_add_u32 s18, s44, 38912
  buffer_load_dwordx4 v2, s[24:27], s18 offen lds
  s_add_u32 m0, s47, 112640
  s_add_u32 s18, s46, 38912
  buffer_load_dwordx4 v2, s[24:27], s18 offen lds
  s_waitcnt vmcnt(16)
  s_barrier
  s_waitcnt vmcnt(12)
  s_barrier
  s_waitcnt vmcnt(8)
  s_barrier
  s_waitcnt vmcnt(4)
  s_barrier
  s_waitcnt vmcnt(0)
  s_barrier
  s_mov_b32 s62, s11
  s_and_b32 s11, s13, 3
  s_lshl_b32 s11, s11, 3
  s_and_b32 s15, s14, 7
  s_add_u32 s11, s11, s15
  s_lshr_b32 s12, s13, 2
  s_lshl_b32 s12, s12, 2
  s_lshr_b32 s15, s14, 3
  s_add_u32 s12, s12, s15
  s_lshr_b32 s63, s11, 1
  s_lshl_b32 s53, s11, 3
  s_add_u32 s53, s53, s12
  s_mul_i32 s52, s62, 2048
  s_mul_i32 s53, s55, 128
  s_add_u32 s52, s52, s53
  s_add_u32 s52, s52, 32768
  v_mov_b32 v20, s52
  s_mul_i32 s52, s63, 2048
  s_add_u32 s52, s52, 32768
  v_and_b32 v22, 15, v0
  v_mul_u32_u24 v22, 128, v22
  v_add_u32 v22, s52, v22
  s_barrier
  v_mov_b32 v21, s54
  s_mov_b64 exec, 1
  buffer_store_dword v21, v20, s[56:59], 0 offen sc1
  s_mov_b64 exec, -1
  s_mov_b32 s30, 0
L_pp_phF_kernel:
  buffer_load_dword v21, v22, s[56:59], 0 offen sc1
  s_waitcnt vmcnt(0)
  v_cmp_ne_u32 vcc, s54, v21
  s_nop 4
  s_cbranch_vccz L_pp_phF_kernel_ok
  s_add_u32 s30, s30, 1
  s_cmp_lt_u32 s30, 0x4000
  s_cbranch_scc1 L_pp_phF_kernel
L_pp_phF_kernel_ok:
  s_barrier
  s_mul_i32 s52, s63, 2048
  s_add_u32 s52, s52, 196608
  v_lshrrev_b32 v22, 2, v0
  v_mul_u32_u24 v22, 128, v22
  v_and_b32 v23, 3, v0
  v_lshl_add_u32 v22, v23, 2, v22
  v_add_u32 v22, s52, v22
  s_barrier
  s_barrier
  s_barrier
  s_barrier
  buffer_load_dword v23, v22, s[56:59], 0 offen sc1
  s_barrier
  s_barrier
  s_waitcnt vmcnt(0)
  v_cmp_ne_u32 vcc, s54, v23
  s_nop 4
  s_cbranch_vccz L_p2_phF_kernel_done
  s_mov_b32 s30, 0
L_p2_phF_kernel:
  buffer_load_dword v23, v22, s[56:59], 0 offen sc1
  s_waitcnt vmcnt(0)
  v_cmp_ne_u32 vcc, s54, v23
  s_nop 4
  s_cbranch_vccz L_p2_phF_kernel_ok
  s_add_u32 s30, s30, 1
  s_cmp_lt_u32 s30, 0x4000
  s_cbranch_scc1 L_p2_phF_kernel
L_p2_phF_kernel_ok:
L_p2_phF_kernel_done:
  s_barrier
  s_endpgm
L_exit_phF_kernel:
  s_endpgm
.section .rodata,"a"
.p2align 6
.amdhsa_kernel sequential_preLN__sliding_block__glu_gated_bilinear__prompt_kernel
  .amdhsa_next_free_vgpr 256
  .amdhsa_next_free_sgpr 102
  .amdhsa_accum_offset 256
  .amdhsa_group_segment_fixed_size 0
  .amdhsa_kernarg_size 80
  .amdhsa_user_sgpr_count 2
  .amdhsa_user_sgpr_kernarg_segment_ptr 1
  .amdhsa_system_sgpr_workgroup_id_x 1
  .amdhsa_float_denorm_mode_32 3
.end_amdhsa_kernel
.text
```
